```python
import torch

def _softmax(x, axis=-1):
    return torch.softmax(x, dim=axis)
def _gelu(x):
    return torch.nn.functional.gelu(x, approximate="tanh")
def _silu(x):
    return torch.nn.functional.silu(x)
def _sigmoid(x):
    return torch.sigmoid(x)
def _layernorm(x, axis=-1, eps=1e-5):
    m = x.mean(dim=axis, keepdim=True)
    v = x.var(dim=axis, keepdim=True, unbiased=False)
    return (x - m) / torch.sqrt(v + eps)
def _scatter_add(tgt, idx, src, axis=0):
    return tgt.clone().index_add_(axis, idx, src)
def _segment_sum(src, seg, n):
    out = torch.zeros((n,) + src.shape[1:], dtype=src.dtype)
    return out.index_add_(0, seg, src)
def _pad(x, pw):
    flat = tuple(v for pair in reversed(pw) for v in pair)
    return torch.nn.functional.pad(x, flat)

kernel_name = 'standalone__mha_block_cached__near_ridge'

def setup_inputs():

    _w = (lambda a: (lambda t: t.to(torch.bfloat16) if t.is_floating_point() else t)(torch.as_tensor(a)))
    B, Sq, D = 8, 144, 448
    H, Sk, Dh = 16, 512, 256
    return {
        "x": _w((lambda *s: torch.randn(*s, dtype=torch.bfloat16) * 0.8)(B, Sq, D)),
        "k_cache": _w((lambda *s: torch.randn(*s, dtype=torch.bfloat16) * 0.8)(B, H, Sk, Dh)),
        "v_cache": _w((lambda *s: torch.randn(*s, dtype=torch.bfloat16) * 0.05)(B, H, Sk, Dh)),
        "wq": _w((lambda *s: torch.randn(*s, dtype=torch.bfloat16) * 0.8)(D, H * Dh) * (D ** -0.5)),
        "wo": _w((lambda *s: torch.randn(*s, dtype=torch.bfloat16) * 0.05)(H * Dh, D) * ((H * Dh) ** -0.5)),
    }

def reference(x, k_cache, v_cache, wq, wo):
    B, Sq, D = x.shape
    H, Dh = 16, 256
    q = (lambda x, *d: x.permute(*d))((x @ wq).reshape(B, Sq, H, Dh), 0, 2, 1, 3)
    scores = torch.einsum("bhqd,bhkd->bhqk", q, k_cache) * (Dh ** -0.5)
    p = _softmax(scores, axis=-1)
    o = torch.einsum("bhqk,bhkd->bhqd", p, v_cache)
    return (lambda x, *d: x.permute(*d))(o, 0, 2, 1, 3).reshape(B, Sq, H * Dh) @ wo
```

```asm
; @launch grid=(256,1,1) block=(256,1,1) lds=159744
.amdgcn_target "amdgcn-amd-amdhsa--gfx950"
.text
.globl standalone__mha_block_cached__near_ridge_kernel
.p2align 8
.type standalone__mha_block_cached__near_ridge_kernel,@function
standalone__mha_block_cached__near_ridge_kernel:
    s_cmp_ge_u32 s2, 256
    s_cbranch_scc1 L_k1_end
    s_load_dwordx16 s[36:51], s[0:1], 0
    v_lshrrev_b32 v1, 6, v0
    v_and_b32 v0, 63, v0
    v_readfirstlane_b32 s3, v1
    v_lshrrev_b32 v38, 3, v0
    v_and_b32 v39, 7, v0
    s_bfe_u32 s34, s2, 0x10003
    s_bfe_u32 s32, s2, 0x30004
    s_lshr_b32 s76, s2, 7
    s_and_b32 s33, s2, 7
    s_lshl1_add_u32 s33, s33, s76
    s_bfe_u32 s73, s2, 0x40003
    s_mul_i32 s76, s76, 3
    s_add_u32 s35, s32, s76
    s_cmp_ge_u32 s35, 7
    s_cselect_b32 s76, 7, 0
    s_sub_u32 s79, s35, s76
    s_lshl_b32 s52, s79, 7
    s_lshl1_add_u32 s35, s79, s34
    s_lshl_b32 s59, s35, 18
    s_lshl_b32 s35, s3, 14
    s_add_u32 s28, s35, 94208
    v_and_b32 v43, 6, v38
    v_xor_b32 v43, v43, v39
    v_lshlrev_b32 v43, 4, v43
    v_and_b32 v41, 4, v38
    v_add_u32 v41, v41, v38
    v_lshl_add_u32 v18, v41, 13, v43
    v_add_u32 v19, 130048, v18
    v_add_u32 v20, 30720, v18
    v_add_u32 v21, 160768, v18
    v_mul_u32_u24 v41, 896, v38
    v_lshrrev_b32 v40, 1, v38
    v_xor_b32 v40, v40, v39
    v_lshlrev_b32 v40, 4, v40
    v_xor_b32 v42, 64, v40
    s_mul_i32 s35, s3, 14336
    v_add3_u32 v34, v41, v40, s35
    s_add_u32 s35, s35, 6144
    v_add3_u32 v35, v41, v42, s35
    s_mul_i32 s35, s32, 129024
    s_mul_i32 s76, s34, 71680
    s_add_u32 s35, s35, s76
    s_lshl2_add_u32 s76, s33, s3
    s_lshl_b32 s76, s76, 7
    s_lshl_b32 m0, s3, 11
    s_waitcnt lgkmcnt(0)
    s_add_u32 s4, s36, s35
    s_addc_u32 s5, s37, 0
    s_sub_u32 s6, 1032192, s35
    s_mov_b32 s7, 0x20000
    buffer_load_dwordx4 v34, s[4:7], s52 offen  lds
    buffer_load_dwordx4 v35, s[4:7], s52 offen offset:1024  lds
    s_mov_b32 m0, s28
    s_add_u32 s16, s42, s76
    s_addc_u32 s17, s43, 0
    s_sub_u32 s18, 3670016, s76
    s_mov_b32 s19, 0x20000
    buffer_load_dwordx4 v18, s[16:19], s59 offen offset:0  lds
    buffer_load_dwordx4 v19, s[16:19], s59 offen offset:1024  lds
    buffer_load_dwordx4 v20, s[16:19], s59 offen offset:2048  lds
    buffer_load_dwordx4 v21, s[16:19], s59 offen offset:3072  lds
    s_getpc_b64 s[74:75]
    s_lshl2_add_u32 s35, s73, s3
    v_lshl_add_u32 v2, v0, 6, s35
    v_lshlrev_b32 v2, 7, v2
    v_min_u32 v2, L_main_end-standalone__mha_block_cached__near_ridge_kernel-256, v2
    s_mov_b64 exec, 0x1ff
    global_load_dword v240, v2, s[74:75]
    s_mov_b64 exec, -1
    s_lshl_b32 s35, s3, 5
    v_xor_b32 v36, s35, v40
    s_mul_i32 s35, s3, 3584
    s_add_u32 s35, s35, 57344
    v_add3_u32 v36, v41, v36, s35
    s_lshl_b32 s37, s3, 11
    s_cmp_eq_u32 s34, 1
    s_cbranch_scc1 L_light
    s_lshl_b32 s35, s3, 9
    s_add_u32 m0, s35, 8192
    s_mov_b32 exec_hi, 0
    buffer_load_dwordx4 v36, s[4:7], s52 offen  lds
    s_mov_b32 exec_hi, -1
    s_xor_b32 s60, s59, 0x40000
    s_add_u32 s79, s79, 1
    s_cmp_eq_u32 s79, 7
    s_cselect_b32 s79, 0, s79
    s_lshl_b32 s53, s79, 7
    s_lshl1_add_u32 s35, s79, s34
    s_lshl_b32 s61, s35, 18
    s_xor_b32 s62, s61, 0x40000
    s_add_u32 s79, s79, 1
    s_cmp_eq_u32 s79, 7
    s_cselect_b32 s79, 0, s79
    s_lshl_b32 s54, s79, 7
    s_lshl1_add_u32 s35, s79, s34
    s_lshl_b32 s63, s35, 18
    s_xor_b32 s64, s63, 0x40000
    s_add_u32 s79, s79, 1
    s_cmp_eq_u32 s79, 7
    s_cselect_b32 s79, 0, s79
    s_lshl_b32 s55, s79, 7
    s_lshl1_add_u32 s35, s79, s34
    s_lshl_b32 s65, s35, 18
    s_xor_b32 s66, s65, 0x40000
    s_add_u32 s79, s79, 1
    s_cmp_eq_u32 s79, 7
    s_cselect_b32 s79, 0, s79
    s_lshl_b32 s56, s79, 7
    s_lshl1_add_u32 s35, s79, s34
    s_lshl_b32 s67, s35, 18
    s_xor_b32 s68, s67, 0x40000
    s_add_u32 s79, s79, 1
    s_cmp_eq_u32 s79, 7
    s_cselect_b32 s79, 0, s79
    s_lshl_b32 s57, s79, 7
    s_lshl1_add_u32 s35, s79, s34
    s_lshl_b32 s69, s35, 18
    s_xor_b32 s70, s69, 0x40000
    s_add_u32 s79, s79, 1
    s_cmp_eq_u32 s79, 7
    s_cselect_b32 s79, 0, s79
    s_lshl_b32 s58, s79, 7
    s_lshl1_add_u32 s35, s79, s34
    s_lshl_b32 s71, s35, 18
    s_xor_b32 s72, s71, 0x40000
    s_add_u32 s29, s28, 4096
    s_add_u32 s30, s28, 8192
    s_add_u32 s31, s28, 12288
    s_lshl_b32 s1, s32, 13
    s_and_b32 s0, s1, 0xc000
    s_and_b32 s76, s33, 1
    s_lshl_b32 s76, s76, 12
    s_and_b32 s77, s1, 0x2000
    s_or_b32 s77, s77, s76
    v_add_u32 v30, v41, v43
    v_lshl_add_u32 v43, v38, 9, v43
    s_xor_b32 s35, s77, 0
    s_add_u32 s35, s35, 3072
    v_add_u32 v26, s35, v43
    s_xor_b32 s35, s77, 4096
    s_add_u32 s35, s35, 2048
    v_add_u32 v27, s35, v43
    s_xor_b32 s35, s77, 8192
    s_add_u32 s35, s35, 1024
    v_add_u32 v28, s35, v43
    s_xor_b32 s35, s77, 12288
    s_add_u32 s35, s35, 0
    v_add_u32 v29, s35, v43
    v_lshl_add_u32 v40, v38, 9, v40
    v_lshl_add_u32 v42, v38, 9, v42
    s_xor_b32 s35, s76, 0
    s_add_u32 s35, s35, 3072
    v_add_u32 v22, s35, v40
    s_xor_b32 s35, s76, 4096
    s_add_u32 s35, s35, 2048
    v_add_u32 v23, s35, v42
    s_xor_b32 s35, s76, 0
    s_add_u32 s35, s35, 1152
    v_add_u32 v24, s35, v40
    s_xor_b32 s35, s76, 4096
    s_add_u32 s35, s35, 128
    v_add_u32 v25, s35, v42
    s_lshl4_add_u32 s77, s32, s33
    s_lshl_b32 s35, s77, 18
    s_lshl_b32 s76, s3, 7
    s_add_u32 s76, s35, s76
    s_sub_u32 s40, s40, 3072
    s_subb_u32 s41, s41, 0
    s_add_u32 s12, s40, s76
    s_addc_u32 s13, s41, 0
    s_sub_u32 s14, 33557504, s76
    s_mov_b32 s15, 0x20000
    s_lshl_b32 s76, s3, 16
    s_add_u32 s35, s35, s76
    s_sub_u32 s38, s38, 3072
    s_subb_u32 s39, s39, 0
    s_add_u32 s8, s38, s35
    s_addc_u32 s9, s39, 0
    s_sub_u32 s10, 33557504, s35
    s_mov_b32 s11, 0x20000
    s_lshl3_add_u32 s35, s33, s3
    s_mul_i32 s35, s35, 28672
    s_add_u32 s20, s44, s35
    s_addc_u32 s21, s45, 0
    s_sub_u32 s22, 3670016, s35
    s_mov_b32 s23, 0x20000
    s_mul_i32 s35, s77, 131072
    s_add_u32 s24, s50, s35
    s_addc_u32 s25, s51, 0
    s_sub_u32 s26, 268435456, s35
    s_mov_b32 s27, 0x20000
    s_lshl_b32 s38, s3, 9
    s_add_u32 s38, s38, 8192
    v_mov_b32 v241, s53
    s_mov_b32 exec_lo, 0xffff0000
    v_mov_b32 v241, s54
    s_mov_b32 exec_lo, 0
    v_mov_b32 v241, s55
    s_mov_b32 exec_lo, -1
    v_and_b32 v242, 15, v0
    v_mul_u32_u24 v242, 896, v242
    s_add_u32 s35, s3, 5
    s_mul_i32 s35, s35, 14336
    v_add_u32 v241, v241, v242
    s_mov_b32 exec_hi, 0xffff
    buffer_load_dword v242, v241, s[4:7], s35 offen
    s_mov_b32 exec_hi, -1
    v_add_u32 v31, 6144, v30
    v_add_u32 v32, 12288, v30
    v_add_u32 v33, 18432, v30
    v_lshrrev_b32 v41, 4, v0
    v_and_b32 v42, 15, v0
    v_lshrrev_b32 v38, 2, v0
    v_and_b32 v39, 6, v38
    v_bfe_u32 v40, v0, 1, 1
    v_or_b32 v39, v39, v40
    v_lshlrev_b32 v39, 4, v39
    v_lshl_add_u32 v39, v38, 7, v39
    v_and_b32 v40, 1, v0
    v_lshl_add_u32 v39, v40, 3, v39
    v_xor_b32 v40, 0, v39
    v_add_u32 v1, s28, v40
    v_xor_b32 v40, 32, v39
    v_add_u32 v2, s28, v40
    v_xor_b32 v40, 64, v39
    v_add_u32 v3, s28, v40
    v_xor_b32 v40, 96, v39
    v_add_u32 v4, s28, v40
    s_lshl_b32 s35, s3, 5
    v_xor_b32 v40, s35, v39
    v_add_u32 v5, 94208, v40
    v_add_u32 v255, 40960, v40
    v_lshrrev_b32 v38, 1, v42
    v_xor_b32 v38, v38, v41
    v_lshlrev_b32 v38, 4, v38
    v_lshl_add_u32 v8, v42, 7, v38
    v_xor_b32 v9, 64, v8
    v_add_u32 v6, s28, v8
    v_add_u32 v7, s28, v9
    v_lshlrev_b32 v10, 4, v0
    v_add_u32 v11, 49152, v10
    v_lshrrev_b32 v38, 1, v41
    v_lshl_add_u32 v38, v38, 4, v42
    v_lshlrev_b32 v38, 4, v38
    v_and_b32 v39, 1, v41
    v_lshl_add_u32 v38, v39, 3, v38
    s_mul_i32 s35, s3, 10240
    v_add_u32 v12, s35, v38
    v_add_u32 v17, s35, v10
    s_mul_i32 s35, s3, 5120
    v_add_u32 v15, s35, v10
    v_add_u32 v16, s35, v11
    v_lshlrev_b32 v38, 4, v42
    v_add_u32 v14, 90112, v38
    s_lshl_b32 s35, s3, 2
    v_add_u32 v13, s35, v14
    v_mov_b32 v44, 0x3f803f80
    v_mov_b32 v45, 0x3f803f80
    v_mov_b32 v46, 0x3f803f80
    v_mov_b32 v47, 0x3f803f80
    s_mov_b32 s74, 0x3db8aa3b
    s_mov_b32 s75, 0x3db8aa3b
    s_mov_b32 s39, 0
    s_add_u32 m0, s37, 10240
    s_nop 0
    buffer_load_dwordx4 v34, s[4:7], s53 offen  lds
    buffer_load_dwordx4 v35, s[4:7], s53 offen offset:1024  lds
    s_add_u32 m0, s38, 10240
    s_mov_b32 exec_hi, 0
    buffer_load_dwordx4 v36, s[4:7], s53 offen  lds
    s_mov_b32 exec_hi, -1
    s_add_u32 m0, s37, 20480
    s_nop 0
    buffer_load_dwordx4 v34, s[4:7], s54 offen  lds
    buffer_load_dwordx4 v35, s[4:7], s54 offen offset:1024  lds
    s_add_u32 m0, s38, 20480
    s_mov_b32 exec_hi, 0
    buffer_load_dwordx4 v36, s[4:7], s54 offen  lds
    s_mov_b32 exec_hi, -1
    s_add_u32 m0, s37, 30720
    s_nop 0
    buffer_load_dwordx4 v34, s[4:7], s55 offen  lds
    buffer_load_dwordx4 v35, s[4:7], s55 offen offset:1024  lds
    s_add_u32 m0, s38, 30720
    s_mov_b32 exec_hi, 0
    buffer_load_dwordx4 v36, s[4:7], s55 offen  lds
    s_mov_b32 exec_hi, -1
    s_waitcnt vmcnt(10)
    s_barrier
    ds_read_b128 v[160:163], v8 offset:0
    ds_read_b128 v[164:167], v8 offset:2048
    ds_read_b128 v[168:171], v8 offset:4096
    ds_read_b128 v[172:175], v8 offset:6144
    ds_read_b128 v[176:179], v8 offset:8192
    ds_read_b64_tr_b16 v[128:129], v1 offset:0
    ds_read_b64_tr_b16 v[130:131], v1 offset:2048
    ds_read_b64_tr_b16 v[132:133], v2 offset:0
    ds_read_b64_tr_b16 v[134:135], v2 offset:2048
    ds_read_b64_tr_b16 v[136:137], v3 offset:0
    ds_read_b64_tr_b16 v[138:139], v3 offset:2048
    ds_read_b64_tr_b16 v[140:141], v4 offset:0
    ds_read_b64_tr_b16 v[142:143], v4 offset:2048
    s_mov_b32 m0, s29
    s_nop 0
    buffer_load_dwordx4 v18, s[16:19], s60 offen offset:0  lds
    buffer_load_dwordx4 v19, s[16:19], s60 offen offset:1024  lds
    buffer_load_dwordx4 v20, s[16:19], s60 offen offset:2048  lds
    buffer_load_dwordx4 v21, s[16:19], s60 offen offset:3072  lds
    s_mov_b32 m0, s30
    s_nop 0
    buffer_load_dwordx4 v18, s[16:19], s61 offen offset:0  lds
    buffer_load_dwordx4 v19, s[16:19], s61 offen offset:1024  lds
    buffer_load_dwordx4 v20, s[16:19], s61 offen offset:2048  lds
    buffer_load_dwordx4 v21, s[16:19], s61 offen offset:3072  lds
    s_waitcnt lgkmcnt(0)
    v_mfma_f32_16x16x32_bf16 v[48:51], v[128:131], v[160:163], 0
    s_mov_b32 m0, s31
    ds_read_b128 v[180:183], v9 offset:0
    ds_read_b128 v[184:187], v9 offset:2048
    v_mfma_f32_16x16x32_bf16 v[68:71], v[132:135], v[160:163], 0
    buffer_load_dwordx4 v18, s[16:19], s62 offen offset:0  lds
    ds_read_b128 v[188:191], v9 offset:4096
    v_mfma_f32_16x16x32_bf16 v[88:91], v[136:139], v[160:163], 0
    ds_read_b128 v[192:195], v9 offset:6144
    ds_read_b128 v[196:199], v9 offset:8192
    v_mfma_f32_16x16x32_bf16 v[108:111], v[140:143], v[160:163], 0
    buffer_load_dwordx4 v19, s[16:19], s62 offen offset:1024  lds
    v_mfma_f32_16x16x32_bf16 v[112:115], v[140:143], v[164:167], 0
    v_mfma_f32_16x16x32_bf16 v[92:95], v[136:139], v[164:167], 0
    buffer_load_dwordx4 v20, s[16:19], s62 offen offset:2048  lds
    v_mfma_f32_16x16x32_bf16 v[72:75], v[132:135], v[164:167], 0
    v_mfma_f32_16x16x32_bf16 v[52:55], v[128:131], v[164:167], 0
    v_mfma_f32_16x16x32_bf16 v[56:59], v[128:131], v[168:171], 0
    buffer_load_dwordx4 v21, s[16:19], s62 offen offset:3072  lds
    v_mfma_f32_16x16x32_bf16 v[76:79], v[132:135], v[168:171], 0
    s_waitcnt vmcnt(8)
    s_mov_b32 m0, s28
    ds_read_b64_tr_b16 v[144:145], v1 offset:4096
    v_mfma_f32_16x16x32_bf16 v[96:99], v[136:139], v[168:171], 0
    buffer_load_dwordx4 v18, s[16:19], s63 offen offset:0  lds
    ds_read_b64_tr_b16 v[146:147], v1 offset:6144
    v_mfma_f32_16x16x32_bf16 v[116:119], v[140:143], v[168:171], 0
    ds_read_b64_tr_b16 v[148:149], v2 offset:4096
    ds_read_b64_tr_b16 v[150:151], v2 offset:6144
    v_mfma_f32_16x16x32_bf16 v[120:123], v[140:143], v[172:175], 0
    buffer_load_dwordx4 v19, s[16:19], s63 offen offset:1024  lds
    ds_read_b64_tr_b16 v[152:153], v3 offset:4096
    v_mfma_f32_16x16x32_bf16 v[100:103], v[136:139], v[172:175], 0
    ds_read_b64_tr_b16 v[154:155], v3 offset:6144
    ds_read_b64_tr_b16 v[156:157], v4 offset:4096
    v_mfma_f32_16x16x32_bf16 v[80:83], v[132:135], v[172:175], 0
    ds_read_b64_tr_b16 v[158:159], v4 offset:6144
    v_mfma_f32_16x16x32_bf16 v[60:63], v[128:131], v[172:175], 0
    buffer_load_dwordx4 v20, s[16:19], s63 offen offset:2048  lds
    v_mfma_f32_16x16x32_bf16 v[64:67], v[128:131], v[176:179], 0
    v_mfma_f32_16x16x32_bf16 v[84:87], v[132:135], v[176:179], 0
    buffer_load_dwordx4 v21, s[16:19], s63 offen offset:3072  lds
    v_mfma_f32_16x16x32_bf16 v[104:107], v[136:139], v[176:179], 0
    v_mfma_f32_16x16x32_bf16 v[124:127], v[140:143], v[176:179], 0
    s_waitcnt lgkmcnt(0)
    v_mfma_f32_16x16x32_bf16 v[48:51], v[144:147], v[180:183], v[48:51]
    s_add_u32 m0, s37, 40960
    v_mfma_f32_16x16x32_bf16 v[68:71], v[148:151], v[180:183], v[68:71]
    s_waitcnt vmcnt(8)
    s_barrier
    buffer_load_dwordx4 v34, s[4:7], s56 offen  lds
    v_mfma_f32_16x16x32_bf16 v[88:91], v[152:155], v[180:183], v[88:91]
    ds_read_b128 v[160:163], v8 offset:10240
    ds_read_b128 v[164:167], v8 offset:12288
    v_mfma_f32_16x16x32_bf16 v[108:111], v[156:159], v[180:183], v[108:111]
    buffer_load_dwordx4 v35, s[4:7], s56 offen offset:1024  lds
    ds_read_b128 v[168:171], v8 offset:14336
    v_mfma_f32_16x16x32_bf16 v[112:115], v[156:159], v[184:187], v[112:115]
    ds_read_b128 v[172:175], v8 offset:16384
    ds_read_b128 v[176:179], v8 offset:18432
    v_mfma_f32_16x16x32_bf16 v[92:95], v[152:155], v[184:187], v[92:95]
    s_add_u32 m0, s38, 40960
    ds_read_b64_tr_b16 v[128:129], v1 offset:8192
    ds_read_b64_tr_b16 v[130:131], v1 offset:10240
    v_mfma_f32_16x16x32_bf16 v[72:75], v[148:151], v[184:187], v[72:75]
    s_mov_b32 exec_hi, 0
    buffer_load_dwordx4 v36, s[4:7], s56 offen  lds
    s_mov_b32 exec_hi, -1
    v_mfma_f32_16x16x32_bf16 v[52:55], v[144:147], v[184:187], v[52:55]
    ds_read_b64_tr_b16 v[132:133], v2 offset:8192
    ds_read_b64_tr_b16 v[134:135], v2 offset:10240
    v_mfma_f32_16x16x32_bf16 v[56:59], v[144:147], v[188:191], v[56:59]
    s_mov_b32 m0, s29
    ds_read_b64_tr_b16 v[136:137], v3 offset:8192
    ds_read_b64_tr_b16 v[138:139], v3 offset:10240
    v_mfma_f32_16x16x32_bf16 v[76:79], v[148:151], v[188:191], v[76:79]
    buffer_load_dwordx4 v18, s[16:19], s64 offen offset:0  lds
    ds_read_b64_tr_b16 v[140:141], v4 offset:8192
    v_mfma_f32_16x16x32_bf16 v[96:99], v[152:155], v[188:191], v[96:99]
    ds_read_b64_tr_b16 v[142:143], v4 offset:10240
    v_mfma_f32_16x16x32_bf16 v[116:119], v[156:159], v[188:191], v[116:119]
    buffer_load_dwordx4 v19, s[16:19], s64 offen offset:1024  lds
    v_mfma_f32_16x16x32_bf16 v[120:123], v[156:159], v[192:195], v[120:123]
    v_mfma_f32_16x16x32_bf16 v[100:103], v[152:155], v[192:195], v[100:103]
    v_mfma_f32_16x16x32_bf16 v[80:83], v[148:151], v[192:195], v[80:83]
    buffer_load_dwordx4 v20, s[16:19], s64 offen offset:2048  lds
    v_mfma_f32_16x16x32_bf16 v[60:63], v[144:147], v[192:195], v[60:63]
    v_mfma_f32_16x16x32_bf16 v[64:67], v[144:147], v[196:199], v[64:67]
    v_mfma_f32_16x16x32_bf16 v[84:87], v[148:151], v[196:199], v[84:87]
    buffer_load_dwordx4 v21, s[16:19], s64 offen offset:3072  lds
    v_mfma_f32_16x16x32_bf16 v[104:107], v[152:155], v[196:199], v[104:107]
    v_mfma_f32_16x16x32_bf16 v[124:127], v[156:159], v[196:199], v[124:127]
    s_waitcnt lgkmcnt(0)
    v_mfma_f32_16x16x32_bf16 v[48:51], v[128:131], v[160:163], v[48:51]
    s_add_u32 m0, s37, 51200
    ds_read_b128 v[180:183], v9 offset:10240
    ds_read_b128 v[184:187], v9 offset:12288
    v_mfma_f32_16x16x32_bf16 v[68:71], v[132:135], v[160:163], v[68:71]
    buffer_load_dwordx4 v34, s[4:7], s57 offen  lds
    ds_read_b128 v[188:191], v9 offset:14336
    v_mfma_f32_16x16x32_bf16 v[88:91], v[136:139], v[160:163], v[88:91]
    ds_read_b128 v[192:195], v9 offset:16384
    ds_read_b128 v[196:199], v9 offset:18432
    v_mfma_f32_16x16x32_bf16 v[108:111], v[140:143], v[160:163], v[108:111]
    buffer_load_dwordx4 v35, s[4:7], s57 offen offset:1024  lds
    v_mfma_f32_16x16x32_bf16 v[112:115], v[140:143], v[164:167], v[112:115]
    v_mfma_f32_16x16x32_bf16 v[92:95], v[136:139], v[164:167], v[92:95]
    s_add_u32 m0, s38, 51200
    v_mfma_f32_16x16x32_bf16 v[72:75], v[132:135], v[164:167], v[72:75]
    s_mov_b32 exec_hi, 0
    buffer_load_dwordx4 v36, s[4:7], s57 offen  lds
    s_mov_b32 exec_hi, -1
    v_mfma_f32_16x16x32_bf16 v[52:55], v[128:131], v[164:167], v[52:55]
    v_mfma_f32_16x16x32_bf16 v[56:59], v[128:131], v[168:171], v[56:59]
    s_mov_b32 m0, s30
    v_mfma_f32_16x16x32_bf16 v[76:79], v[132:135], v[168:171], v[76:79]
    s_waitcnt vmcnt(14)
    buffer_load_dwordx4 v18, s[16:19], s65 offen offset:0  lds
    ds_read_b64_tr_b16 v[144:145], v1 offset:12288
    v_mfma_f32_16x16x32_bf16 v[96:99], v[136:139], v[168:171], v[96:99]
    ds_read_b64_tr_b16 v[146:147], v1 offset:14336
    ds_read_b64_tr_b16 v[148:149], v2 offset:12288
    v_mfma_f32_16x16x32_bf16 v[116:119], v[140:143], v[168:171], v[116:119]
    buffer_load_dwordx4 v19, s[16:19], s65 offen offset:1024  lds
    ds_read_b64_tr_b16 v[150:151], v2 offset:14336
    v_mfma_f32_16x16x32_bf16 v[120:123], v[140:143], v[172:175], v[120:123]
    ds_read_b64_tr_b16 v[152:153], v3 offset:12288
    ds_read_b64_tr_b16 v[154:155], v3 offset:14336
    v_mfma_f32_16x16x32_bf16 v[100:103], v[136:139], v[172:175], v[100:103]
    ds_read_b64_tr_b16 v[156:157], v4 offset:12288
    ds_read_b64_tr_b16 v[158:159], v4 offset:14336
    v_mfma_f32_16x16x32_bf16 v[80:83], v[132:135], v[172:175], v[80:83]
    buffer_load_dwordx4 v20, s[16:19], s65 offen offset:2048  lds
    v_mfma_f32_16x16x32_bf16 v[60:63], v[128:131], v[172:175], v[60:63]
    v_mfma_f32_16x16x32_bf16 v[64:67], v[128:131], v[176:179], v[64:67]
    v_mfma_f32_16x16x32_bf16 v[84:87], v[132:135], v[176:179], v[84:87]
    buffer_load_dwordx4 v21, s[16:19], s65 offen offset:3072  lds
    v_mfma_f32_16x16x32_bf16 v[104:107], v[136:139], v[176:179], v[104:107]
    v_mfma_f32_16x16x32_bf16 v[124:127], v[140:143], v[176:179], v[124:127]
    s_waitcnt lgkmcnt(0)
    v_mfma_f32_16x16x32_bf16 v[48:51], v[144:147], v[180:183], v[48:51]
    s_add_u32 m0, s37, 61440
    ds_read_b128 v[160:163], v8 offset:20480
    ds_read_b128 v[164:167], v8 offset:22528
    v_mfma_f32_16x16x32_bf16 v[68:71], v[148:151], v[180:183], v[68:71]
    buffer_load_dwordx4 v34, s[4:7], s58 offen  lds
    ds_read_b128 v[168:171], v8 offset:24576
    v_mfma_f32_16x16x32_bf16 v[88:91], v[152:155], v[180:183], v[88:91]
    ds_read_b128 v[172:175], v8 offset:26624
    ds_read_b128 v[176:179], v8 offset:28672
    v_mfma_f32_16x16x32_bf16 v[108:111], v[156:159], v[180:183], v[108:111]
    buffer_load_dwordx4 v35, s[4:7], s58 offen offset:1024  lds
    v_mfma_f32_16x16x32_bf16 v[112:115], v[156:159], v[184:187], v[112:115]
    v_mfma_f32_16x16x32_bf16 v[92:95], v[152:155], v[184:187], v[92:95]
    s_add_u32 m0, s38, 61440
    v_mfma_f32_16x16x32_bf16 v[72:75], v[148:151], v[184:187], v[72:75]
    s_mov_b32 exec_hi, 0
    buffer_load_dwordx4 v36, s[4:7], s58 offen  lds
    s_mov_b32 exec_hi, -1
    v_mfma_f32_16x16x32_bf16 v[52:55], v[144:147], v[184:187], v[52:55]
    v_mfma_f32_16x16x32_bf16 v[56:59], v[144:147], v[188:191], v[56:59]
    s_mov_b32 m0, s31
    v_mfma_f32_16x16x32_bf16 v[76:79], v[148:151], v[188:191], v[76:79]
    s_waitcnt vmcnt(17)
    buffer_load_dwordx4 v18, s[16:19], s66 offen offset:0  lds
    ds_read_b64_tr_b16 v[128:129], v1 offset:0
    v_mfma_f32_16x16x32_bf16 v[96:99], v[152:155], v[188:191], v[96:99]
    ds_read_b64_tr_b16 v[130:131], v1 offset:2048
    ds_read_b64_tr_b16 v[132:133], v2 offset:0
    v_mfma_f32_16x16x32_bf16 v[116:119], v[156:159], v[188:191], v[116:119]
    buffer_load_dwordx4 v19, s[16:19], s66 offen offset:1024  lds
    ds_read_b64_tr_b16 v[134:135], v2 offset:2048
    v_mfma_f32_16x16x32_bf16 v[120:123], v[156:159], v[192:195], v[120:123]
    ds_read_b64_tr_b16 v[136:137], v3 offset:0
    ds_read_b64_tr_b16 v[138:139], v3 offset:2048
    v_mfma_f32_16x16x32_bf16 v[100:103], v[152:155], v[192:195], v[100:103]
    ds_read_b64_tr_b16 v[140:141], v4 offset:0
    ds_read_b64_tr_b16 v[142:143], v4 offset:2048
    v_mfma_f32_16x16x32_bf16 v[80:83], v[148:151], v[192:195], v[80:83]
    buffer_load_dwordx4 v20, s[16:19], s66 offen offset:2048  lds
    v_mfma_f32_16x16x32_bf16 v[60:63], v[144:147], v[192:195], v[60:63]
    v_mfma_f32_16x16x32_bf16 v[64:67], v[144:147], v[196:199], v[64:67]
    v_mfma_f32_16x16x32_bf16 v[84:87], v[148:151], v[196:199], v[84:87]
    buffer_load_dwordx4 v21, s[16:19], s66 offen offset:3072  lds
    v_mfma_f32_16x16x32_bf16 v[104:107], v[152:155], v[196:199], v[104:107]
    v_mfma_f32_16x16x32_bf16 v[124:127], v[156:159], v[196:199], v[124:127]
    s_waitcnt lgkmcnt(0)
    v_mfma_f32_16x16x32_bf16 v[48:51], v[128:131], v[160:163], v[48:51]
    s_mov_b32 m0, s28
    ds_read_b128 v[180:183], v9 offset:20480
    ds_read_b128 v[184:187], v9 offset:22528
    v_mfma_f32_16x16x32_bf16 v[68:71], v[132:135], v[160:163], v[68:71]
    buffer_load_dwordx4 v18, s[16:19], s67 offen offset:0  lds
    ds_read_b128 v[188:191], v9 offset:24576
    v_mfma_f32_16x16x32_bf16 v[88:91], v[136:139], v[160:163], v[88:91]
    ds_read_b128 v[192:195], v9 offset:26624
    ds_read_b128 v[196:199], v9 offset:28672
    v_mfma_f32_16x16x32_bf16 v[108:111], v[140:143], v[160:163], v[108:111]
    v_mfma_f32_16x16x32_bf16 v[112:115], v[140:143], v[164:167], v[112:115]
    v_mfma_f32_16x16x32_bf16 v[92:95], v[136:139], v[164:167], v[92:95]
    buffer_load_dwordx4 v19, s[16:19], s67 offen offset:1024  lds
    v_mfma_f32_16x16x32_bf16 v[72:75], v[132:135], v[164:167], v[72:75]
    v_mfma_f32_16x16x32_bf16 v[52:55], v[128:131], v[164:167], v[52:55]
    v_mfma_f32_16x16x32_bf16 v[56:59], v[128:131], v[168:171], v[56:59]
    v_mfma_f32_16x16x32_bf16 v[76:79], v[132:135], v[168:171], v[76:79]
    s_waitcnt vmcnt(16)
    ds_read_b64_tr_b16 v[144:145], v1 offset:4096
    ds_read_b64_tr_b16 v[146:147], v1 offset:6144
    v_mfma_f32_16x16x32_bf16 v[96:99], v[136:139], v[168:171], v[96:99]
    buffer_load_dwordx4 v20, s[16:19], s67 offen offset:2048  lds
    ds_read_b64_tr_b16 v[148:149], v2 offset:4096
    v_mfma_f32_16x16x32_bf16 v[116:119], v[140:143], v[168:171], v[116:119]
    ds_read_b64_tr_b16 v[150:151], v2 offset:6144
    ds_read_b64_tr_b16 v[152:153], v3 offset:4096
    v_mfma_f32_16x16x32_bf16 v[120:123], v[140:143], v[172:175], v[120:123]
    ds_read_b64_tr_b16 v[154:155], v3 offset:6144
    ds_read_b64_tr_b16 v[156:157], v4 offset:4096
    v_mfma_f32_16x16x32_bf16 v[100:103], v[136:139], v[172:175], v[100:103]
    ds_read_b64_tr_b16 v[158:159], v4 offset:6144
    v_mfma_f32_16x16x32_bf16 v[80:83], v[132:135], v[172:175], v[80:83]
    v_mfma_f32_16x16x32_bf16 v[60:63], v[128:131], v[172:175], v[60:63]
    buffer_load_dwordx4 v21, s[16:19], s67 offen offset:3072  lds
    v_mfma_f32_16x16x32_bf16 v[64:67], v[128:131], v[176:179], v[64:67]
    v_mfma_f32_16x16x32_bf16 v[84:87], v[132:135], v[176:179], v[84:87]
    v_mfma_f32_16x16x32_bf16 v[104:107], v[136:139], v[176:179], v[104:107]
    v_mfma_f32_16x16x32_bf16 v[124:127], v[140:143], v[176:179], v[124:127]
    s_waitcnt lgkmcnt(0)
    v_mfma_f32_16x16x32_bf16 v[48:51], v[144:147], v[180:183], v[48:51]
    s_mov_b32 m0, s29
    ds_read_b128 v[160:163], v8 offset:30720
    ds_read_b128 v[164:167], v8 offset:32768
    v_mfma_f32_16x16x32_bf16 v[68:71], v[148:151], v[180:183], v[68:71]
    buffer_load_dwordx4 v18, s[16:19], s68 offen offset:0  lds
    ds_read_b128 v[168:171], v8 offset:34816
    v_mfma_f32_16x16x32_bf16 v[88:91], v[152:155], v[180:183], v[88:91]
    ds_read_b128 v[172:175], v8 offset:36864
    ds_read_b128 v[176:179], v8 offset:38912
    v_mfma_f32_16x16x32_bf16 v[108:111], v[156:159], v[180:183], v[108:111]
    v_mfma_f32_16x16x32_bf16 v[112:115], v[156:159], v[184:187], v[112:115]
    v_mfma_f32_16x16x32_bf16 v[92:95], v[152:155], v[184:187], v[92:95]
    buffer_load_dwordx4 v19, s[16:19], s68 offen offset:1024  lds
    v_mfma_f32_16x16x32_bf16 v[72:75], v[148:151], v[184:187], v[72:75]
    v_mfma_f32_16x16x32_bf16 v[52:55], v[144:147], v[184:187], v[52:55]
    v_mfma_f32_16x16x32_bf16 v[56:59], v[144:147], v[188:191], v[56:59]
    v_mfma_f32_16x16x32_bf16 v[76:79], v[148:151], v[188:191], v[76:79]
    s_waitcnt vmcnt(13)
    ds_read_b64_tr_b16 v[128:129], v1 offset:8192
    ds_read_b64_tr_b16 v[130:131], v1 offset:10240
    v_mfma_f32_16x16x32_bf16 v[96:99], v[152:155], v[188:191], v[96:99]
    buffer_load_dwordx4 v20, s[16:19], s68 offen offset:2048  lds
    ds_read_b64_tr_b16 v[132:133], v2 offset:8192
    v_mfma_f32_16x16x32_bf16 v[116:119], v[156:159], v[188:191], v[116:119]
    ds_read_b64_tr_b16 v[134:135], v2 offset:10240
    ds_read_b64_tr_b16 v[136:137], v3 offset:8192
    v_mfma_f32_16x16x32_bf16 v[120:123], v[156:159], v[192:195], v[120:123]
    ds_read_b64_tr_b16 v[138:139], v3 offset:10240
    ds_read_b64_tr_b16 v[140:141], v4 offset:8192
    v_mfma_f32_16x16x32_bf16 v[100:103], v[152:155], v[192:195], v[100:103]
    ds_read_b64_tr_b16 v[142:143], v4 offset:10240
    v_mfma_f32_16x16x32_bf16 v[80:83], v[148:151], v[192:195], v[80:83]
    v_mfma_f32_16x16x32_bf16 v[60:63], v[144:147], v[192:195], v[60:63]
    buffer_load_dwordx4 v21, s[16:19], s68 offen offset:3072  lds
    v_mfma_f32_16x16x32_bf16 v[64:67], v[144:147], v[196:199], v[64:67]
    v_mfma_f32_16x16x32_bf16 v[84:87], v[148:151], v[196:199], v[84:87]
    v_mfma_f32_16x16x32_bf16 v[104:107], v[152:155], v[196:199], v[104:107]
    v_mfma_f32_16x16x32_bf16 v[124:127], v[156:159], v[196:199], v[124:127]
    s_waitcnt lgkmcnt(0)
    v_mfma_f32_16x16x32_bf16 v[48:51], v[128:131], v[160:163], v[48:51]
    s_mov_b32 m0, s30
    ds_read_b128 v[180:183], v9 offset:30720
    ds_read_b128 v[184:187], v9 offset:32768
    v_mfma_f32_16x16x32_bf16 v[68:71], v[132:135], v[160:163], v[68:71]
    buffer_load_dwordx4 v18, s[16:19], s69 offen offset:0  lds
    ds_read_b128 v[188:191], v9 offset:34816
    v_mfma_f32_16x16x32_bf16 v[88:91], v[136:139], v[160:163], v[88:91]
    ds_read_b128 v[192:195], v9 offset:36864
    ds_read_b128 v[196:199], v9 offset:38912
    v_mfma_f32_16x16x32_bf16 v[108:111], v[140:143], v[160:163], v[108:111]
    v_mfma_f32_16x16x32_bf16 v[112:115], v[140:143], v[164:167], v[112:115]
    v_mfma_f32_16x16x32_bf16 v[92:95], v[136:139], v[164:167], v[92:95]
    buffer_load_dwordx4 v19, s[16:19], s69 offen offset:1024  lds
    v_mfma_f32_16x16x32_bf16 v[72:75], v[132:135], v[164:167], v[72:75]
    v_mfma_f32_16x16x32_bf16 v[52:55], v[128:131], v[164:167], v[52:55]
    v_mfma_f32_16x16x32_bf16 v[56:59], v[128:131], v[168:171], v[56:59]
    v_mfma_f32_16x16x32_bf16 v[76:79], v[132:135], v[168:171], v[76:79]
    s_waitcnt vmcnt(10)
    ds_read_b64_tr_b16 v[144:145], v1 offset:12288
    ds_read_b64_tr_b16 v[146:147], v1 offset:14336
    v_mfma_f32_16x16x32_bf16 v[96:99], v[136:139], v[168:171], v[96:99]
    buffer_load_dwordx4 v20, s[16:19], s69 offen offset:2048  lds
    ds_read_b64_tr_b16 v[148:149], v2 offset:12288
    v_mfma_f32_16x16x32_bf16 v[116:119], v[140:143], v[168:171], v[116:119]
    ds_read_b64_tr_b16 v[150:151], v2 offset:14336
    ds_read_b64_tr_b16 v[152:153], v3 offset:12288
    v_mfma_f32_16x16x32_bf16 v[120:123], v[140:143], v[172:175], v[120:123]
    ds_read_b64_tr_b16 v[154:155], v3 offset:14336
    ds_read_b64_tr_b16 v[156:157], v4 offset:12288
    v_mfma_f32_16x16x32_bf16 v[100:103], v[136:139], v[172:175], v[100:103]
    ds_read_b64_tr_b16 v[158:159], v4 offset:14336
    v_mfma_f32_16x16x32_bf16 v[80:83], v[132:135], v[172:175], v[80:83]
    v_mfma_f32_16x16x32_bf16 v[60:63], v[128:131], v[172:175], v[60:63]
    buffer_load_dwordx4 v21, s[16:19], s69 offen offset:3072  lds
    v_mfma_f32_16x16x32_bf16 v[64:67], v[128:131], v[176:179], v[64:67]
    v_mfma_f32_16x16x32_bf16 v[84:87], v[132:135], v[176:179], v[84:87]
    v_mfma_f32_16x16x32_bf16 v[104:107], v[136:139], v[176:179], v[104:107]
    v_mfma_f32_16x16x32_bf16 v[124:127], v[140:143], v[176:179], v[124:127]
    s_waitcnt lgkmcnt(0)
    v_mfma_f32_16x16x32_bf16 v[48:51], v[144:147], v[180:183], v[48:51]
    s_mov_b32 m0, s31
    v_mfma_f32_16x16x32_bf16 v[68:71], v[148:151], v[180:183], v[68:71]
    s_waitcnt vmcnt(8)
    s_barrier
    buffer_load_dwordx4 v18, s[16:19], s70 offen offset:0  lds
    v_mfma_f32_16x16x32_bf16 v[88:91], v[152:155], v[180:183], v[88:91]
    v_add_u32 v8, 32768, v8
    v_add_u32 v9, 32768, v9
    v_mfma_f32_16x16x32_bf16 v[108:111], v[156:159], v[180:183], v[108:111]
    ds_read_b128 v[160:163], v8 offset:8192
    ds_read_b128 v[164:167], v8 offset:10240
    v_mfma_f32_16x16x32_bf16 v[112:115], v[156:159], v[184:187], v[112:115]
    ds_read_b128 v[168:171], v8 offset:12288
    ds_read_b128 v[172:175], v8 offset:14336
    v_mfma_f32_16x16x32_bf16 v[92:95], v[152:155], v[184:187], v[92:95]
    buffer_load_dwordx4 v19, s[16:19], s70 offen offset:1024  lds
    ds_read_b128 v[176:179], v8 offset:16384
    v_mfma_f32_16x16x32_bf16 v[72:75], v[148:151], v[184:187], v[72:75]
    ds_read_b64_tr_b16 v[128:129], v1 offset:0
    ds_read_b64_tr_b16 v[130:131], v1 offset:2048
    v_mfma_f32_16x16x32_bf16 v[52:55], v[144:147], v[184:187], v[52:55]
    ds_read_b64_tr_b16 v[132:133], v2 offset:0
    ds_read_b64_tr_b16 v[134:135], v2 offset:2048
    v_mfma_f32_16x16x32_bf16 v[56:59], v[144:147], v[188:191], v[56:59]
    ds_read_b64_tr_b16 v[136:137], v3 offset:0
    ds_read_b64_tr_b16 v[138:139], v3 offset:2048
    v_mfma_f32_16x16x32_bf16 v[76:79], v[148:151], v[188:191], v[76:79]
    ds_read_b64_tr_b16 v[140:141], v4 offset:0
    ds_read_b64_tr_b16 v[142:143], v4 offset:2048
    v_mfma_f32_16x16x32_bf16 v[96:99], v[152:155], v[188:191], v[96:99]
    buffer_load_dwordx4 v20, s[16:19], s70 offen offset:2048  lds
    v_mfma_f32_16x16x32_bf16 v[116:119], v[156:159], v[188:191], v[116:119]
    v_mfma_f32_16x16x32_bf16 v[120:123], v[156:159], v[192:195], v[120:123]
    v_mfma_f32_16x16x32_bf16 v[100:103], v[152:155], v[192:195], v[100:103]
    v_mfma_f32_16x16x32_bf16 v[80:83], v[148:151], v[192:195], v[80:83]
    v_mfma_f32_16x16x32_bf16 v[60:63], v[144:147], v[192:195], v[60:63]
    buffer_load_dwordx4 v21, s[16:19], s70 offen offset:3072  lds
    v_mfma_f32_16x16x32_bf16 v[64:67], v[144:147], v[196:199], v[64:67]
    v_mfma_f32_16x16x32_bf16 v[84:87], v[148:151], v[196:199], v[84:87]
    v_mfma_f32_16x16x32_bf16 v[104:107], v[152:155], v[196:199], v[104:107]
    v_mfma_f32_16x16x32_bf16 v[124:127], v[156:159], v[196:199], v[124:127]
    s_waitcnt lgkmcnt(0)
    v_mfma_f32_16x16x32_bf16 v[48:51], v[128:131], v[160:163], v[48:51]
    s_mov_b32 m0, s28
    ds_read_b128 v[180:183], v9 offset:8192
    ds_read_b128 v[184:187], v9 offset:10240
    v_mfma_f32_16x16x32_bf16 v[68:71], v[132:135], v[160:163], v[68:71]
    buffer_load_dwordx4 v18, s[16:19], s71 offen offset:0  lds
    ds_read_b128 v[188:191], v9 offset:12288
    v_mfma_f32_16x16x32_bf16 v[88:91], v[136:139], v[160:163], v[88:91]
    ds_read_b128 v[192:195], v9 offset:14336
    ds_read_b128 v[196:199], v9 offset:16384
    v_mfma_f32_16x16x32_bf16 v[108:111], v[140:143], v[160:163], v[108:111]
    v_mfma_f32_16x16x32_bf16 v[112:115], v[140:143], v[164:167], v[112:115]
    v_mfma_f32_16x16x32_bf16 v[92:95], v[136:139], v[164:167], v[92:95]
    buffer_load_dwordx4 v19, s[16:19], s71 offen offset:1024  lds
    v_mfma_f32_16x16x32_bf16 v[72:75], v[132:135], v[164:167], v[72:75]
    v_mfma_f32_16x16x32_bf16 v[52:55], v[128:131], v[164:167], v[52:55]
    v_mfma_f32_16x16x32_bf16 v[56:59], v[128:131], v[168:171], v[56:59]
    v_mfma_f32_16x16x32_bf16 v[76:79], v[132:135], v[168:171], v[76:79]
    s_waitcnt vmcnt(10)
    ds_read_b64_tr_b16 v[144:145], v1 offset:4096
    ds_read_b64_tr_b16 v[146:147], v1 offset:6144
    v_mfma_f32_16x16x32_bf16 v[96:99], v[136:139], v[168:171], v[96:99]
    buffer_load_dwordx4 v20, s[16:19], s71 offen offset:2048  lds
    ds_read_b64_tr_b16 v[148:149], v2 offset:4096
    v_mfma_f32_16x16x32_bf16 v[116:119], v[140:143], v[168:171], v[116:119]
    ds_read_b64_tr_b16 v[150:151], v2 offset:6144
    ds_read_b64_tr_b16 v[152:153], v3 offset:4096
    v_mfma_f32_16x16x32_bf16 v[120:123], v[140:143], v[172:175], v[120:123]
    ds_read_b64_tr_b16 v[154:155], v3 offset:6144
    ds_read_b64_tr_b16 v[156:157], v4 offset:4096
    v_mfma_f32_16x16x32_bf16 v[100:103], v[136:139], v[172:175], v[100:103]
    ds_read_b64_tr_b16 v[158:159], v4 offset:6144
    v_mfma_f32_16x16x32_bf16 v[80:83], v[132:135], v[172:175], v[80:83]
    v_mfma_f32_16x16x32_bf16 v[60:63], v[128:131], v[172:175], v[60:63]
    buffer_load_dwordx4 v21, s[16:19], s71 offen offset:3072  lds
    v_mfma_f32_16x16x32_bf16 v[64:67], v[128:131], v[176:179], v[64:67]
    v_mfma_f32_16x16x32_bf16 v[84:87], v[132:135], v[176:179], v[84:87]
    v_mfma_f32_16x16x32_bf16 v[104:107], v[136:139], v[176:179], v[104:107]
    v_mfma_f32_16x16x32_bf16 v[124:127], v[140:143], v[176:179], v[124:127]
    s_waitcnt lgkmcnt(0)
    v_mfma_f32_16x16x32_bf16 v[48:51], v[144:147], v[180:183], v[48:51]
    s_mov_b32 m0, s29
    ds_read_b128 v[160:163], v8 offset:18432
    ds_read_b128 v[164:167], v8 offset:20480
    v_mfma_f32_16x16x32_bf16 v[68:71], v[148:151], v[180:183], v[68:71]
    buffer_load_dwordx4 v18, s[16:19], s72 offen offset:0  lds
    ds_read_b128 v[168:171], v8 offset:22528
    v_mfma_f32_16x16x32_bf16 v[88:91], v[152:155], v[180:183], v[88:91]
    ds_read_b128 v[172:175], v8 offset:24576
    ds_read_b128 v[176:179], v8 offset:26624
    v_mfma_f32_16x16x32_bf16 v[108:111], v[156:159], v[180:183], v[108:111]
    v_mfma_f32_16x16x32_bf16 v[112:115], v[156:159], v[184:187], v[112:115]
    v_mfma_f32_16x16x32_bf16 v[92:95], v[152:155], v[184:187], v[92:95]
    buffer_load_dwordx4 v19, s[16:19], s72 offen offset:1024  lds
    v_mfma_f32_16x16x32_bf16 v[72:75], v[148:151], v[184:187], v[72:75]
    v_mfma_f32_16x16x32_bf16 v[52:55], v[144:147], v[184:187], v[52:55]
    v_mfma_f32_16x16x32_bf16 v[56:59], v[144:147], v[188:191], v[56:59]
    v_mfma_f32_16x16x32_bf16 v[76:79], v[148:151], v[188:191], v[76:79]
    s_waitcnt vmcnt(10)
    ds_read_b64_tr_b16 v[128:129], v1 offset:8192
    ds_read_b64_tr_b16 v[130:131], v1 offset:10240
    v_mfma_f32_16x16x32_bf16 v[96:99], v[152:155], v[188:191], v[96:99]
    buffer_load_dwordx4 v20, s[16:19], s72 offen offset:2048  lds
    ds_read_b64_tr_b16 v[132:133], v2 offset:8192
    v_mfma_f32_16x16x32_bf16 v[116:119], v[156:159], v[188:191], v[116:119]
    ds_read_b64_tr_b16 v[134:135], v2 offset:10240
    ds_read_b64_tr_b16 v[136:137], v3 offset:8192
    v_mfma_f32_16x16x32_bf16 v[120:123], v[156:159], v[192:195], v[120:123]
    ds_read_b64_tr_b16 v[138:139], v3 offset:10240
    ds_read_b64_tr_b16 v[140:141], v4 offset:8192
    v_mfma_f32_16x16x32_bf16 v[100:103], v[152:155], v[192:195], v[100:103]
    ds_read_b64_tr_b16 v[142:143], v4 offset:10240
    v_mfma_f32_16x16x32_bf16 v[80:83], v[148:151], v[192:195], v[80:83]
    v_mfma_f32_16x16x32_bf16 v[60:63], v[144:147], v[192:195], v[60:63]
    buffer_load_dwordx4 v21, s[16:19], s72 offen offset:3072  lds
    v_mfma_f32_16x16x32_bf16 v[64:67], v[144:147], v[196:199], v[64:67]
    v_mfma_f32_16x16x32_bf16 v[84:87], v[148:151], v[196:199], v[84:87]
    v_mfma_f32_16x16x32_bf16 v[104:107], v[152:155], v[196:199], v[104:107]
    v_mfma_f32_16x16x32_bf16 v[124:127], v[156:159], v[196:199], v[124:127]
    s_waitcnt lgkmcnt(0)
    v_mfma_f32_16x16x32_bf16 v[48:51], v[128:131], v[160:163], v[48:51]
    s_xor_b32 s36, s1, 0
    s_mov_b32 m0, s30
    ds_read_b128 v[180:183], v9 offset:18432
    v_mfma_f32_16x16x32_bf16 v[68:71], v[132:135], v[160:163], v[68:71]
    buffer_load_dwordx4 v22, s[8:11], s36 offen offset:0  lds
    ds_read_b128 v[184:187], v9 offset:20480
    v_mfma_f32_16x16x32_bf16 v[88:91], v[136:139], v[160:163], v[88:91]
    ds_read_b128 v[188:191], v9 offset:22528
    ds_read_b128 v[192:195], v9 offset:24576
    v_mfma_f32_16x16x32_bf16 v[108:111], v[140:143], v[160:163], v[108:111]
    ds_read_b128 v[196:199], v9 offset:26624
    v_mfma_f32_16x16x32_bf16 v[112:115], v[140:143], v[164:167], v[112:115]
    v_mfma_f32_16x16x32_bf16 v[92:95], v[136:139], v[164:167], v[92:95]
    buffer_load_dwordx4 v23, s[8:11], s36 offen offset:1024  lds
    v_mfma_f32_16x16x32_bf16 v[72:75], v[132:135], v[164:167], v[72:75]
    v_mfma_f32_16x16x32_bf16 v[52:55], v[128:131], v[164:167], v[52:55]
    v_mfma_f32_16x16x32_bf16 v[56:59], v[128:131], v[168:171], v[56:59]
    v_mfma_f32_16x16x32_bf16 v[76:79], v[132:135], v[168:171], v[76:79]
    s_waitcnt vmcnt(10)
    ds_read_b64_tr_b16 v[144:145], v1 offset:12288
    ds_read_b64_tr_b16 v[146:147], v1 offset:14336
    v_mfma_f32_16x16x32_bf16 v[96:99], v[136:139], v[168:171], v[96:99]
    buffer_load_dwordx4 v24, s[8:11], s36 offen offset:2048  lds
    ds_read_b64_tr_b16 v[148:149], v2 offset:12288
    v_mfma_f32_16x16x32_bf16 v[116:119], v[140:143], v[168:171], v[116:119]
    ds_read_b64_tr_b16 v[150:151], v2 offset:14336
    ds_read_b64_tr_b16 v[152:153], v3 offset:12288
    v_mfma_f32_16x16x32_bf16 v[120:123], v[140:143], v[172:175], v[120:123]
    ds_read_b64_tr_b16 v[154:155], v3 offset:14336
    ds_read_b64_tr_b16 v[156:157], v4 offset:12288
    v_mfma_f32_16x16x32_bf16 v[100:103], v[136:139], v[172:175], v[100:103]
    ds_read_b64_tr_b16 v[158:159], v4 offset:14336
    v_mfma_f32_16x16x32_bf16 v[80:83], v[132:135], v[172:175], v[80:83]
    v_mfma_f32_16x16x32_bf16 v[60:63], v[128:131], v[172:175], v[60:63]
    buffer_load_dwordx4 v25, s[8:11], s36 offen offset:3072  lds
    v_mfma_f32_16x16x32_bf16 v[64:67], v[128:131], v[176:179], v[64:67]
    v_mfma_f32_16x16x32_bf16 v[84:87], v[132:135], v[176:179], v[84:87]
    v_mfma_f32_16x16x32_bf16 v[104:107], v[136:139], v[176:179], v[104:107]
    v_mfma_f32_16x16x32_bf16 v[124:127], v[140:143], v[176:179], v[124:127]
    s_waitcnt lgkmcnt(0)
    v_mfma_f32_16x16x32_bf16 v[48:51], v[144:147], v[180:183], v[48:51]
    s_xor_b32 s36, s1, 256
    s_mov_b32 m0, s31
    ds_read_b128 v[160:163], v8 offset:28672
    v_mfma_f32_16x16x32_bf16 v[68:71], v[148:151], v[180:183], v[68:71]
    buffer_load_dwordx4 v22, s[8:11], s36 offen offset:0  lds
    ds_read_b128 v[164:167], v8 offset:30720
    v_mfma_f32_16x16x32_bf16 v[88:91], v[152:155], v[180:183], v[88:91]
    ds_read_b128 v[168:171], v8 offset:32768
    ds_read_b128 v[172:175], v8 offset:34816
    v_mfma_f32_16x16x32_bf16 v[108:111], v[156:159], v[180:183], v[108:111]
    ds_read_b128 v[176:179], v8 offset:36864
    v_mfma_f32_16x16x32_bf16 v[112:115], v[156:159], v[184:187], v[112:115]
    v_mfma_f32_16x16x32_bf16 v[92:95], v[152:155], v[184:187], v[92:95]
    buffer_load_dwordx4 v23, s[8:11], s36 offen offset:1024  lds
    v_mfma_f32_16x16x32_bf16 v[72:75], v[148:151], v[184:187], v[72:75]
    v_mfma_f32_16x16x32_bf16 v[52:55], v[144:147], v[184:187], v[52:55]
    v_mfma_f32_16x16x32_bf16 v[56:59], v[144:147], v[188:191], v[56:59]
    v_mfma_f32_16x16x32_bf16 v[76:79], v[148:151], v[188:191], v[76:79]
    s_waitcnt vmcnt(10)
    ds_read_b64_tr_b16 v[128:129], v1 offset:0
    ds_read_b64_tr_b16 v[130:131], v1 offset:2048
    v_mfma_f32_16x16x32_bf16 v[96:99], v[152:155], v[188:191], v[96:99]
    buffer_load_dwordx4 v24, s[8:11], s36 offen offset:2048  lds
    ds_read_b64_tr_b16 v[132:133], v2 offset:0
    v_mfma_f32_16x16x32_bf16 v[116:119], v[156:159], v[188:191], v[116:119]
    ds_read_b64_tr_b16 v[134:135], v2 offset:2048
    ds_read_b64_tr_b16 v[136:137], v3 offset:0
    v_mfma_f32_16x16x32_bf16 v[120:123], v[156:159], v[192:195], v[120:123]
    ds_read_b64_tr_b16 v[138:139], v3 offset:2048
    ds_read_b64_tr_b16 v[140:141], v4 offset:0
    v_mfma_f32_16x16x32_bf16 v[100:103], v[152:155], v[192:195], v[100:103]
    ds_read_b64_tr_b16 v[142:143], v4 offset:2048
    v_mfma_f32_16x16x32_bf16 v[80:83], v[148:151], v[192:195], v[80:83]
    v_mfma_f32_16x16x32_bf16 v[60:63], v[144:147], v[192:195], v[60:63]
    buffer_load_dwordx4 v25, s[8:11], s36 offen offset:3072  lds
    v_mfma_f32_16x16x32_bf16 v[64:67], v[144:147], v[196:199], v[64:67]
    v_mfma_f32_16x16x32_bf16 v[84:87], v[148:151], v[196:199], v[84:87]
    v_mfma_f32_16x16x32_bf16 v[104:107], v[152:155], v[196:199], v[104:107]
    v_mfma_f32_16x16x32_bf16 v[124:127], v[156:159], v[196:199], v[124:127]
    s_waitcnt lgkmcnt(0)
    v_mfma_f32_16x16x32_bf16 v[48:51], v[128:131], v[160:163], v[48:51]
    s_xor_b32 s36, s1, 16384
    s_mov_b32 m0, s28
    ds_read_b128 v[180:183], v9 offset:28672
    v_mfma_f32_16x16x32_bf16 v[68:71], v[132:135], v[160:163], v[68:71]
    buffer_load_dwordx4 v22, s[8:11], s36 offen offset:0  lds
    ds_read_b128 v[184:187], v9 offset:30720
    v_mfma_f32_16x16x32_bf16 v[88:91], v[136:139], v[160:163], v[88:91]
    ds_read_b128 v[188:191], v9 offset:32768
    ds_read_b128 v[192:195], v9 offset:34816
    v_mfma_f32_16x16x32_bf16 v[108:111], v[140:143], v[160:163], v[108:111]
    ds_read_b128 v[196:199], v9 offset:36864
    v_mfma_f32_16x16x32_bf16 v[112:115], v[140:143], v[164:167], v[112:115]
    v_mfma_f32_16x16x32_bf16 v[92:95], v[136:139], v[164:167], v[92:95]
    buffer_load_dwordx4 v23, s[8:11], s36 offen offset:1024  lds
    v_mfma_f32_16x16x32_bf16 v[72:75], v[132:135], v[164:167], v[72:75]
    v_mfma_f32_16x16x32_bf16 v[52:55], v[128:131], v[164:167], v[52:55]
    v_mfma_f32_16x16x32_bf16 v[56:59], v[128:131], v[168:171], v[56:59]
    v_mfma_f32_16x16x32_bf16 v[76:79], v[132:135], v[168:171], v[76:79]
    s_waitcnt vmcnt(10)
    ds_read_b64_tr_b16 v[144:145], v1 offset:4096
    ds_read_b64_tr_b16 v[146:147], v1 offset:6144
    v_mfma_f32_16x16x32_bf16 v[96:99], v[136:139], v[168:171], v[96:99]
    buffer_load_dwordx4 v24, s[8:11], s36 offen offset:2048  lds
    ds_read_b64_tr_b16 v[148:149], v2 offset:4096
    v_mfma_f32_16x16x32_bf16 v[116:119], v[140:143], v[168:171], v[116:119]
    ds_read_b64_tr_b16 v[150:151], v2 offset:6144
    ds_read_b64_tr_b16 v[152:153], v3 offset:4096
    v_mfma_f32_16x16x32_bf16 v[120:123], v[140:143], v[172:175], v[120:123]
    ds_read_b64_tr_b16 v[154:155], v3 offset:6144
    ds_read_b64_tr_b16 v[156:157], v4 offset:4096
    v_mfma_f32_16x16x32_bf16 v[100:103], v[136:139], v[172:175], v[100:103]
    ds_read_b64_tr_b16 v[158:159], v4 offset:6144
    v_mfma_f32_16x16x32_bf16 v[80:83], v[132:135], v[172:175], v[80:83]
    v_mfma_f32_16x16x32_bf16 v[60:63], v[128:131], v[172:175], v[60:63]
    buffer_load_dwordx4 v25, s[8:11], s36 offen offset:3072  lds
    v_mfma_f32_16x16x32_bf16 v[64:67], v[128:131], v[176:179], v[64:67]
    v_mfma_f32_16x16x32_bf16 v[84:87], v[132:135], v[176:179], v[84:87]
    v_mfma_f32_16x16x32_bf16 v[104:107], v[136:139], v[176:179], v[104:107]
    v_mfma_f32_16x16x32_bf16 v[124:127], v[140:143], v[176:179], v[124:127]
    s_waitcnt lgkmcnt(0)
    v_mfma_f32_16x16x32_bf16 v[48:51], v[144:147], v[180:183], v[48:51]
    s_waitcnt vmcnt(8)
    s_xor_b32 s36, s1, 16640
    s_mov_b32 m0, s29
    v_mfma_f32_16x16x32_bf16 v[68:71], v[148:151], v[180:183], v[68:71]
    buffer_load_dwordx4 v22, s[8:11], s36 offen offset:0  lds
    ds_read_b128 a[160:163], v6 offset:8192
    v_mfma_f32_16x16x32_bf16 v[88:91], v[152:155], v[180:183], v[88:91]
    buffer_load_dwordx4 v23, s[8:11], s36 offen offset:1024  lds
    ds_read_b128 a[164:167], v7 offset:8192
    v_mfma_f32_16x16x32_bf16 v[108:111], v[156:159], v[180:183], v[108:111]
    buffer_load_dwordx4 v24, s[8:11], s36 offen offset:2048  lds
    ds_read_b128 a[168:171], v6 offset:10240
    v_mfma_f32_16x16x32_bf16 v[52:55], v[144:147], v[184:187], v[52:55]
    buffer_load_dwordx4 v25, s[8:11], s36 offen offset:3072  lds
    ds_read_b128 a[172:175], v7 offset:10240
    v_mfma_f32_16x16x32_bf16 v[72:75], v[148:151], v[184:187], v[72:75]
    s_waitcnt vmcnt(8)
    ds_read_b128 a[176:179], v6 offset:12288
    v_pk_mul_f32 v[48:49], v[48:49], s[74:75]
    v_mfma_f32_16x16x32_bf16 v[92:95], v[152:155], v[184:187], v[92:95]
    ds_read_b128 a[180:183], v7 offset:12288
    v_pk_mul_f32 v[50:51], v[50:51], s[74:75]
    v_mfma_f32_16x16x32_bf16 v[112:115], v[156:159], v[184:187], v[112:115]
    ds_read_b128 a[184:187], v6 offset:14336
    v_cvt_pk_bf16_f32 v200, v48, v49
    v_mfma_f32_16x16x32_bf16 v[56:59], v[144:147], v[188:191], v[56:59]
    ds_read_b128 a[188:191], v7 offset:14336
    s_xor_b32 s36, s1, 8192
    v_mfma_f32_16x16x32_bf16 v[76:79], v[148:151], v[188:191], v[76:79]
    s_mov_b32 m0, s30
    s_waitcnt lgkmcnt(4)
    buffer_load_dwordx4 v22, s[8:11], s36 offen offset:0  lds
    v_cvt_pk_bf16_f32 v201, v50, v51
    v_mfma_f32_16x16x32_bf16 v[96:99], v[152:155], v[188:191], v[96:99]
    buffer_load_dwordx4 v23, s[8:11], s36 offen offset:1024  lds
    ds_write_b64 v12, v[200:201] offset:0
    v_mfma_f32_16x16x32_bf16 v[116:119], v[156:159], v[188:191], v[116:119]
    buffer_load_dwordx4 v24, s[8:11], s36 offen offset:2048  lds
    v_pk_mul_f32 v[68:69], v[68:69], s[74:75]
    v_mfma_f32_16x16x32_bf16 v[60:63], v[144:147], v[192:195], v[60:63]
    buffer_load_dwordx4 v25, s[8:11], s36 offen offset:3072  lds
    s_waitcnt vmcnt(8)
    v_mfma_f32_16x16x32_bf16 v[80:83], v[148:151], v[192:195], v[80:83]
    ds_read_b128 a[192:195], v6 offset:0
    v_pk_mul_f32 v[70:71], v[70:71], s[74:75]
    v_mfma_f32_16x16x32_bf16 v[100:103], v[152:155], v[192:195], v[100:103]
    ds_read_b128 a[196:199], v7 offset:0
    v_cvt_pk_bf16_f32 v202, v68, v69
    v_mfma_f32_16x16x32_bf16 v[120:123], v[156:159], v[192:195], v[120:123]
    ds_read_b128 a[200:203], v6 offset:2048
    v_cvt_pk_bf16_f32 v203, v70, v71
    v_mfma_f32_16x16x32_bf16 v[64:67], v[144:147], v[196:199], v[64:67]
    ds_read_b128 a[204:207], v7 offset:2048
    s_xor_b32 s36, s1, 8448
    v_mfma_f32_16x16x32_bf16 v[84:87], v[148:151], v[196:199], v[84:87]
    s_mov_b32 m0, s31
    s_waitcnt lgkmcnt(5)
    buffer_load_dwordx4 v22, s[8:11], s36 offen offset:0  lds
    ds_write_b64 v12, v[202:203] offset:512
    v_mfma_f32_16x16x32_bf16 v[104:107], v[152:155], v[196:199], v[104:107]
    buffer_load_dwordx4 v23, s[8:11], s36 offen offset:1024  lds
    v_pk_mul_f32 v[88:89], v[88:89], s[74:75]
    v_mfma_f32_16x16x32_bf16 v[124:127], v[156:159], v[196:199], v[124:127]
    buffer_load_dwordx4 v24, s[8:11], s36 offen offset:2048  lds
    v_pk_mul_f32 v[90:91], v[90:91], s[74:75]
    buffer_load_dwordx4 v25, s[8:11], s36 offen offset:3072  lds
    v_cvt_pk_bf16_f32 v204, v88, v89
    v_cvt_pk_bf16_f32 v205, v90, v91
    ds_write_b64 v12, v[204:205] offset:5120
    v_pk_mul_f32 v[108:109], v[108:109], s[74:75]
    v_pk_mul_f32 v[110:111], v[110:111], s[74:75]
    v_cvt_pk_bf16_f32 v206, v108, v109
    v_cvt_pk_bf16_f32 v207, v110, v111
    ds_write_b64 v12, v[206:207] offset:5632
    v_pk_mul_f32 v[52:53], v[52:53], s[74:75]
    v_pk_mul_f32 v[54:55], v[54:55], s[74:75]
    v_cvt_pk_bf16_f32 v208, v52, v53
    v_cvt_pk_bf16_f32 v209, v54, v55
    ds_write_b64 v12, v[208:209] offset:1024
    v_pk_mul_f32 v[72:73], v[72:73], s[74:75]
    v_pk_mul_f32 v[74:75], v[74:75], s[74:75]
    v_cvt_pk_bf16_f32 v210, v72, v73
    v_cvt_pk_bf16_f32 v211, v74, v75
    ds_write_b64 v12, v[210:211] offset:1536
    v_pk_mul_f32 v[92:93], v[92:93], s[74:75]
    v_pk_mul_f32 v[94:95], v[94:95], s[74:75]
    v_cvt_pk_bf16_f32 v212, v92, v93
    v_cvt_pk_bf16_f32 v213, v94, v95
    ds_write_b64 v12, v[212:213] offset:6144
    v_pk_mul_f32 v[112:113], v[112:113], s[74:75]
    v_pk_mul_f32 v[114:115], v[114:115], s[74:75]
    v_cvt_pk_bf16_f32 v214, v112, v113
    v_cvt_pk_bf16_f32 v215, v114, v115
    ds_write_b64 v12, v[214:215] offset:6656
    v_pk_mul_f32 v[56:57], v[56:57], s[74:75]
    v_pk_mul_f32 v[58:59], v[58:59], s[74:75]
    v_cvt_pk_bf16_f32 v200, v56, v57
    v_cvt_pk_bf16_f32 v201, v58, v59
    ds_write_b64 v12, v[200:201] offset:2048
    v_pk_mul_f32 v[76:77], v[76:77], s[74:75]
    v_pk_mul_f32 v[78:79], v[78:79], s[74:75]
    v_cvt_pk_bf16_f32 v202, v76, v77
    v_cvt_pk_bf16_f32 v203, v78, v79
    ds_write_b64 v12, v[202:203] offset:2560
    v_pk_mul_f32 v[96:97], v[96:97], s[74:75]
    v_pk_mul_f32 v[98:99], v[98:99], s[74:75]
    v_cvt_pk_bf16_f32 v204, v96, v97
    v_cvt_pk_bf16_f32 v205, v98, v99
    ds_write_b64 v12, v[204:205] offset:7168
    v_pk_mul_f32 v[116:117], v[116:117], s[74:75]
    v_pk_mul_f32 v[118:119], v[118:119], s[74:75]
    v_cvt_pk_bf16_f32 v206, v116, v117
    v_cvt_pk_bf16_f32 v207, v118, v119
    ds_write_b64 v12, v[206:207] offset:7680
    v_pk_mul_f32 v[60:61], v[60:61], s[74:75]
    v_pk_mul_f32 v[62:63], v[62:63], s[74:75]
    v_cvt_pk_bf16_f32 v208, v60, v61
    v_cvt_pk_bf16_f32 v209, v62, v63
    ds_write_b64 v12, v[208:209] offset:3072
    v_pk_mul_f32 v[80:81], v[80:81], s[74:75]
    v_pk_mul_f32 v[82:83], v[82:83], s[74:75]
    v_cvt_pk_bf16_f32 v210, v80, v81
    v_cvt_pk_bf16_f32 v211, v82, v83
    ds_write_b64 v12, v[210:211] offset:3584
    v_pk_mul_f32 v[100:101], v[100:101], s[74:75]
    v_pk_mul_f32 v[102:103], v[102:103], s[74:75]
    v_cvt_pk_bf16_f32 v212, v100, v101
    v_cvt_pk_bf16_f32 v213, v102, v103
    ds_write_b64 v12, v[212:213] offset:8192
    v_pk_mul_f32 v[120:121], v[120:121], s[74:75]
    v_pk_mul_f32 v[122:123], v[122:123], s[74:75]
    v_cvt_pk_bf16_f32 v214, v120, v121
    v_cvt_pk_bf16_f32 v215, v122, v123
    ds_write_b64 v12, v[214:215] offset:8704
    v_pk_mul_f32 v[64:65], v[64:65], s[74:75]
    v_pk_mul_f32 v[66:67], v[66:67], s[74:75]
    v_cvt_pk_bf16_f32 v200, v64, v65
    v_cvt_pk_bf16_f32 v201, v66, v67
    ds_write_b64 v12, v[200:201] offset:4096
    v_pk_mul_f32 v[84:85], v[84:85], s[74:75]
    v_pk_mul_f32 v[86:87], v[86:87], s[74:75]
    v_cvt_pk_bf16_f32 v202, v84, v85
    v_cvt_pk_bf16_f32 v203, v86, v87
    ds_write_b64 v12, v[202:203] offset:4608
    v_pk_mul_f32 v[104:105], v[104:105], s[74:75]
    v_pk_mul_f32 v[106:107], v[106:107], s[74:75]
    v_cvt_pk_bf16_f32 v204, v104, v105
    v_cvt_pk_bf16_f32 v205, v106, v107
    ds_write_b64 v12, v[204:205] offset:9216
    v_pk_mul_f32 v[124:125], v[124:125], s[74:75]
    v_pk_mul_f32 v[126:127], v[126:127], s[74:75]
    v_cvt_pk_bf16_f32 v206, v124, v125
    v_cvt_pk_bf16_f32 v207, v126, v127
    ds_write_b64 v12, v[206:207] offset:9728
    s_xor_b32 s36, s1, 24576
    s_mov_b32 m0, s28
    s_waitcnt lgkmcnt(14)
    buffer_load_dwordx4 v22, s[8:11], s36 offen offset:0  lds
    buffer_load_dwordx4 v23, s[8:11], s36 offen offset:1024  lds
    buffer_load_dwordx4 v24, s[8:11], s36 offen offset:2048  lds
    buffer_load_dwordx4 v25, s[8:11], s36 offen offset:3072  lds
    s_waitcnt vmcnt(12)
    ds_read_b128 a[208:211], v6 offset:4096
    ds_read_b128 a[212:215], v7 offset:4096
    ds_read_b128 a[216:219], v6 offset:6144
    ds_read_b128 a[220:223], v7 offset:6144
    s_waitcnt lgkmcnt(0)
    s_barrier
    ds_read_b128 a[0:3], v10 offset:0
    ds_read_b128 a[20:23], v10 offset:5120
    ds_read_b128 a[40:43], v10 offset:10240
    ds_read_b128 a[60:63], v10 offset:15360
    ds_read_b128 a[4:7], v10 offset:1024
    ds_read_b128 a[24:27], v10 offset:6144
    ds_read_b128 a[44:47], v10 offset:11264
    ds_read_b128 a[64:67], v10 offset:16384
    ds_read_b128 a[8:11], v10 offset:2048
    ds_read_b128 a[28:31], v10 offset:7168
    s_waitcnt lgkmcnt(9)
    v_mfma_f32_16x16x32_bf16 v[48:51], a[160:163], a[0:3], 0
    s_xor_b32 s36, s1, 24832
    s_mov_b32 m0, s29
    ds_read_b128 a[48:51], v10 offset:12288
    s_waitcnt lgkmcnt(9)
    v_mfma_f32_16x16x32_bf16 v[48:51], a[164:167], a[20:23], v[48:51]
    ds_read_b128 a[68:71], v10 offset:17408
    buffer_load_dwordx4 v22, s[8:11], s36 offen offset:0  lds
    s_waitcnt lgkmcnt(9)
    v_mfma_f32_16x16x32_bf16 v[48:51], a[168:171], a[40:43], v[48:51]
    ds_read_b128 a[12:15], v10 offset:3072
    ds_read_b128 a[32:35], v10 offset:8192
    s_waitcnt lgkmcnt(10)
    v_mfma_f32_16x16x32_bf16 v[48:51], a[172:175], a[60:63], v[48:51]
    ds_read_b128 a[52:55], v10 offset:13312
    ds_read_b128 a[72:75], v10 offset:18432
    s_waitcnt lgkmcnt(11)
    v_mfma_f32_16x16x32_bf16 v[52:55], a[160:163], a[4:7], 0
    ds_read_b128 a[16:19], v10 offset:4096
    ds_read_b128 a[36:39], v10 offset:9216
    s_waitcnt lgkmcnt(12)
    v_mfma_f32_16x16x32_bf16 v[52:55], a[164:167], a[24:27], v[52:55]
    ds_read_b128 a[56:59], v10 offset:14336
    buffer_load_dwordx4 v23, s[8:11], s36 offen offset:1024  lds
    s_waitcnt lgkmcnt(12)
    v_mfma_f32_16x16x32_bf16 v[52:55], a[168:171], a[44:47], v[52:55]
    ds_read_b128 a[76:79], v10 offset:19456
    ds_read_b128 a[80:83], v10 offset:20480
    s_waitcnt lgkmcnt(13)
    v_mfma_f32_16x16x32_bf16 v[52:55], a[172:175], a[64:67], v[52:55]
    ds_read_b128 a[100:103], v10 offset:25600
    ds_read_b128 a[120:123], v10 offset:30720
    s_waitcnt lgkmcnt(14)
    v_mfma_f32_16x16x32_bf16 v[56:59], a[160:163], a[8:11], 0
    ds_read_b128 a[140:143], v10 offset:35840
    ds_read_b128 a[84:87], v10 offset:21504
    s_waitcnt lgkmcnt(14)
    v_mfma_f32_16x16x32_bf16 v[56:59], a[164:167], a[28:31], v[56:59]
    ds_read_b128 a[104:107], v10 offset:26624
    ds_read_b128 a[124:127], v10 offset:31744
    v_mfma_f32_16x16x32_bf16 v[56:59], a[168:171], a[48:51], v[56:59]
    ds_read_b128 a[144:147], v10 offset:36864
    buffer_load_dwordx4 v24, s[8:11], s36 offen offset:2048  lds
    s_waitcnt lgkmcnt(14)
    v_mfma_f32_16x16x32_bf16 v[56:59], a[172:175], a[68:71], v[56:59]
    ds_read_b128 a[88:91], v10 offset:22528
    ds_read_b128 a[108:111], v10 offset:27648
    v_mfma_f32_16x16x32_bf16 v[60:63], a[160:163], a[12:15], 0
    v_mfma_f32_16x16x32_bf16 v[60:63], a[164:167], a[32:35], v[60:63]
    s_waitcnt lgkmcnt(14)
    v_mfma_f32_16x16x32_bf16 v[60:63], a[168:171], a[52:55], v[60:63]
    v_mfma_f32_16x16x32_bf16 v[60:63], a[172:175], a[72:75], v[60:63]
    buffer_load_dwordx4 v25, s[8:11], s36 offen offset:3072  lds
    s_waitcnt lgkmcnt(13)
    v_mfma_f32_16x16x32_bf16 v[64:67], a[160:163], a[16:19], 0
    s_waitcnt lgkmcnt(12)
    v_mfma_f32_16x16x32_bf16 v[64:67], a[164:167], a[36:39], v[64:67]
    s_waitcnt lgkmcnt(11)
    v_mfma_f32_16x16x32_bf16 v[64:67], a[168:171], a[56:59], v[64:67]
    s_waitcnt lgkmcnt(10)
    v_mfma_f32_16x16x32_bf16 v[64:67], a[172:175], a[76:79], v[64:67]
    s_waitcnt lgkmcnt(9)
    v_mfma_f32_16x16x32_bf16 v[48:51], a[176:179], a[80:83], v[48:51]
    ds_read_b128 a[128:131], v10 offset:32768
    ds_read_b128 a[148:151], v10 offset:37888
    s_waitcnt lgkmcnt(10)
    v_mfma_f32_16x16x32_bf16 v[48:51], a[180:183], a[100:103], v[48:51]
    ds_read_b128 a[92:95], v10 offset:23552
    ds_read_b128 a[112:115], v10 offset:28672
    s_waitcnt lgkmcnt(11)
    v_mfma_f32_16x16x32_bf16 v[48:51], a[184:187], a[120:123], v[48:51]
    ds_read_b128 a[132:135], v10 offset:33792
    ds_read_b128 a[152:155], v10 offset:38912
    s_waitcnt lgkmcnt(12)
    v_mfma_f32_16x16x32_bf16 v[48:51], a[188:191], a[140:143], v[48:51]
    ds_read_b128 a[96:99], v10 offset:24576
    ds_read_b128 a[116:119], v10 offset:29696
    s_waitcnt lgkmcnt(13)
    v_mfma_f32_16x16x32_bf16 v[52:55], a[176:179], a[84:87], v[52:55]
    ds_read_b128 a[136:139], v10 offset:34816
    ds_read_b128 a[156:159], v10 offset:39936
    s_waitcnt lgkmcnt(14)
    v_mfma_f32_16x16x32_bf16 v[52:55], a[180:183], a[104:107], v[52:55]
    s_waitcnt lgkmcnt(13)
    v_mfma_f32_16x16x32_bf16 v[52:55], a[184:187], a[124:127], v[52:55]
    s_waitcnt lgkmcnt(12)
    v_mfma_f32_16x16x32_bf16 v[52:55], a[188:191], a[144:147], v[52:55]
    v_exp_f32 v48, v48
    s_waitcnt lgkmcnt(11)
    v_mfma_f32_16x16x32_bf16 v[56:59], a[176:179], a[88:91], v[56:59]
    v_exp_f32 v49, v49
    s_waitcnt lgkmcnt(10)
    v_mfma_f32_16x16x32_bf16 v[56:59], a[180:183], a[108:111], v[56:59]
    v_exp_f32 v50, v50
    s_waitcnt lgkmcnt(9)
    v_mfma_f32_16x16x32_bf16 v[56:59], a[184:187], a[128:131], v[56:59]
    v_exp_f32 v51, v51
    v_cvt_pk_bf16_f32 v108, v48, v49
    s_waitcnt lgkmcnt(8)
    v_mfma_f32_16x16x32_bf16 v[56:59], a[188:191], a[148:151], v[56:59]
    v_cvt_pk_bf16_f32 v109, v50, v51
    s_waitcnt lgkmcnt(7)
    v_mfma_f32_16x16x32_bf16 v[60:63], a[176:179], a[92:95], v[60:63]
    s_waitcnt vmcnt(12)
    ds_read_b128 v[128:131], v6 offset:8192
    ds_read_b128 v[132:135], v7 offset:8192
    s_waitcnt lgkmcnt(8)
    v_mfma_f32_16x16x32_bf16 v[60:63], a[180:183], a[112:115], v[60:63]
    ds_read_b128 v[136:139], v6 offset:10240
    ds_read_b128 v[140:143], v7 offset:10240
    s_waitcnt lgkmcnt(9)
    v_mfma_f32_16x16x32_bf16 v[60:63], a[184:187], a[132:135], v[60:63]
    v_exp_f32 v52, v52
    s_waitcnt lgkmcnt(8)
    v_mfma_f32_16x16x32_bf16 v[60:63], a[188:191], a[152:155], v[60:63]
    v_exp_f32 v53, v53
    s_waitcnt lgkmcnt(7)
    v_mfma_f32_16x16x32_bf16 v[64:67], a[176:179], a[96:99], v[64:67]
    v_exp_f32 v54, v54
    s_waitcnt lgkmcnt(6)
    v_mfma_f32_16x16x32_bf16 v[64:67], a[180:183], a[116:119], v[64:67]
    v_exp_f32 v55, v55
    v_cvt_pk_bf16_f32 v112, v52, v53
    s_waitcnt lgkmcnt(5)
    v_mfma_f32_16x16x32_bf16 v[64:67], a[184:187], a[136:139], v[64:67]
    v_cvt_pk_bf16_f32 v113, v54, v55
    s_waitcnt lgkmcnt(4)
    v_mfma_f32_16x16x32_bf16 v[64:67], a[188:191], a[156:159], v[64:67]
    v_exp_f32 v56, v56
    s_waitcnt lgkmcnt(0)
    v_mfma_f32_16x16x32_bf16 v[68:71], v[128:131], a[0:3], 0
    s_xor_b32 s36, s1, 32768
    s_mov_b32 m0, s30
    v_mfma_f32_16x16x32_bf16 v[68:71], v[132:135], a[20:23], v[68:71]
    buffer_load_dwordx4 v22, s[8:11], s36 offen offset:0  lds
    v_mfma_f32_16x16x32_bf16 v[68:71], v[136:139], a[40:43], v[68:71]
    v_exp_f32 v57, v57
    v_mfma_f32_16x16x32_bf16 v[68:71], v[140:143], a[60:63], v[68:71]
    v_exp_f32 v58, v58
    v_mfma_f32_16x16x32_bf16 v[72:75], v[128:131], a[4:7], 0
    v_exp_f32 v59, v59
    v_mfma_f32_16x16x32_bf16 v[72:75], v[132:135], a[24:27], v[72:75]
    buffer_load_dwordx4 v23, s[8:11], s36 offen offset:1024  lds
    v_cvt_pk_bf16_f32 v116, v56, v57
    v_mfma_f32_16x16x32_bf16 v[72:75], v[136:139], a[44:47], v[72:75]
    v_cvt_pk_bf16_f32 v117, v58, v59
    v_mfma_f32_16x16x32_bf16 v[72:75], v[140:143], a[64:67], v[72:75]
    v_exp_f32 v60, v60
    v_mfma_f32_16x16x32_bf16 v[76:79], v[128:131], a[8:11], 0
    v_exp_f32 v61, v61
    v_mfma_f32_16x16x32_bf16 v[76:79], v[132:135], a[28:31], v[76:79]
    v_exp_f32 v62, v62
    v_mfma_f32_16x16x32_bf16 v[76:79], v[136:139], a[48:51], v[76:79]
    buffer_load_dwordx4 v24, s[8:11], s36 offen offset:2048  lds
    v_mfma_f32_16x16x32_bf16 v[76:79], v[140:143], a[68:71], v[76:79]
    v_exp_f32 v63, v63
    v_mfma_f32_16x16x32_bf16 v[80:83], v[128:131], a[12:15], 0
    s_waitcnt vmcnt(11)
    ds_read_b128 v[144:147], v6 offset:12288
    v_cvt_pk_bf16_f32 v120, v60, v61
    v_mfma_f32_16x16x32_bf16 v[80:83], v[132:135], a[32:35], v[80:83]
    ds_read_b128 v[148:151], v7 offset:12288
    v_cvt_pk_bf16_f32 v121, v62, v63
    v_mfma_f32_16x16x32_bf16 v[80:83], v[136:139], a[52:55], v[80:83]
    ds_read_b128 v[152:155], v6 offset:14336
    ds_read_b128 v[156:159], v7 offset:14336
    v_mfma_f32_16x16x32_bf16 v[80:83], v[140:143], a[72:75], v[80:83]
    buffer_load_dwordx4 v25, s[8:11], s36 offen offset:3072  lds
    v_mfma_f32_16x16x32_bf16 v[84:87], v[128:131], a[16:19], 0
    v_exp_f32 v64, v64
    v_mfma_f32_16x16x32_bf16 v[84:87], v[132:135], a[36:39], v[84:87]
    v_exp_f32 v65, v65
    v_mfma_f32_16x16x32_bf16 v[84:87], v[136:139], a[56:59], v[84:87]
    v_exp_f32 v66, v66
    v_mfma_f32_16x16x32_bf16 v[84:87], v[140:143], a[76:79], v[84:87]
    v_exp_f32 v67, v67
    s_waitcnt lgkmcnt(0)
    v_mfma_f32_16x16x32_bf16 v[68:71], v[144:147], a[80:83], v[68:71]
    s_xor_b32 s36, s1, 33024
    s_mov_b32 m0, s31
    v_cvt_pk_bf16_f32 v124, v64, v65
    v_mfma_f32_16x16x32_bf16 v[68:71], v[148:151], a[100:103], v[68:71]
    buffer_load_dwordx4 v22, s[8:11], s36 offen offset:0  lds
    v_cvt_pk_bf16_f32 v125, v66, v67
    v_mfma_f32_16x16x32_bf16 v[68:71], v[152:155], a[120:123], v[68:71]
    v_mfma_f32_16x16x32_bf16 v[68:71], v[156:159], a[140:143], v[68:71]
    v_mfma_f32_16x16x32_bf16 v[72:75], v[144:147], a[84:87], v[72:75]
    v_mfma_f32_16x16x32_bf16 v[72:75], v[148:151], a[104:107], v[72:75]
    buffer_load_dwordx4 v23, s[8:11], s36 offen offset:1024  lds
    v_mfma_f32_16x16x32_bf16 v[72:75], v[152:155], a[124:127], v[72:75]
    v_mfma_f32_16x16x32_bf16 v[72:75], v[156:159], a[144:147], v[72:75]
    s_nop 2
    v_exp_f32 v68, v68
    v_mfma_f32_16x16x32_bf16 v[76:79], v[144:147], a[88:91], v[76:79]
    v_exp_f32 v69, v69
    v_mfma_f32_16x16x32_bf16 v[76:79], v[148:151], a[108:111], v[76:79]
    v_exp_f32 v70, v70
    v_mfma_f32_16x16x32_bf16 v[76:79], v[152:155], a[128:131], v[76:79]
    buffer_load_dwordx4 v24, s[8:11], s36 offen offset:2048  lds
    v_mfma_f32_16x16x32_bf16 v[76:79], v[156:159], a[148:151], v[76:79]
    v_exp_f32 v71, v71
    v_mfma_f32_16x16x32_bf16 v[80:83], v[144:147], a[92:95], v[80:83]
    v_cvt_pk_bf16_f32 v110, v68, v69
    v_cvt_pk_bf16_f32 v111, v70, v71
    v_mfma_f32_16x16x32_bf16 v[80:83], v[148:151], a[112:115], v[80:83]
    v_exp_f32 v72, v72
    v_mfma_f32_16x16x32_bf16 v[80:83], v[152:155], a[132:135], v[80:83]
    v_exp_f32 v73, v73
    v_mfma_f32_16x16x32_bf16 v[80:83], v[156:159], a[152:155], v[80:83]
    buffer_load_dwordx4 v25, s[8:11], s36 offen offset:3072  lds
    v_mfma_f32_16x16x32_bf16 v[84:87], v[144:147], a[96:99], v[84:87]
    v_mfma_f32_16x16x32_bf16 v[88:91], v[44:47], v[108:111], 0
    ds_write_b128 v16, v[108:111] offset:0
    v_mfma_f32_16x16x32_bf16 v[84:87], v[148:151], a[116:119], v[84:87]
    v_exp_f32 v74, v74
    v_mfma_f32_16x16x32_bf16 v[84:87], v[152:155], a[136:139], v[84:87]
    v_exp_f32 v75, v75
    v_mfma_f32_16x16x32_bf16 v[84:87], v[156:159], a[156:159], v[84:87]
    v_cvt_pk_bf16_f32 v114, v72, v73
    v_cvt_pk_bf16_f32 v115, v74, v75
    v_mfma_f32_16x16x32_bf16 v[48:51], a[192:195], a[0:3], 0
    v_exp_f32 v76, v76
    v_mfma_f32_16x16x32_bf16 v[48:51], a[196:199], a[20:23], v[48:51]
    v_exp_f32 v77, v77
    v_mfma_f32_16x16x32_bf16 v[48:51], a[200:203], a[40:43], v[48:51]
    v_mfma_f32_16x16x32_bf16 v[92:95], v[44:47], v[112:115], 0
    ds_write_b128 v16, v[112:115] offset:1024
    v_mfma_f32_16x16x32_bf16 v[48:51], a[204:207], a[60:63], v[48:51]
    v_exp_f32 v78, v78
    v_mfma_f32_16x16x32_bf16 v[52:55], a[192:195], a[4:7], 0
    v_exp_f32 v79, v79
    v_mfma_f32_16x16x32_bf16 v[52:55], a[196:199], a[24:27], v[52:55]
    v_cvt_pk_bf16_f32 v118, v76, v77
    v_cvt_pk_bf16_f32 v119, v78, v79
    v_mfma_f32_16x16x32_bf16 v[52:55], a[200:203], a[44:47], v[52:55]
    v_exp_f32 v80, v80
    v_mfma_f32_16x16x32_bf16 v[52:55], a[204:207], a[64:67], v[52:55]
    v_exp_f32 v81, v81
    v_mfma_f32_16x16x32_bf16 v[56:59], a[192:195], a[8:11], 0
    v_mfma_f32_16x16x32_bf16 v[96:99], v[44:47], v[116:119], 0
    ds_write_b128 v16, v[116:119] offset:2048
    v_mfma_f32_16x16x32_bf16 v[56:59], a[196:199], a[28:31], v[56:59]
    v_exp_f32 v82, v82
    v_mfma_f32_16x16x32_bf16 v[56:59], a[200:203], a[48:51], v[56:59]
    v_exp_f32 v83, v83
    v_mfma_f32_16x16x32_bf16 v[56:59], a[204:207], a[68:71], v[56:59]
    v_cvt_pk_bf16_f32 v122, v80, v81
    v_cvt_pk_bf16_f32 v123, v82, v83
    v_mfma_f32_16x16x32_bf16 v[60:63], a[192:195], a[12:15], 0
    v_exp_f32 v84, v84
    v_mfma_f32_16x16x32_bf16 v[60:63], a[196:199], a[32:35], v[60:63]
    v_exp_f32 v85, v85
    v_mfma_f32_16x16x32_bf16 v[60:63], a[200:203], a[52:55], v[60:63]
    v_mfma_f32_16x16x32_bf16 v[100:103], v[44:47], v[120:123], 0
    ds_write_b128 v16, v[120:123] offset:3072
    v_mfma_f32_16x16x32_bf16 v[60:63], a[204:207], a[72:75], v[60:63]
    v_exp_f32 v86, v86
    v_mfma_f32_16x16x32_bf16 v[64:67], a[192:195], a[16:19], 0
    v_exp_f32 v87, v87
    v_mfma_f32_16x16x32_bf16 v[64:67], a[196:199], a[36:39], v[64:67]
    v_cvt_pk_bf16_f32 v126, v84, v85
    v_cvt_pk_bf16_f32 v127, v86, v87
    v_mfma_f32_16x16x32_bf16 v[64:67], a[200:203], a[56:59], v[64:67]
    s_nop 0
    v_mfma_f32_16x16x32_bf16 v[104:107], v[44:47], v[124:127], 0
    ds_write_b128 v16, v[124:127] offset:4096
    v_mfma_f32_16x16x32_bf16 v[64:67], a[204:207], a[76:79], v[64:67]
    v_mfma_f32_16x16x32_bf16 v[48:51], a[208:211], a[80:83], v[48:51]
    v_mfma_f32_16x16x32_bf16 v[48:51], a[212:215], a[100:103], v[48:51]
    v_mfma_f32_16x16x32_bf16 v[48:51], a[216:219], a[120:123], v[48:51]
    v_mfma_f32_16x16x32_bf16 v[48:51], a[220:223], a[140:143], v[48:51]
    v_mfma_f32_16x16x32_bf16 v[52:55], a[208:211], a[84:87], v[52:55]
    v_mfma_f32_16x16x32_bf16 v[52:55], a[212:215], a[104:107], v[52:55]
    v_mfma_f32_16x16x32_bf16 v[52:55], a[216:219], a[124:127], v[52:55]
    v_mfma_f32_16x16x32_bf16 v[52:55], a[220:223], a[144:147], v[52:55]
    s_nop 3
    v_exp_f32 v48, v48
    v_mfma_f32_16x16x32_bf16 v[56:59], a[208:211], a[88:91], v[56:59]
    v_exp_f32 v49, v49
    v_mfma_f32_16x16x32_bf16 v[56:59], a[212:215], a[108:111], v[56:59]
    v_exp_f32 v50, v50
    v_mfma_f32_16x16x32_bf16 v[56:59], a[216:219], a[128:131], v[56:59]
    v_exp_f32 v51, v51
    v_mfma_f32_16x16x32_bf16 v[56:59], a[220:223], a[148:151], v[56:59]
    v_cvt_pk_bf16_f32 v108, v48, v49
    v_cvt_pk_bf16_f32 v109, v50, v51
    v_mfma_f32_16x16x32_bf16 v[60:63], a[208:211], a[92:95], v[60:63]
    s_waitcnt vmcnt(12)
    ds_read_b128 v[128:131], v6 offset:0
    ds_read_b128 v[132:135], v7 offset:0
    v_mfma_f32_16x16x32_bf16 v[60:63], a[212:215], a[112:115], v[60:63]
    ds_read_b128 v[136:139], v6 offset:2048
    ds_read_b128 v[140:143], v7 offset:2048
    v_mfma_f32_16x16x32_bf16 v[60:63], a[216:219], a[132:135], v[60:63]
    v_exp_f32 v52, v52
    v_mfma_f32_16x16x32_bf16 v[60:63], a[220:223], a[152:155], v[60:63]
    v_exp_f32 v53, v53
    v_mfma_f32_16x16x32_bf16 v[64:67], a[208:211], a[96:99], v[64:67]
    v_exp_f32 v54, v54
    v_mfma_f32_16x16x32_bf16 v[64:67], a[212:215], a[116:119], v[64:67]
    v_exp_f32 v55, v55
    v_mfma_f32_16x16x32_bf16 v[64:67], a[216:219], a[136:139], v[64:67]
    v_cvt_pk_bf16_f32 v112, v52, v53
    v_cvt_pk_bf16_f32 v113, v54, v55
    v_mfma_f32_16x16x32_bf16 v[64:67], a[220:223], a[156:159], v[64:67]
    v_exp_f32 v56, v56
    s_waitcnt lgkmcnt(0)
    v_mfma_f32_16x16x32_bf16 v[68:71], v[128:131], a[0:3], 0
    s_xor_b32 s36, s1, 40960
    s_mov_b32 m0, s28
    v_mfma_f32_16x16x32_bf16 v[68:71], v[132:135], a[20:23], v[68:71]
    buffer_load_dwordx4 v22, s[8:11], s36 offen offset:0  lds
    v_mfma_f32_16x16x32_bf16 v[68:71], v[136:139], a[40:43], v[68:71]
    v_exp_f32 v57, v57
    v_mfma_f32_16x16x32_bf16 v[68:71], v[140:143], a[60:63], v[68:71]
    v_exp_f32 v58, v58
    v_mfma_f32_16x16x32_bf16 v[72:75], v[128:131], a[4:7], 0
    v_exp_f32 v59, v59
    v_mfma_f32_16x16x32_bf16 v[72:75], v[132:135], a[24:27], v[72:75]
    buffer_load_dwordx4 v23, s[8:11], s36 offen offset:1024  lds
    v_cvt_pk_bf16_f32 v116, v56, v57
    v_mfma_f32_16x16x32_bf16 v[72:75], v[136:139], a[44:47], v[72:75]
    v_cvt_pk_bf16_f32 v117, v58, v59
    v_mfma_f32_16x16x32_bf16 v[72:75], v[140:143], a[64:67], v[72:75]
    v_exp_f32 v60, v60
    v_mfma_f32_16x16x32_bf16 v[76:79], v[128:131], a[8:11], 0
    v_exp_f32 v61, v61
    v_mfma_f32_16x16x32_bf16 v[76:79], v[132:135], a[28:31], v[76:79]
    v_exp_f32 v62, v62
    v_mfma_f32_16x16x32_bf16 v[76:79], v[136:139], a[48:51], v[76:79]
    buffer_load_dwordx4 v24, s[8:11], s36 offen offset:2048  lds
    v_mfma_f32_16x16x32_bf16 v[76:79], v[140:143], a[68:71], v[76:79]
    v_exp_f32 v63, v63
    v_mfma_f32_16x16x32_bf16 v[80:83], v[128:131], a[12:15], 0
    s_waitcnt vmcnt(11)
    ds_read_b128 v[144:147], v6 offset:4096
    v_cvt_pk_bf16_f32 v120, v60, v61
    v_mfma_f32_16x16x32_bf16 v[80:83], v[132:135], a[32:35], v[80:83]
    ds_read_b128 v[148:151], v7 offset:4096
    v_cvt_pk_bf16_f32 v121, v62, v63
    v_mfma_f32_16x16x32_bf16 v[80:83], v[136:139], a[52:55], v[80:83]
    ds_read_b128 v[152:155], v6 offset:6144
    ds_read_b128 v[156:159], v7 offset:6144
    v_mfma_f32_16x16x32_bf16 v[80:83], v[140:143], a[72:75], v[80:83]
    buffer_load_dwordx4 v25, s[8:11], s36 offen offset:3072  lds
    v_mfma_f32_16x16x32_bf16 v[84:87], v[128:131], a[16:19], 0
    v_exp_f32 v64, v64
    v_mfma_f32_16x16x32_bf16 v[84:87], v[132:135], a[36:39], v[84:87]
    v_exp_f32 v65, v65
    v_mfma_f32_16x16x32_bf16 v[84:87], v[136:139], a[56:59], v[84:87]
    v_exp_f32 v66, v66
    v_mfma_f32_16x16x32_bf16 v[84:87], v[140:143], a[76:79], v[84:87]
    v_exp_f32 v67, v67
    s_waitcnt lgkmcnt(0)
    v_mfma_f32_16x16x32_bf16 v[68:71], v[144:147], a[80:83], v[68:71]
    s_barrier
    s_xor_b32 s36, s1, 41216
    s_mov_b32 m0, s29
    v_mfma_f32_16x16x32_bf16 v[68:71], v[148:151], a[100:103], v[68:71]
    buffer_load_dwordx4 v22, s[8:11], s36 offen offset:0  lds
    v_cvt_pk_bf16_f32 v124, v64, v65
    v_mfma_f32_16x16x32_bf16 v[68:71], v[152:155], a[120:123], v[68:71]
    v_cvt_pk_bf16_f32 v125, v66, v67
    v_mfma_f32_16x16x32_bf16 v[68:71], v[156:159], a[140:143], v[68:71]
    v_mfma_f32_16x16x32_bf16 v[72:75], v[144:147], a[84:87], v[72:75]
    v_mfma_f32_16x16x32_bf16 v[72:75], v[148:151], a[104:107], v[72:75]
    buffer_load_dwordx4 v23, s[8:11], s36 offen offset:1024  lds
    v_mfma_f32_16x16x32_bf16 v[72:75], v[152:155], a[124:127], v[72:75]
    v_mfma_f32_16x16x32_bf16 v[72:75], v[156:159], a[144:147], v[72:75]
    s_nop 2
    v_exp_f32 v68, v68
    v_mfma_f32_16x16x32_bf16 v[76:79], v[144:147], a[88:91], v[76:79]
    v_exp_f32 v69, v69
    v_mfma_f32_16x16x32_bf16 v[76:79], v[148:151], a[108:111], v[76:79]
    v_exp_f32 v70, v70
    v_mfma_f32_16x16x32_bf16 v[76:79], v[152:155], a[128:131], v[76:79]
    buffer_load_dwordx4 v24, s[8:11], s36 offen offset:2048  lds
    v_mfma_f32_16x16x32_bf16 v[76:79], v[156:159], a[148:151], v[76:79]
    v_exp_f32 v71, v71
    v_mfma_f32_16x16x32_bf16 v[80:83], v[144:147], a[92:95], v[80:83]
    s_waitcnt vmcnt(11)
    ds_read_b128 v[128:131], v6 offset:8192
    v_cvt_pk_bf16_f32 v110, v68, v69
    v_mfma_f32_16x16x32_bf16 v[80:83], v[148:151], a[112:115], v[80:83]
    ds_read_b128 v[132:135], v7 offset:8192
    v_cvt_pk_bf16_f32 v111, v70, v71
    v_mfma_f32_16x16x32_bf16 v[80:83], v[152:155], a[132:135], v[80:83]
    ds_read_b128 v[136:139], v6 offset:10240
    ds_read_b128 v[140:143], v7 offset:10240
    v_mfma_f32_16x16x32_bf16 v[80:83], v[156:159], a[152:155], v[80:83]
    buffer_load_dwordx4 v25, s[8:11], s36 offen offset:3072  lds
    v_mfma_f32_16x16x32_bf16 v[84:87], v[144:147], a[96:99], v[84:87]
    v_exp_f32 v72, v72
    v_mfma_f32_16x16x32_bf16 v[84:87], v[148:151], a[116:119], v[84:87]
    v_exp_f32 v73, v73
    v_mfma_f32_16x16x32_bf16 v[84:87], v[152:155], a[136:139], v[84:87]
    v_mfma_f32_16x16x32_bf16 v[88:91], v[44:47], v[108:111], v[88:91]
    ds_write_b128 v16, v[108:111] offset:20480
    v_mfma_f32_16x16x32_bf16 v[84:87], v[156:159], a[156:159], v[84:87]
    v_exp_f32 v74, v74
    s_waitcnt lgkmcnt(1)
    v_mfma_f32_16x16x32_bf16 v[48:51], v[128:131], a[0:3], 0
    v_exp_f32 v75, v75
    v_mfma_f32_16x16x32_bf16 v[48:51], v[132:135], a[20:23], v[48:51]
    v_mov_b32 v253, 0
    global_load_dword v250, v253, s[48:49] sc1
    v_mfma_f32_16x16x32_bf16 v[48:51], v[136:139], a[40:43], v[48:51]
    v_cvt_pk_bf16_f32 v114, v72, v73
    v_cvt_pk_bf16_f32 v115, v74, v75
    v_mfma_f32_16x16x32_bf16 v[48:51], v[140:143], a[60:63], v[48:51]
    s_xor_b32 s36, s1, 49152
    s_mov_b32 m0, s30
    v_mfma_f32_16x16x32_bf16 v[52:55], v[128:131], a[4:7], 0
    buffer_load_dwordx4 v22, s[8:11], s36 offen offset:0  lds
    v_mfma_f32_16x16x32_bf16 v[52:55], v[132:135], a[24:27], v[52:55]
    v_exp_f32 v76, v76
    v_mfma_f32_16x16x32_bf16 v[52:55], v[136:139], a[44:47], v[52:55]
    v_exp_f32 v77, v77
    v_mfma_f32_16x16x32_bf16 v[52:55], v[140:143], a[64:67], v[52:55]
    v_mfma_f32_16x16x32_bf16 v[92:95], v[44:47], v[112:115], v[92:95]
    ds_write_b128 v16, v[112:115] offset:21504
    v_mfma_f32_16x16x32_bf16 v[56:59], v[128:131], a[8:11], 0
    buffer_load_dwordx4 v23, s[8:11], s36 offen offset:1024  lds
    v_mfma_f32_16x16x32_bf16 v[56:59], v[132:135], a[28:31], v[56:59]
    v_exp_f32 v78, v78
    v_mfma_f32_16x16x32_bf16 v[56:59], v[136:139], a[48:51], v[56:59]
    v_exp_f32 v79, v79
    v_mfma_f32_16x16x32_bf16 v[56:59], v[140:143], a[68:71], v[56:59]
    v_cvt_pk_bf16_f32 v118, v76, v77
    v_cvt_pk_bf16_f32 v119, v78, v79
    v_mfma_f32_16x16x32_bf16 v[60:63], v[128:131], a[12:15], 0
    s_waitcnt vmcnt(11)
    buffer_load_dwordx4 v24, s[8:11], s36 offen offset:2048  lds
    ds_read_b128 v[144:147], v6 offset:12288
    v_mfma_f32_16x16x32_bf16 v[60:63], v[132:135], a[32:35], v[60:63]
    ds_read_b128 v[148:151], v7 offset:12288
    ds_read_b128 v[152:155], v6 offset:14336
    v_mfma_f32_16x16x32_bf16 v[60:63], v[136:139], a[52:55], v[60:63]
    ds_read_b128 v[156:159], v7 offset:14336
    v_mfma_f32_16x16x32_bf16 v[60:63], v[140:143], a[72:75], v[60:63]
    v_exp_f32 v80, v80
    v_mfma_f32_16x16x32_bf16 v[64:67], v[128:131], a[16:19], 0
    buffer_load_dwordx4 v25, s[8:11], s36 offen offset:3072  lds
    v_mfma_f32_16x16x32_bf16 v[64:67], v[132:135], a[36:39], v[64:67]
    v_exp_f32 v81, v81
    v_mfma_f32_16x16x32_bf16 v[64:67], v[136:139], a[56:59], v[64:67]
    v_mfma_f32_16x16x32_bf16 v[96:99], v[44:47], v[116:119], v[96:99]
    ds_write_b128 v16, v[116:119] offset:22528
    v_mfma_f32_16x16x32_bf16 v[64:67], v[140:143], a[76:79], v[64:67]
    v_exp_f32 v82, v82
    s_waitcnt lgkmcnt(1)
    v_mfma_f32_16x16x32_bf16 v[48:51], v[144:147], a[80:83], v[48:51]
    s_xor_b32 s36, s1, 49408
    s_mov_b32 m0, s31
    v_mfma_f32_16x16x32_bf16 v[48:51], v[148:151], a[100:103], v[48:51]
    buffer_load_dwordx4 v22, s[8:11], s36 offen offset:0  lds
    v_mfma_f32_16x16x32_bf16 v[48:51], v[152:155], a[120:123], v[48:51]
    v_exp_f32 v83, v83
    v_mfma_f32_16x16x32_bf16 v[48:51], v[156:159], a[140:143], v[48:51]
    v_cvt_pk_bf16_f32 v122, v80, v81
    v_cvt_pk_bf16_f32 v123, v82, v83
    v_mfma_f32_16x16x32_bf16 v[52:55], v[144:147], a[84:87], v[52:55]
    v_exp_f32 v84, v84
    v_mfma_f32_16x16x32_bf16 v[52:55], v[148:151], a[104:107], v[52:55]
    buffer_load_dwordx4 v23, s[8:11], s36 offen offset:1024  lds
    v_mfma_f32_16x16x32_bf16 v[52:55], v[152:155], a[124:127], v[52:55]
    v_exp_f32 v85, v85
    v_mfma_f32_16x16x32_bf16 v[52:55], v[156:159], a[144:147], v[52:55]
    v_mfma_f32_16x16x32_bf16 v[100:103], v[44:47], v[120:123], v[100:103]
    ds_write_b128 v16, v[120:123] offset:23552
    v_mfma_f32_16x16x32_bf16 v[56:59], v[144:147], a[88:91], v[56:59]
    v_exp_f32 v86, v86
    v_mfma_f32_16x16x32_bf16 v[56:59], v[148:151], a[108:111], v[56:59]
    v_exp_f32 v87, v87
    v_mfma_f32_16x16x32_bf16 v[56:59], v[152:155], a[128:131], v[56:59]
    buffer_load_dwordx4 v24, s[8:11], s36 offen offset:2048  lds
    v_cvt_pk_bf16_f32 v126, v84, v85
    v_mfma_f32_16x16x32_bf16 v[56:59], v[156:159], a[148:151], v[56:59]
    v_cvt_pk_bf16_f32 v127, v86, v87
    v_mfma_f32_16x16x32_bf16 v[60:63], v[144:147], a[92:95], v[60:63]
    s_waitcnt vmcnt(12)
    ds_read_b128 v[128:131], v6 offset:0
    ds_read_b128 v[132:135], v7 offset:0
    v_mfma_f32_16x16x32_bf16 v[60:63], v[148:151], a[112:115], v[60:63]
    ds_read_b128 v[136:139], v6 offset:2048
    ds_read_b128 v[140:143], v7 offset:2048
    v_mfma_f32_16x16x32_bf16 v[60:63], v[152:155], a[132:135], v[60:63]
    v_mfma_f32_16x16x32_bf16 v[104:107], v[44:47], v[124:127], v[104:107]
    ds_write_b128 v16, v[124:127] offset:24576
    v_mfma_f32_16x16x32_bf16 v[60:63], v[156:159], a[152:155], v[60:63]
    buffer_load_dwordx4 v25, s[8:11], s36 offen offset:3072  lds
    v_mfma_f32_16x16x32_bf16 v[64:67], v[144:147], a[96:99], v[64:67]
    v_exp_f32 v48, v48
    v_mfma_f32_16x16x32_bf16 v[64:67], v[148:151], a[116:119], v[64:67]
    v_exp_f32 v49, v49
    v_mfma_f32_16x16x32_bf16 v[64:67], v[152:155], a[136:139], v[64:67]
    v_exp_f32 v50, v50
    v_mfma_f32_16x16x32_bf16 v[64:67], v[156:159], a[156:159], v[64:67]
    v_exp_f32 v51, v51
    s_waitcnt lgkmcnt(1)
    v_mfma_f32_16x16x32_bf16 v[68:71], v[128:131], a[0:3], 0
    s_xor_b32 s36, s1, 57344
    s_mov_b32 m0, s28
    v_cvt_pk_bf16_f32 v108, v48, v49
    v_mfma_f32_16x16x32_bf16 v[68:71], v[132:135], a[20:23], v[68:71]
    buffer_load_dwordx4 v22, s[8:11], s36 offen offset:0  lds
    v_cvt_pk_bf16_f32 v109, v50, v51
    v_mfma_f32_16x16x32_bf16 v[68:71], v[136:139], a[40:43], v[68:71]
    v_exp_f32 v52, v52
    v_mfma_f32_16x16x32_bf16 v[68:71], v[140:143], a[60:63], v[68:71]
    v_exp_f32 v53, v53
    v_mfma_f32_16x16x32_bf16 v[72:75], v[128:131], a[4:7], 0
    v_exp_f32 v54, v54
    v_mfma_f32_16x16x32_bf16 v[72:75], v[132:135], a[24:27], v[72:75]
    buffer_load_dwordx4 v23, s[8:11], s36 offen offset:1024  lds
    v_mfma_f32_16x16x32_bf16 v[72:75], v[136:139], a[44:47], v[72:75]
    v_exp_f32 v55, v55
    v_mfma_f32_16x16x32_bf16 v[72:75], v[140:143], a[64:67], v[72:75]
    v_cvt_pk_bf16_f32 v112, v52, v53
    v_cvt_pk_bf16_f32 v113, v54, v55
    v_mfma_f32_16x16x32_bf16 v[76:79], v[128:131], a[8:11], 0
    v_exp_f32 v56, v56
    v_mfma_f32_16x16x32_bf16 v[76:79], v[132:135], a[28:31], v[76:79]
    v_exp_f32 v57, v57
    v_mfma_f32_16x16x32_bf16 v[76:79], v[136:139], a[48:51], v[76:79]
    buffer_load_dwordx4 v24, s[8:11], s36 offen offset:2048  lds
    v_mfma_f32_16x16x32_bf16 v[76:79], v[140:143], a[68:71], v[76:79]
    v_exp_f32 v58, v58
    v_mfma_f32_16x16x32_bf16 v[80:83], v[128:131], a[12:15], 0
    s_waitcnt vmcnt(12)
    ds_read_b128 v[144:147], v6 offset:4096
    ds_read_b128 v[148:151], v7 offset:4096
    v_mfma_f32_16x16x32_bf16 v[80:83], v[132:135], a[32:35], v[80:83]
    ds_read_b128 v[152:155], v6 offset:6144
    ds_read_b128 v[156:159], v7 offset:6144
    v_mfma_f32_16x16x32_bf16 v[80:83], v[136:139], a[52:55], v[80:83]
    v_exp_f32 v59, v59
    v_mfma_f32_16x16x32_bf16 v[80:83], v[140:143], a[72:75], v[80:83]
    buffer_load_dwordx4 v25, s[8:11], s36 offen offset:3072  lds
    v_cvt_pk_bf16_f32 v116, v56, v57
    v_mfma_f32_16x16x32_bf16 v[84:87], v[128:131], a[16:19], 0
    v_cvt_pk_bf16_f32 v117, v58, v59
    v_mfma_f32_16x16x32_bf16 v[84:87], v[132:135], a[36:39], v[84:87]
    v_exp_f32 v60, v60
    v_mfma_f32_16x16x32_bf16 v[84:87], v[136:139], a[56:59], v[84:87]
    v_exp_f32 v61, v61
    v_mfma_f32_16x16x32_bf16 v[84:87], v[140:143], a[76:79], v[84:87]
    v_exp_f32 v62, v62
    s_waitcnt lgkmcnt(0)
    v_mfma_f32_16x16x32_bf16 v[68:71], v[144:147], a[80:83], v[68:71]
    s_xor_b32 s36, s1, 57600
    s_mov_b32 m0, s29
    v_mfma_f32_16x16x32_bf16 v[68:71], v[148:151], a[100:103], v[68:71]
    buffer_load_dwordx4 v22, s[8:11], s36 offen offset:0  lds
    v_mfma_f32_16x16x32_bf16 v[68:71], v[152:155], a[120:123], v[68:71]
    v_exp_f32 v63, v63
    v_mfma_f32_16x16x32_bf16 v[68:71], v[156:159], a[140:143], v[68:71]
    v_cvt_pk_bf16_f32 v120, v60, v61
    v_cvt_pk_bf16_f32 v121, v62, v63
    v_mfma_f32_16x16x32_bf16 v[72:75], v[144:147], a[84:87], v[72:75]
    v_exp_f32 v64, v64
    v_mfma_f32_16x16x32_bf16 v[72:75], v[148:151], a[104:107], v[72:75]
    buffer_load_dwordx4 v23, s[8:11], s36 offen offset:1024  lds
    v_mfma_f32_16x16x32_bf16 v[72:75], v[152:155], a[124:127], v[72:75]
    v_exp_f32 v65, v65
    v_mfma_f32_16x16x32_bf16 v[72:75], v[156:159], a[144:147], v[72:75]
    v_exp_f32 v66, v66
    v_mfma_f32_16x16x32_bf16 v[76:79], v[144:147], a[88:91], v[76:79]
    v_exp_f32 v67, v67
    v_mfma_f32_16x16x32_bf16 v[76:79], v[148:151], a[108:111], v[76:79]
    v_cvt_pk_bf16_f32 v124, v64, v65
    v_cvt_pk_bf16_f32 v125, v66, v67
    v_mfma_f32_16x16x32_bf16 v[76:79], v[152:155], a[128:131], v[76:79]
    buffer_load_dwordx4 v24, s[8:11], s36 offen offset:2048  lds
    v_mfma_f32_16x16x32_bf16 v[76:79], v[156:159], a[148:151], v[76:79]
    v_exp_f32 v68, v68
    v_mfma_f32_16x16x32_bf16 v[80:83], v[144:147], a[92:95], v[80:83]
    s_waitcnt vmcnt(11)
    ds_read_b128 v[128:131], v6 offset:8192
    ds_read_b128 v[132:135], v7 offset:8192
    v_mfma_f32_16x16x32_bf16 v[80:83], v[148:151], a[112:115], v[80:83]
    ds_read_b128 v[136:139], v6 offset:10240
    ds_read_b128 v[140:143], v7 offset:10240
    v_mfma_f32_16x16x32_bf16 v[80:83], v[152:155], a[132:135], v[80:83]
    v_exp_f32 v69, v69
    v_mfma_f32_16x16x32_bf16 v[80:83], v[156:159], a[152:155], v[80:83]
    buffer_load_dwordx4 v25, s[8:11], s36 offen offset:3072  lds
    v_mfma_f32_16x16x32_bf16 v[84:87], v[144:147], a[96:99], v[84:87]
    v_exp_f32 v70, v70
    v_mfma_f32_16x16x32_bf16 v[84:87], v[148:151], a[116:119], v[84:87]
    v_exp_f32 v71, v71
    v_mfma_f32_16x16x32_bf16 v[84:87], v[152:155], a[136:139], v[84:87]
    v_cvt_pk_bf16_f32 v110, v68, v69
    v_cvt_pk_bf16_f32 v111, v70, v71
    v_mfma_f32_16x16x32_bf16 v[84:87], v[156:159], a[156:159], v[84:87]
    v_exp_f32 v72, v72
    s_waitcnt lgkmcnt(0)
    v_mfma_f32_16x16x32_bf16 v[48:51], v[128:131], a[0:3], 0
    s_xor_b32 s36, s0, 32768
    s_mov_b32 m0, s30
    v_mfma_f32_16x16x32_bf16 v[48:51], v[132:135], a[20:23], v[48:51]
    buffer_load_dwordx4 v26, s[12:15], s36 offen offset:0  lds
    v_mfma_f32_16x16x32_bf16 v[48:51], v[136:139], a[40:43], v[48:51]
    v_exp_f32 v73, v73
    v_mfma_f32_16x16x32_bf16 v[48:51], v[140:143], a[60:63], v[48:51]
    v_mfma_f32_16x16x32_bf16 v[88:91], v[44:47], v[108:111], v[88:91]
    ds_write_b128 v15, v[108:111] offset:0
    v_mfma_f32_16x16x32_bf16 v[52:55], v[128:131], a[4:7], 0
    v_exp_f32 v74, v74
    v_mfma_f32_16x16x32_bf16 v[52:55], v[132:135], a[24:27], v[52:55]
    buffer_load_dwordx4 v27, s[12:15], s36 offen offset:1024  lds
    v_mfma_f32_16x16x32_bf16 v[52:55], v[136:139], a[44:47], v[52:55]
    v_exp_f32 v75, v75
    v_mfma_f32_16x16x32_bf16 v[52:55], v[140:143], a[64:67], v[52:55]
    v_cvt_pk_bf16_f32 v114, v72, v73
    v_cvt_pk_bf16_f32 v115, v74, v75
    v_mfma_f32_16x16x32_bf16 v[56:59], v[128:131], a[8:11], 0
    v_exp_f32 v76, v76
    v_mfma_f32_16x16x32_bf16 v[56:59], v[132:135], a[28:31], v[56:59]
    v_exp_f32 v77, v77
    v_mfma_f32_16x16x32_bf16 v[56:59], v[136:139], a[48:51], v[56:59]
    buffer_load_dwordx4 v28, s[12:15], s36 offen offset:2048  lds
    v_mfma_f32_16x16x32_bf16 v[56:59], v[140:143], a[68:71], v[56:59]
    v_mfma_f32_16x16x32_bf16 v[92:95], v[44:47], v[112:115], v[92:95]
    ds_write_b128 v15, v[112:115] offset:1024
    v_mfma_f32_16x16x32_bf16 v[60:63], v[128:131], a[12:15], 0
    s_waitcnt vmcnt(11)
    ds_read_b128 v[144:147], v6 offset:12288
    ds_read_b128 v[148:151], v7 offset:12288
    v_mfma_f32_16x16x32_bf16 v[60:63], v[132:135], a[32:35], v[60:63]
    ds_read_b128 v[152:155], v6 offset:14336
    ds_read_b128 v[156:159], v7 offset:14336
    v_mfma_f32_16x16x32_bf16 v[60:63], v[136:139], a[52:55], v[60:63]
    v_exp_f32 v78, v78
    v_mfma_f32_16x16x32_bf16 v[60:63], v[140:143], a[72:75], v[60:63]
    buffer_load_dwordx4 v29, s[12:15], s36 offen offset:3072  lds
    v_mfma_f32_16x16x32_bf16 v[64:67], v[128:131], a[16:19], 0
    v_exp_f32 v79, v79
    v_mfma_f32_16x16x32_bf16 v[64:67], v[132:135], a[36:39], v[64:67]
    v_cvt_pk_bf16_f32 v118, v76, v77
    v_cvt_pk_bf16_f32 v119, v78, v79
    v_mfma_f32_16x16x32_bf16 v[64:67], v[136:139], a[56:59], v[64:67]
    v_exp_f32 v80, v80
    v_mfma_f32_16x16x32_bf16 v[64:67], v[140:143], a[76:79], v[64:67]
    v_exp_f32 v81, v81
    s_waitcnt lgkmcnt(0)
    v_mfma_f32_16x16x32_bf16 v[48:51], v[144:147], a[80:83], v[48:51]
    s_xor_b32 s36, s0, 98304
    s_mov_b32 m0, s31
    v_mfma_f32_16x16x32_bf16 v[48:51], v[148:151], a[100:103], v[48:51]
    buffer_load_dwordx4 v26, s[12:15], s36 offen offset:0  lds
    v_mfma_f32_16x16x32_bf16 v[48:51], v[152:155], a[120:123], v[48:51]
    v_mfma_f32_16x16x32_bf16 v[96:99], v[44:47], v[116:119], v[96:99]
    ds_write_b128 v15, v[116:119] offset:2048
    v_mfma_f32_16x16x32_bf16 v[48:51], v[156:159], a[140:143], v[48:51]
    v_exp_f32 v82, v82
    v_mfma_f32_16x16x32_bf16 v[52:55], v[144:147], a[84:87], v[52:55]
    v_exp_f32 v83, v83
    v_mfma_f32_16x16x32_bf16 v[52:55], v[148:151], a[104:107], v[52:55]
    buffer_load_dwordx4 v27, s[12:15], s36 offen offset:1024  lds
    v_cvt_pk_bf16_f32 v122, v80, v81
    v_mfma_f32_16x16x32_bf16 v[52:55], v[152:155], a[124:127], v[52:55]
    v_cvt_pk_bf16_f32 v123, v82, v83
    v_mfma_f32_16x16x32_bf16 v[52:55], v[156:159], a[144:147], v[52:55]
    v_exp_f32 v84, v84
    v_mfma_f32_16x16x32_bf16 v[56:59], v[144:147], a[88:91], v[56:59]
    v_exp_f32 v85, v85
    v_mfma_f32_16x16x32_bf16 v[56:59], v[148:151], a[108:111], v[56:59]
    v_mfma_f32_16x16x32_bf16 v[100:103], v[44:47], v[120:123], v[100:103]
    ds_write_b128 v15, v[120:123] offset:3072
    v_mfma_f32_16x16x32_bf16 v[56:59], v[152:155], a[128:131], v[56:59]
    buffer_load_dwordx4 v28, s[12:15], s36 offen offset:2048  lds
    v_mfma_f32_16x16x32_bf16 v[56:59], v[156:159], a[148:151], v[56:59]
    v_exp_f32 v86, v86
    v_mfma_f32_16x16x32_bf16 v[60:63], v[144:147], a[92:95], v[60:63]
    s_waitcnt vmcnt(11)
    ds_read_b128 v[128:131], v6 offset:0
    ds_read_b128 v[132:135], v7 offset:0
    v_mfma_f32_16x16x32_bf16 v[60:63], v[148:151], a[112:115], v[60:63]
    ds_read_b128 v[136:139], v6 offset:2048
    ds_read_b128 v[140:143], v7 offset:2048
    v_mfma_f32_16x16x32_bf16 v[60:63], v[152:155], a[132:135], v[60:63]
    v_exp_f32 v87, v87
    v_mfma_f32_16x16x32_bf16 v[60:63], v[156:159], a[152:155], v[60:63]
    buffer_load_dwordx4 v29, s[12:15], s36 offen offset:3072  lds
    v_cvt_pk_bf16_f32 v126, v84, v85
    v_mfma_f32_16x16x32_bf16 v[64:67], v[144:147], a[96:99], v[64:67]
    v_cvt_pk_bf16_f32 v127, v86, v87
    v_mfma_f32_16x16x32_bf16 v[64:67], v[148:151], a[116:119], v[64:67]
    s_nop 0
    v_mfma_f32_16x16x32_bf16 v[104:107], v[44:47], v[124:127], v[104:107]
    ds_write_b128 v15, v[124:127] offset:4096
    v_mfma_f32_16x16x32_bf16 v[64:67], v[152:155], a[136:139], v[64:67]
    v_exp_f32 v48, v48
    v_mfma_f32_16x16x32_bf16 v[64:67], v[156:159], a[156:159], v[64:67]
    v_exp_f32 v49, v49
    s_waitcnt lgkmcnt(1)
    v_mfma_f32_16x16x32_bf16 v[68:71], v[128:131], a[0:3], 0
    s_xor_b32 s36, s0, 163840
    s_mov_b32 m0, s28
    v_mfma_f32_16x16x32_bf16 v[68:71], v[132:135], a[20:23], v[68:71]
    buffer_load_dwordx4 v26, s[12:15], s36 offen offset:0  lds
    v_mfma_f32_16x16x32_bf16 v[68:71], v[136:139], a[40:43], v[68:71]
    v_exp_f32 v50, v50
    v_mfma_f32_16x16x32_bf16 v[68:71], v[140:143], a[60:63], v[68:71]
    v_exp_f32 v51, v51
    v_mfma_f32_16x16x32_bf16 v[72:75], v[128:131], a[4:7], 0
    v_cvt_pk_bf16_f32 v108, v48, v49
    v_cvt_pk_bf16_f32 v109, v50, v51
    v_mfma_f32_16x16x32_bf16 v[72:75], v[132:135], a[24:27], v[72:75]
    buffer_load_dwordx4 v27, s[12:15], s36 offen offset:1024  lds
    v_mfma_f32_16x16x32_bf16 v[72:75], v[136:139], a[44:47], v[72:75]
    v_exp_f32 v52, v52
    v_mfma_f32_16x16x32_bf16 v[72:75], v[140:143], a[64:67], v[72:75]
    v_exp_f32 v53, v53
    v_mfma_f32_16x16x32_bf16 v[76:79], v[128:131], a[8:11], 0
    v_exp_f32 v54, v54
    v_mfma_f32_16x16x32_bf16 v[76:79], v[132:135], a[28:31], v[76:79]
    v_exp_f32 v55, v55
    v_mfma_f32_16x16x32_bf16 v[76:79], v[136:139], a[48:51], v[76:79]
    buffer_load_dwordx4 v28, s[12:15], s36 offen offset:2048  lds
    v_cvt_pk_bf16_f32 v112, v52, v53
    v_mfma_f32_16x16x32_bf16 v[76:79], v[140:143], a[68:71], v[76:79]
    v_cvt_pk_bf16_f32 v113, v54, v55
    v_mfma_f32_16x16x32_bf16 v[80:83], v[128:131], a[12:15], 0
    s_waitcnt vmcnt(11)
    ds_read_b128 v[144:147], v6 offset:4096
    ds_read_b128 v[148:151], v7 offset:4096
    v_mfma_f32_16x16x32_bf16 v[80:83], v[132:135], a[32:35], v[80:83]
    ds_read_b128 v[152:155], v6 offset:6144
    ds_read_b128 v[156:159], v7 offset:6144
    v_mfma_f32_16x16x32_bf16 v[80:83], v[136:139], a[52:55], v[80:83]
    v_exp_f32 v56, v56
    v_mfma_f32_16x16x32_bf16 v[80:83], v[140:143], a[72:75], v[80:83]
    buffer_load_dwordx4 v29, s[12:15], s36 offen offset:3072  lds
    v_mfma_f32_16x16x32_bf16 v[84:87], v[128:131], a[16:19], 0
    v_exp_f32 v57, v57
    v_mfma_f32_16x16x32_bf16 v[84:87], v[132:135], a[36:39], v[84:87]
    v_exp_f32 v58, v58
    v_mfma_f32_16x16x32_bf16 v[84:87], v[136:139], a[56:59], v[84:87]
    v_exp_f32 v59, v59
    v_mfma_f32_16x16x32_bf16 v[84:87], v[140:143], a[76:79], v[84:87]
    v_cvt_pk_bf16_f32 v116, v56, v57
    v_cvt_pk_bf16_f32 v117, v58, v59
    s_waitcnt lgkmcnt(0)
    v_mfma_f32_16x16x32_bf16 v[68:71], v[144:147], a[80:83], v[68:71]
    s_xor_b32 s36, s0, 229376
    s_mov_b32 m0, s29
    v_mfma_f32_16x16x32_bf16 v[68:71], v[148:151], a[100:103], v[68:71]
    buffer_load_dwordx4 v26, s[12:15], s36 offen offset:0  lds
    v_mfma_f32_16x16x32_bf16 v[68:71], v[152:155], a[120:123], v[68:71]
    v_exp_f32 v60, v60
    v_mfma_f32_16x16x32_bf16 v[68:71], v[156:159], a[140:143], v[68:71]
    v_exp_f32 v61, v61
    v_mfma_f32_16x16x32_bf16 v[72:75], v[144:147], a[84:87], v[72:75]
    v_exp_f32 v62, v62
    v_mfma_f32_16x16x32_bf16 v[72:75], v[148:151], a[104:107], v[72:75]
    buffer_load_dwordx4 v27, s[12:15], s36 offen offset:1024  lds
    v_mfma_f32_16x16x32_bf16 v[72:75], v[152:155], a[124:127], v[72:75]
    v_exp_f32 v63, v63
    v_mfma_f32_16x16x32_bf16 v[72:75], v[156:159], a[144:147], v[72:75]
    v_cvt_pk_bf16_f32 v120, v60, v61
    v_cvt_pk_bf16_f32 v121, v62, v63
    v_mfma_f32_16x16x32_bf16 v[76:79], v[144:147], a[88:91], v[76:79]
    v_exp_f32 v64, v64
    v_mfma_f32_16x16x32_bf16 v[76:79], v[148:151], a[108:111], v[76:79]
    s_waitcnt vmcnt(10)
    ds_read_b64_tr_b16 v[128:129], v1 offset:8192
    ds_read_b64_tr_b16 v[130:131], v1 offset:10240
    v_mfma_f32_16x16x32_bf16 v[76:79], v[152:155], a[128:131], v[76:79]
    buffer_load_dwordx4 v28, s[12:15], s36 offen offset:2048  lds
    ds_read_b64_tr_b16 v[132:133], v2 offset:8192
    v_mfma_f32_16x16x32_bf16 v[76:79], v[156:159], a[148:151], v[76:79]
    ds_read_b64_tr_b16 v[134:135], v2 offset:10240
    ds_read_b64_tr_b16 v[136:137], v3 offset:8192
    v_mfma_f32_16x16x32_bf16 v[80:83], v[144:147], a[92:95], v[80:83]
    ds_read_b64_tr_b16 v[138:139], v3 offset:10240
    ds_read_b64_tr_b16 v[140:141], v4 offset:8192
    v_mfma_f32_16x16x32_bf16 v[80:83], v[148:151], a[112:115], v[80:83]
    ds_read_b64_tr_b16 v[142:143], v4 offset:10240
    v_mfma_f32_16x16x32_bf16 v[80:83], v[152:155], a[132:135], v[80:83]
    v_exp_f32 v65, v65
    v_mfma_f32_16x16x32_bf16 v[80:83], v[156:159], a[152:155], v[80:83]
    buffer_load_dwordx4 v29, s[12:15], s36 offen offset:3072  lds
    v_mfma_f32_16x16x32_bf16 v[84:87], v[144:147], a[96:99], v[84:87]
    v_exp_f32 v66, v66
    v_mfma_f32_16x16x32_bf16 v[84:87], v[148:151], a[116:119], v[84:87]
    v_exp_f32 v67, v67
    v_mfma_f32_16x16x32_bf16 v[84:87], v[152:155], a[136:139], v[84:87]
    v_cvt_pk_bf16_f32 v124, v64, v65
    v_cvt_pk_bf16_f32 v125, v66, v67
    v_mfma_f32_16x16x32_bf16 v[84:87], v[156:159], a[156:159], v[84:87]
    v_exp_f32 v68, v68
    s_xor_b32 s36, s0, 49152
    s_mov_b32 m0, s30
    v_exp_f32 v69, v69
    v_exp_f32 v70, v70
    v_exp_f32 v71, v71
    v_cvt_pk_bf16_f32 v110, v68, v69
    s_waitcnt vmcnt(8)
    ds_read_b64_tr_b16 v[144:145], v1 offset:12288
    ds_read_b64_tr_b16 v[146:147], v1 offset:14336
    ds_read_b64_tr_b16 v[148:149], v2 offset:12288
    ds_read_b64_tr_b16 v[150:151], v2 offset:14336
    s_waitcnt lgkmcnt(4)
    buffer_load_dwordx4 v26, s[12:15], s36 offen offset:0  lds
    ds_read_b64_tr_b16 v[152:153], v3 offset:12288
    ds_read_b64_tr_b16 v[154:155], v3 offset:14336
    ds_read_b64_tr_b16 v[156:157], v4 offset:12288
    ds_read_b64_tr_b16 v[158:159], v4 offset:14336
    v_cvt_pk_bf16_f32 v111, v70, v71
    v_exp_f32 v72, v72
    v_exp_f32 v73, v73
    v_mfma_f32_16x16x32_bf16 v[88:91], v[44:47], v[108:111], v[88:91]
    ds_write_b128 v15, v[108:111] offset:20480
    buffer_load_dwordx4 v27, s[12:15], s36 offen offset:1024  lds
    v_exp_f32 v74, v74
    v_exp_f32 v75, v75
    v_cvt_pk_bf16_f32 v114, v72, v73
    v_cvt_pk_bf16_f32 v115, v74, v75
    v_exp_f32 v76, v76
    v_exp_f32 v77, v77
    v_mfma_f32_16x16x32_bf16 v[92:95], v[44:47], v[112:115], v[92:95]
    ds_write_b128 v15, v[112:115] offset:21504
    v_exp_f32 v78, v78
    v_exp_f32 v79, v79
    buffer_load_dwordx4 v28, s[12:15], s36 offen offset:2048  lds
    v_cvt_pk_bf16_f32 v118, v76, v77
    v_cvt_pk_bf16_f32 v119, v78, v79
    v_exp_f32 v80, v80
    v_exp_f32 v81, v81
    v_mfma_f32_16x16x32_bf16 v[96:99], v[44:47], v[116:119], v[96:99]
    ds_write_b128 v15, v[116:119] offset:22528
    v_exp_f32 v82, v82
    v_exp_f32 v83, v83
    v_cvt_pk_bf16_f32 v122, v80, v81
    v_cvt_pk_bf16_f32 v123, v82, v83
    buffer_load_dwordx4 v29, s[12:15], s36 offen offset:3072  lds
    v_exp_f32 v84, v84
    v_exp_f32 v85, v85
    v_mfma_f32_16x16x32_bf16 v[100:103], v[44:47], v[120:123], v[100:103]
    ds_write_b128 v15, v[120:123] offset:23552
    v_exp_f32 v86, v86
    v_exp_f32 v87, v87
    v_cvt_pk_bf16_f32 v126, v84, v85
    v_cvt_pk_bf16_f32 v127, v86, v87
    s_nop 1
    v_mfma_f32_16x16x32_bf16 v[104:107], v[44:47], v[124:127], v[104:107]
    ds_write_b128 v15, v[124:127] offset:24576
    ds_write_b32 v13, v88 offset:0
    ds_write_b32 v13, v92 offset:256
    ds_write_b32 v13, v96 offset:512
    ds_write_b32 v13, v100 offset:768
    s_nop 2
    ds_write_b32 v13, v104 offset:1024
    v_cmp_eq_u32 vcc, 0, v250
    s_waitcnt lgkmcnt(0)
    s_barrier
    s_cbranch_vccnz L_ep_h
L_epok_h:
    s_mov_b32 s36, 0
    s_mov_b32 m0, s31
    s_nop 0
    buffer_load_dwordx4 v30, s[20:23], s36 offen offset:0  lds
    buffer_load_dwordx4 v31, s[20:23], s36 offen offset:1024  lds
    buffer_load_dwordx4 v32, s[20:23], s36 offen offset:2048  lds
    buffer_load_dwordx4 v33, s[20:23], s36 offen offset:3072  lds
L_pv_h:
    ds_read_b128 v[200:203], v14 offset:0
    ds_read_b128 v[204:207], v14 offset:256
    ds_read_b128 v[208:211], v14 offset:512
    ds_read_b128 v[212:215], v14 offset:768
    ds_read_b128 v[216:219], v14 offset:1024
    ds_read_b128 v[160:163], v10 offset:0
    ds_read_b128 v[164:167], v10 offset:1024
    ds_read_b128 v[168:171], v10 offset:2048
    ds_read_b128 v[172:175], v10 offset:3072
    ds_read_b128 v[176:179], v10 offset:4096
    s_waitcnt lgkmcnt(9)
    v_add_f32 v200, v200, v201
    v_add_f32 v202, v202, v203
    v_add_f32 v245, v200, v202
    v_rcp_f32 v240, v245
    s_waitcnt lgkmcnt(8)
    v_add_f32 v204, v204, v205
    v_add_f32 v206, v206, v207
    v_add_f32 v246, v204, v206
    v_rcp_f32 v241, v246
    s_waitcnt lgkmcnt(7)
    v_add_f32 v208, v208, v209
    v_add_f32 v210, v210, v211
    v_add_f32 v247, v208, v210
    v_rcp_f32 v242, v247
    s_waitcnt lgkmcnt(6)
    v_add_f32 v212, v212, v213
    v_add_f32 v214, v214, v215
    v_add_f32 v248, v212, v214
    v_rcp_f32 v243, v248
    s_waitcnt lgkmcnt(5)
    v_add_f32 v216, v216, v217
    v_add_f32 v218, v218, v219
    v_add_f32 v249, v216, v218
    v_rcp_f32 v244, v249
    v_max_f32 v38, v245, v240
    v_max3_f32 v38, v38, v246, v241
    v_max3_f32 v38, v38, v247, v242
    v_max3_f32 v38, v38, v248, v243
    v_max3_f32 v38, v38, v249, v244
    v_cmp_lt_f32 vcc, 0x5d800000, v38
    s_nop 1
    s_cbranch_vccz L_pvgo_h
    s_cmp_eq_u32 s39, 0
    s_cbranch_scc1 L_slow_h
L_pvgo_h:
    s_waitcnt lgkmcnt(0)
    v_mfma_f32_16x16x32_bf16 v[48:51], v[128:131], v[160:163], 0
    ds_read_b128 v[180:183], v10 offset:5120
    ds_read_b128 v[184:187], v10 offset:6144
    v_mfma_f32_16x16x32_bf16 v[68:71], v[132:135], v[160:163], 0
    v_add_u32 v40, 0, v0
    v_bfe_u32 v41, v40, 1, 1
    v_lshlrev_b32 v41, 7, v41
    v_and_or_b32 v41, v40, 1, v41
    v_mul_u32_u24 v41, 896, v41
    v_lshrrev_b32 v40, 2, v40
    v_lshl_add_u32 v40, v40, 7, v41
    s_mul_i32 s35, s73, 1792
    s_mov_b64 exec, 0xffff
    buffer_load_dword v39, v40, s[20:23], s35 offen
    s_mov_b64 exec, -1
    v_mfma_f32_16x16x32_bf16 v[88:91], v[136:139], v[160:163], 0
    ds_read_b128 v[188:191], v10 offset:7168
    ds_read_b128 v[192:195], v10 offset:8192
    v_mfma_f32_16x16x32_bf16 v[108:111], v[140:143], v[160:163], 0
    ds_read_b128 v[196:199], v10 offset:9216
    v_mfma_f32_16x16x32_bf16 v[112:115], v[140:143], v[164:167], 0
    v_mfma_f32_16x16x32_bf16 v[92:95], v[136:139], v[164:167], 0
    v_mfma_f32_16x16x32_bf16 v[72:75], v[132:135], v[164:167], 0
    v_mfma_f32_16x16x32_bf16 v[52:55], v[128:131], v[164:167], 0
    v_mfma_f32_16x16x32_bf16 v[56:59], v[128:131], v[168:171], 0
    v_mfma_f32_16x16x32_bf16 v[76:79], v[132:135], v[168:171], 0
    v_mfma_f32_16x16x32_bf16 v[96:99], v[136:139], v[168:171], 0
    v_mfma_f32_16x16x32_bf16 v[116:119], v[140:143], v[168:171], 0
    v_mfma_f32_16x16x32_bf16 v[120:123], v[140:143], v[172:175], 0
    v_mfma_f32_16x16x32_bf16 v[100:103], v[136:139], v[172:175], 0
    v_mfma_f32_16x16x32_bf16 v[80:83], v[132:135], v[172:175], 0
    v_mfma_f32_16x16x32_bf16 v[60:63], v[128:131], v[172:175], 0
    v_mfma_f32_16x16x32_bf16 v[64:67], v[128:131], v[176:179], 0
    v_mfma_f32_16x16x32_bf16 v[84:87], v[132:135], v[176:179], 0
    v_mfma_f32_16x16x32_bf16 v[104:107], v[136:139], v[176:179], 0
    v_mfma_f32_16x16x32_bf16 v[124:127], v[140:143], v[176:179], 0
    s_waitcnt lgkmcnt(0)
    v_mfma_f32_16x16x32_bf16 v[48:51], v[144:147], v[180:183], v[48:51]
    ds_read_b128 v[160:163], v10 offset:10240
    s_mov_b32 s4, s50
    v_mfma_f32_16x16x32_bf16 v[68:71], v[148:151], v[180:183], v[68:71]
    ds_read_b128 v[164:167], v10 offset:11264
    s_mov_b32 s5, s51
    v_mfma_f32_16x16x32_bf16 v[88:91], v[152:155], v[180:183], v[88:91]
    ds_read_b128 v[168:171], v10 offset:12288
    s_mov_b32 s6, 268435456
    v_mfma_f32_16x16x32_bf16 v[108:111], v[156:159], v[180:183], v[108:111]
    ds_read_b128 v[172:175], v10 offset:13312
    s_mov_b32 s7, 0x20000
    v_mfma_f32_16x16x32_bf16 v[112:115], v[156:159], v[184:187], v[112:115]
    ds_read_b128 v[176:179], v10 offset:14336
    s_mov_b32 s16, s46
    v_mfma_f32_16x16x32_bf16 v[92:95], v[152:155], v[184:187], v[92:95]
    s_mov_b32 s17, s47
    s_mov_b32 s18, 1032192
    v_mfma_f32_16x16x32_bf16 v[72:75], v[148:151], v[184:187], v[72:75]
    s_mov_b32 s19, 0x20000
    v_readfirstlane_b32 s54, v250
    v_mfma_f32_16x16x32_bf16 v[52:55], v[144:147], v[184:187], v[52:55]
    s_mov_b32 s58, s3
    s_and_b32 s61, s54, 16
    v_mfma_f32_16x16x32_bf16 v[56:59], v[144:147], v[188:191], v[56:59]
    s_lshl_b32 s61, s61, 9
    s_and_b32 s54, s54, 14
    v_mfma_f32_16x16x32_bf16 v[76:79], v[148:151], v[188:191], v[76:79]
    s_waitcnt vmcnt(13)
    ds_read_b64_tr_b16 v[128:129], v1 offset:0
    s_add_u32 s54, s54, s33
    v_mfma_f32_16x16x32_bf16 v[96:99], v[152:155], v[188:191], v[96:99]
    ds_read_b64_tr_b16 v[130:131], v1 offset:2048
    s_and_b32 s54, s54, 15
    v_mfma_f32_16x16x32_bf16 v[116:119], v[156:159], v[188:191], v[116:119]
    ds_read_b64_tr_b16 v[132:133], v2 offset:0
    s_lshr_b32 s42, s54, 3
    v_mfma_f32_16x16x32_bf16 v[120:123], v[156:159], v[192:195], v[120:123]
    ds_read_b64_tr_b16 v[134:135], v2 offset:2048
    s_lshl_b32 s54, s54, 2
    v_mfma_f32_16x16x32_bf16 v[100:103], v[152:155], v[192:195], v[100:103]
    ds_read_b64_tr_b16 v[136:137], v3 offset:0
    s_mov_b32 s56, 37756960
    v_mfma_f32_16x16x32_bf16 v[80:83], v[148:151], v[192:195], v[80:83]
    ds_read_b64_tr_b16 v[138:139], v3 offset:2048
    s_mov_b32 s57, 1093742900
    v_mfma_f32_16x16x32_bf16 v[60:63], v[144:147], v[192:195], v[60:63]
    ds_read_b64_tr_b16 v[140:141], v4 offset:0
    s_lshr_b64 s[56:57], s[56:57], s54
    v_mfma_f32_16x16x32_bf16 v[64:67], v[144:147], v[196:199], v[64:67]
    ds_read_b64_tr_b16 v[142:143], v4 offset:2048
    s_and_b32 s52, s56, 15
    v_mfma_f32_16x16x32_bf16 v[84:87], v[148:151], v[196:199], v[84:87]
    s_mov_b32 s56, 1716868163
    s_mov_b32 s57, 1717916739
    v_mfma_f32_16x16x32_bf16 v[104:107], v[152:155], v[196:199], v[104:107]
    s_lshr_b64 s[56:57], s[56:57], s54
    s_and_b32 s53, s56, 15
    v_mfma_f32_16x16x32_bf16 v[124:127], v[156:159], v[196:199], v[124:127]
    s_mov_b32 s56, 1861604547
    s_mov_b32 s57, 4142257351
    s_waitcnt lgkmcnt(0)
    v_mfma_f32_16x16x32_bf16 v[48:51], v[128:131], v[160:163], v[48:51]
    s_mov_b32 s36, 114688
    s_mov_b32 m0, s28
    ds_read_b128 v[180:183], v10 offset:15360
    v_mfma_f32_16x16x32_bf16 v[68:71], v[132:135], v[160:163], v[68:71]
    buffer_load_dwordx4 v30, s[20:23], s36 offen offset:0  lds
    ds_read_b128 v[184:187], v10 offset:16384
    v_mfma_f32_16x16x32_bf16 v[88:91], v[136:139], v[160:163], v[88:91]
    ds_read_b128 v[188:191], v10 offset:17408
    s_lshr_b64 s[56:57], s[56:57], s54
    v_mfma_f32_16x16x32_bf16 v[108:111], v[140:143], v[160:163], v[108:111]
    ds_read_b128 v[192:195], v10 offset:18432
    s_and_b32 s59, s56, 15
    v_mfma_f32_16x16x32_bf16 v[112:115], v[140:143], v[164:167], v[112:115]
    ds_read_b128 v[196:199], v10 offset:19456
    s_lshl3_add_u32 s54, s52, s53
    v_mfma_f32_16x16x32_bf16 v[92:95], v[136:139], v[164:167], v[92:95]
    buffer_load_dwordx4 v31, s[20:23], s36 offen offset:1024  lds
    v_mfma_f32_16x16x32_bf16 v[72:75], v[132:135], v[164:167], v[72:75]
    s_cmp_eq_u32 s54, 38
    s_cselect_b32 s43, 0xffff, -1
    v_mfma_f32_16x16x32_bf16 v[52:55], v[128:131], v[164:167], v[52:55]
    s_lshl_b32 s56, s32, 14
    s_mul_i32 s55, s3, 896
    v_mfma_f32_16x16x32_bf16 v[56:59], v[128:131], v[168:171], v[56:59]
    s_add_u32 s55, s55, s56
    s_lshl2_add_u32 s55, s33, s55
    v_mfma_f32_16x16x32_bf16 v[76:79], v[132:135], v[168:171], v[76:79]
    s_waitcnt vmcnt(11)
    ds_read_b64_tr_b16 v[144:145], v1 offset:4096
    s_add_u32 s40, s55, 16777216
    v_mfma_f32_16x16x32_bf16 v[96:99], v[136:139], v[168:171], v[96:99]
    buffer_load_dwordx4 v32, s[20:23], s36 offen offset:2048  lds
    ds_read_b64_tr_b16 v[146:147], v1 offset:6144
    v_mfma_f32_16x16x32_bf16 v[116:119], v[140:143], v[168:171], v[116:119]
    ds_read_b64_tr_b16 v[148:149], v2 offset:4096
    s_mul_i32 s55, s58, 896
    v_mfma_f32_16x16x32_bf16 v[120:123], v[140:143], v[172:175], v[120:123]
    ds_read_b64_tr_b16 v[150:151], v2 offset:6144
    s_add_u32 s55, s55, s56
    v_mfma_f32_16x16x32_bf16 v[100:103], v[136:139], v[172:175], v[100:103]
    ds_read_b64_tr_b16 v[152:153], v3 offset:4096
    s_lshl_b32 s56, s42, 13
    v_mfma_f32_16x16x32_bf16 v[80:83], v[132:135], v[172:175], v[80:83]
    ds_read_b64_tr_b16 v[154:155], v3 offset:6144
    s_add_u32 s55, s55, 0
    v_mfma_f32_16x16x32_bf16 v[60:63], v[128:131], v[172:175], v[60:63]
    buffer_load_dwordx4 v33, s[20:23], s36 offen offset:3072  lds
    ds_read_b64_tr_b16 v[156:157], v4 offset:4096
    v_mfma_f32_16x16x32_bf16 v[64:67], v[128:131], v[176:179], v[64:67]
    ds_read_b64_tr_b16 v[158:159], v4 offset:6144
    s_lshl_b32 s54, s53, 2
    v_mfma_f32_16x16x32_bf16 v[84:87], v[132:135], v[176:179], v[84:87]
    s_lshr_b32 s56, 107361075, s54
    s_and_b32 s56, s56, 15
    v_mfma_f32_16x16x32_bf16 v[104:107], v[136:139], v[176:179], v[104:107]
    s_bfe_u32 s54, s52, 0x10001
    s_mul_i32 s54, s54, 28
    v_mfma_f32_16x16x32_bf16 v[124:127], v[140:143], v[176:179], v[124:127]
    s_add_u32 s54, s54, s56
    s_lshl_b32 s54, s54, 7
    s_waitcnt lgkmcnt(0)
    v_mfma_f32_16x16x32_bf16 v[48:51], v[144:147], v[180:183], v[48:51]
    ds_read_b128 v[160:163], v10 offset:20480
    s_add_u32 s54, s54, s55
    v_mfma_f32_16x16x32_bf16 v[68:71], v[148:151], v[180:183], v[68:71]
    s_getpc_b64 s[44:45]
L_pc33_h:
    s_lshr_b32 s35, s2, 4
    s_lshl2_add_u32 s35, s35, s3
    s_lshr_b32 s35, s35, 1
    v_lshl_add_u32 v40, v0, 5, s35
    v_lshlrev_b32 v40, 7, v40
    v_min_u32 v40, L_end_h-L_pc33_h, v40
    s_mov_b64 exec, 15
    global_load_dword v39, v40, s[44:45]
    s_mov_b64 exec, -1
    v_mfma_f32_16x16x32_bf16 v[88:91], v[152:155], v[180:183], v[88:91]
    ds_read_b128 v[164:167], v10 offset:21504
    s_add_u32 s41, s54, 16777216
    v_mfma_f32_16x16x32_bf16 v[108:111], v[156:159], v[180:183], v[108:111]
    s_mov_b32 s36, 128
    s_mov_b32 m0, s29
    ds_read_b128 v[168:171], v10 offset:22528
    v_mfma_f32_16x16x32_bf16 v[112:115], v[156:159], v[184:187], v[112:115]
    buffer_load_dwordx4 v30, s[20:23], s36 offen offset:0  lds
    ds_read_b128 v[172:175], v10 offset:23552
    v_mfma_f32_16x16x32_bf16 v[92:95], v[152:155], v[184:187], v[92:95]
    ds_read_b128 v[176:179], v10 offset:24576
    s_and_b32 s54, s32, 1
    v_mfma_f32_16x16x32_bf16 v[72:75], v[148:151], v[184:187], v[72:75]
    s_lshl_b32 s54, s54, 13
    s_lshr_b32 s55, s33, 1
    v_mfma_f32_16x16x32_bf16 v[52:55], v[144:147], v[184:187], v[52:55]
    s_lshl_b32 s55, s55, 2
    s_and_b32 s60, s33, 1
    v_mfma_f32_16x16x32_bf16 v[56:59], v[144:147], v[188:191], v[56:59]
    buffer_load_dwordx4 v31, s[20:23], s36 offen offset:1024  lds
    s_or_b32 s60, s60, s55
    v_mfma_f32_16x16x32_bf16 v[76:79], v[148:151], v[188:191], v[76:79]
    s_waitcnt vmcnt(12)
    ds_read_b64_tr_b16 v[128:129], v1 offset:8192
    s_lshl2_add_u32 s60, s60, s3
    v_mfma_f32_16x16x32_bf16 v[96:99], v[152:155], v[188:191], v[96:99]
    ds_read_b64_tr_b16 v[130:131], v1 offset:10240
    s_lshl_b32 s60, s60, 10
    v_mfma_f32_16x16x32_bf16 v[116:119], v[156:159], v[188:191], v[116:119]
    ds_read_b64_tr_b16 v[132:133], v2 offset:8192
    s_or_b32 s60, s60, s54
    v_mfma_f32_16x16x32_bf16 v[120:123], v[156:159], v[192:195], v[120:123]
    buffer_load_dwordx4 v32, s[20:23], s36 offen offset:2048  lds
    ds_read_b64_tr_b16 v[134:135], v2 offset:10240
    v_mfma_f32_16x16x32_bf16 v[100:103], v[152:155], v[192:195], v[100:103]
    ds_read_b64_tr_b16 v[136:137], v3 offset:8192
    s_lshl_b32 s55, s33, 12
    v_mfma_f32_16x16x32_bf16 v[80:83], v[148:151], v[192:195], v[80:83]
    ds_read_b64_tr_b16 v[138:139], v3 offset:10240
    s_and_b32 s55, s55, s61
    v_mfma_f32_16x16x32_bf16 v[60:63], v[144:147], v[192:195], v[60:63]
    ds_read_b64_tr_b16 v[140:141], v4 offset:8192
    s_xor_b32 s60, s60, s55
    v_mfma_f32_16x16x32_bf16 v[64:67], v[144:147], v[196:199], v[64:67]
    buffer_load_dwordx4 v33, s[20:23], s36 offen offset:3072  lds
    ds_read_b64_tr_b16 v[142:143], v4 offset:10240
    v_mfma_f32_16x16x32_bf16 v[84:87], v[148:151], v[196:199], v[84:87]
    s_lshl_b32 s42, s42, 13
    s_xor_b32 s54, s54, s42
    v_mfma_f32_16x16x32_bf16 v[104:107], v[152:155], v[196:199], v[104:107]
    s_xor_b32 s60, s60, 0
    s_lshr_b32 s55, s59, 1
    v_mfma_f32_16x16x32_bf16 v[124:127], v[156:159], v[196:199], v[124:127]
    s_lshl_b32 s55, s55, 2
    s_and_b32 s42, s59, 1
    s_waitcnt lgkmcnt(0)
    v_mfma_f32_16x16x32_bf16 v[48:51], v[128:131], v[160:163], v[48:51]
    s_mov_b32 s36, 114816
    s_mov_b32 m0, s30
    ds_read_b128 v[180:183], v10 offset:25600
    v_mfma_f32_16x16x32_bf16 v[68:71], v[132:135], v[160:163], v[68:71]
    buffer_load_dwordx4 v30, s[20:23], s36 offen offset:0  lds
    ds_read_b128 v[184:187], v10 offset:26624
    v_mfma_f32_16x16x32_bf16 v[88:91], v[136:139], v[160:163], v[88:91]
    buffer_load_dwordx4 v31, s[20:23], s36 offen offset:1024  lds
    ds_read_b128 v[188:191], v10 offset:27648
    v_mfma_f32_16x16x32_bf16 v[108:111], v[140:143], v[160:163], v[108:111]
    buffer_load_dwordx4 v32, s[20:23], s36 offen offset:2048  lds
    ds_read_b128 v[192:195], v10 offset:28672
    v_mfma_f32_16x16x32_bf16 v[112:115], v[140:143], v[164:167], v[112:115]
    buffer_load_dwordx4 v33, s[20:23], s36 offen offset:3072  lds
    ds_read_b128 v[196:199], v10 offset:29696
    v_mfma_f32_16x16x32_bf16 v[92:95], v[136:139], v[164:167], v[92:95]
    s_waitcnt vmcnt(14)
    s_barrier
    ds_read_b64_tr_b16 a[160:161], v5 offset:12288
    v_mfma_f32_16x16x32_bf16 v[72:75], v[132:135], v[164:167], v[72:75]
    ds_read_b64_tr_b16 a[162:163], v5 offset:14336
    s_or_b32 s42, s42, s55
    v_mfma_f32_16x16x32_bf16 v[52:55], v[128:131], v[164:167], v[52:55]
    ds_read_b64_tr_b16 a[164:165], v5 offset:28672
    s_lshl2_add_u32 s42, s42, s3
    v_mfma_f32_16x16x32_bf16 v[56:59], v[128:131], v[168:171], v[56:59]
    ds_read_b64_tr_b16 a[166:167], v5 offset:30720
    s_lshl_b32 s42, s42, 10
    v_mfma_f32_16x16x32_bf16 v[76:79], v[132:135], v[168:171], v[76:79]
    ds_read_b64_tr_b16 a[168:169], v5 offset:45056
    s_or_b32 s42, s42, s54
    v_mfma_f32_16x16x32_bf16 v[96:99], v[136:139], v[168:171], v[96:99]
    ds_read_b64_tr_b16 a[170:171], v5 offset:47104
    s_lshl_b32 s54, s32, 21
    v_mfma_f32_16x16x32_bf16 v[116:119], v[140:143], v[168:171], v[116:119]
    ds_read_b64_tr_b16 a[172:173], v5 offset:61440
    s_or_b32 s42, s42, s54
    v_mfma_f32_16x16x32_bf16 v[120:123], v[140:143], v[172:175], v[120:123]
    ds_read_b64_tr_b16 a[174:175], v5 offset:63488
    s_waitcnt vmcnt(9) lgkmcnt(0)
    v_mfma_f32_16x16x32_bf16 v[100:103], v[136:139], v[172:175], v[100:103]
    s_barrier
    ds_read_b64_tr_b16 a[176:177], v5 offset:0
    s_xor_b32 s61, s61, s42
    v_mfma_f32_16x16x32_bf16 v[80:83], v[132:135], v[172:175], v[80:83]
    ds_read_b64_tr_b16 a[178:179], v5 offset:2048
    s_lshl_b32 s54, s52, 3
    v_mfma_f32_16x16x32_bf16 v[60:63], v[128:131], v[172:175], v[60:63]
    ds_read_b64_tr_b16 a[180:181], v5 offset:16384
    s_mov_b32 s56, 1884299264
    v_mfma_f32_16x16x32_bf16 v[64:67], v[128:131], v[176:179], v[64:67]
    ds_read_b64_tr_b16 a[182:183], v5 offset:18432
    s_mov_b32 s57, 64
    v_mfma_f32_16x16x32_bf16 v[84:87], v[132:135], v[176:179], v[84:87]
    ds_read_b64_tr_b16 a[184:185], v5 offset:32768
    s_lshr_b64 s[56:57], s[56:57], s54
    v_mfma_f32_16x16x32_bf16 v[104:107], v[136:139], v[176:179], v[104:107]
    ds_read_b64_tr_b16 a[186:187], v5 offset:34816
    s_and_b32 s54, s56, 255
    v_mfma_f32_16x16x32_bf16 v[124:127], v[140:143], v[176:179], v[124:127]
    ds_read_b64_tr_b16 a[188:189], v5 offset:49152
    s_mul_i32 s55, s32, 144
    ds_read_b64_tr_b16 a[190:191], v5 offset:51200
    s_mov_b32 s36, 256
    s_mov_b32 m0, s31
    s_nop 0
    buffer_load_dwordx4 v30, s[20:23], s36 offen offset:0  lds
    buffer_load_dwordx4 v31, s[20:23], s36 offen offset:1024  lds
    buffer_load_dwordx4 v32, s[20:23], s36 offen offset:2048  lds
    buffer_load_dwordx4 v33, s[20:23], s36 offen offset:3072  lds
    s_waitcnt vmcnt(8) lgkmcnt(0)
    s_barrier
    ds_read_b64_tr_b16 a[192:193], v5 offset:4096
    ds_read_b64_tr_b16 a[194:195], v5 offset:6144
    ds_read_b64_tr_b16 a[196:197], v5 offset:20480
    ds_read_b64_tr_b16 a[198:199], v5 offset:22528
    ds_read_b64_tr_b16 a[200:201], v5 offset:36864
    ds_read_b64_tr_b16 a[202:203], v5 offset:38912
    ds_read_b64_tr_b16 a[204:205], v5 offset:53248
    ds_read_b64_tr_b16 a[206:207], v5 offset:55296
    s_mov_b32 s36, 114944
    s_mov_b32 m0, s28
    s_nop 0
    buffer_load_dwordx4 v30, s[20:23], s36 offen offset:0  lds
    buffer_load_dwordx4 v31, s[20:23], s36 offen offset:1024  lds
    buffer_load_dwordx4 v32, s[20:23], s36 offen offset:2048  lds
    buffer_load_dwordx4 v33, s[20:23], s36 offen offset:3072  lds
    s_waitcnt vmcnt(8) lgkmcnt(0)
    s_barrier
    ds_read_b64_tr_b16 a[208:209], v5 offset:8192
    ds_read_b64_tr_b16 a[210:211], v5 offset:10240
    ds_read_b64_tr_b16 a[212:213], v5 offset:24576
    ds_read_b64_tr_b16 a[214:215], v5 offset:26624
    ds_read_b64_tr_b16 a[216:217], v5 offset:40960
    ds_read_b64_tr_b16 a[218:219], v5 offset:43008
    ds_read_b64_tr_b16 a[220:221], v5 offset:57344
    ds_read_b64_tr_b16 a[222:223], v5 offset:59392
    s_mov_b32 s36, 384
    s_mov_b32 m0, s29
    s_nop 0
    buffer_load_dwordx4 v30, s[20:23], s36 offen offset:0  lds
    buffer_load_dwordx4 v31, s[20:23], s36 offen offset:1024  lds
    buffer_load_dwordx4 v32, s[20:23], s36 offen offset:2048  lds
    buffer_load_dwordx4 v33, s[20:23], s36 offen offset:3072  lds
    s_waitcnt vmcnt(8) lgkmcnt(0)
    s_barrier
    ds_read_b64_tr_b16 a[224:225], v5 offset:12288
    ds_read_b64_tr_b16 a[226:227], v5 offset:14336
    ds_read_b64_tr_b16 a[228:229], v5 offset:28672
    ds_read_b64_tr_b16 a[230:231], v5 offset:30720
    ds_read_b64_tr_b16 a[232:233], v5 offset:45056
    ds_read_b64_tr_b16 a[234:235], v5 offset:47104
    ds_read_b64_tr_b16 a[236:237], v5 offset:61440
    ds_read_b64_tr_b16 a[238:239], v5 offset:63488
    s_mov_b32 s36, 115072
    s_mov_b32 m0, s30
    s_nop 0
    buffer_load_dwordx4 v30, s[20:23], s36 offen offset:0  lds
    buffer_load_dwordx4 v31, s[20:23], s36 offen offset:1024  lds
    buffer_load_dwordx4 v32, s[20:23], s36 offen offset:2048  lds
    buffer_load_dwordx4 v33, s[20:23], s36 offen offset:3072  lds
    s_waitcnt vmcnt(8) lgkmcnt(0)
    s_barrier
    ds_read_b64_tr_b16 a[240:241], v5 offset:0
    ds_read_b64_tr_b16 a[242:243], v5 offset:2048
    ds_read_b64_tr_b16 a[244:245], v5 offset:16384
    ds_read_b64_tr_b16 a[246:247], v5 offset:18432
    ds_read_b64_tr_b16 a[248:249], v5 offset:32768
    ds_read_b64_tr_b16 a[250:251], v5 offset:34816
    ds_read_b64_tr_b16 a[252:253], v5 offset:49152
    ds_read_b64_tr_b16 a[254:255], v5 offset:51200
    s_xor_b32 s36, s0, 114688
    s_mov_b32 m0, s31
    s_nop 0
    buffer_load_dwordx4 v26, s[12:15], s36 offen offset:0  lds
    buffer_load_dwordx4 v27, s[12:15], s36 offen offset:1024  lds
    buffer_load_dwordx4 v28, s[12:15], s36 offen offset:2048  lds
    buffer_load_dwordx4 v29, s[12:15], s36 offen offset:3072  lds
    s_waitcnt vmcnt(8) lgkmcnt(0)
    s_barrier
    ds_read_b64_tr_b16 v[224:225], v5 offset:4096
    ds_read_b64_tr_b16 v[226:227], v5 offset:6144
    ds_read_b64_tr_b16 v[228:229], v5 offset:20480
    ds_read_b64_tr_b16 v[230:231], v5 offset:22528
    ds_read_b64_tr_b16 v[232:233], v5 offset:36864
    ds_read_b64_tr_b16 v[234:235], v5 offset:38912
    ds_read_b64_tr_b16 v[236:237], v5 offset:53248
    ds_read_b64_tr_b16 v[238:239], v5 offset:55296
    s_xor_b32 s36, s0, 180224
    s_mov_b32 m0, s28
    s_nop 0
    buffer_load_dwordx4 v26, s[12:15], s36 offen offset:0  lds
    buffer_load_dwordx4 v27, s[12:15], s36 offen offset:1024  lds
    buffer_load_dwordx4 v28, s[12:15], s36 offen offset:2048  lds
    buffer_load_dwordx4 v29, s[12:15], s36 offen offset:3072  lds
    s_waitcnt vmcnt(8) lgkmcnt(0)
    s_barrier
    ds_read_b64_tr_b16 v[200:201], v5 offset:8192
    ds_read_b64_tr_b16 v[202:203], v5 offset:10240
    ds_read_b64_tr_b16 v[204:205], v5 offset:24576
    ds_read_b64_tr_b16 v[206:207], v5 offset:26624
    ds_read_b64_tr_b16 v[208:209], v5 offset:40960
    ds_read_b64_tr_b16 v[210:211], v5 offset:43008
    ds_read_b64_tr_b16 v[212:213], v5 offset:57344
    ds_read_b64_tr_b16 v[214:215], v5 offset:59392
    s_xor_b32 s36, s0, 245760
    s_mov_b32 m0, s29
    s_nop 0
    buffer_load_dwordx4 v26, s[12:15], s36 offen offset:0  lds
    buffer_load_dwordx4 v27, s[12:15], s36 offen offset:1024  lds
    buffer_load_dwordx4 v28, s[12:15], s36 offen offset:2048  lds
    buffer_load_dwordx4 v29, s[12:15], s36 offen offset:3072  lds
    s_waitcnt vmcnt(8) lgkmcnt(0)
    s_barrier
    ds_read_b64_tr_b16 v[144:145], v1 offset:12288
    ds_read_b64_tr_b16 v[146:147], v1 offset:14336
    ds_read_b64_tr_b16 v[148:149], v2 offset:12288
    ds_read_b64_tr_b16 v[150:151], v2 offset:14336
    ds_read_b64_tr_b16 v[152:153], v3 offset:12288
    ds_read_b64_tr_b16 v[154:155], v3 offset:14336
    ds_read_b64_tr_b16 v[156:157], v4 offset:12288
    ds_read_b64_tr_b16 v[158:159], v4 offset:14336
    s_xor_b32 s36, s0, 0
    s_mov_b32 m0, s30
    s_nop 0
    buffer_load_dwordx4 v26, s[12:15], s36 offen offset:0  lds
    buffer_load_dwordx4 v27, s[12:15], s36 offen offset:1024  lds
    buffer_load_dwordx4 v28, s[12:15], s36 offen offset:2048  lds
    buffer_load_dwordx4 v29, s[12:15], s36 offen offset:3072  lds
    s_waitcnt lgkmcnt(0)
    v_mfma_f32_16x16x32_bf16 v[48:51], v[144:147], v[180:183], v[48:51]
    s_xor_b32 s36, s0, 65536
    s_mov_b32 m0, s31
    ds_read_b128 v[160:163], v10 offset:30720
    v_mfma_f32_16x16x32_bf16 v[68:71], v[148:151], v[180:183], v[68:71]
    buffer_load_dwordx4 v26, s[12:15], s36 offen offset:0  lds
    ds_read_b128 v[164:167], v10 offset:31744
    v_mfma_f32_16x16x32_bf16 v[88:91], v[152:155], v[180:183], v[88:91]
    ds_read_b128 v[168:171], v10 offset:32768
    s_add_u32 s54, s54, s55
    v_mfma_f32_16x16x32_bf16 v[108:111], v[156:159], v[180:183], v[108:111]
    ds_read_b128 v[172:175], v10 offset:33792
    s_mul_i32 s54, s54, 896
    v_mfma_f32_16x16x32_bf16 v[112:115], v[156:159], v[184:187], v[112:115]
    ds_read_b128 v[176:179], v10 offset:34816
    s_lshr_b32 s55, s52, 2
    v_mfma_f32_16x16x32_bf16 v[92:95], v[152:155], v[184:187], v[92:95]
    buffer_load_dwordx4 v27, s[12:15], s36 offen offset:1024  lds
    s_andn2_b32 s55, s53, s55
    v_mfma_f32_16x16x32_bf16 v[72:75], v[148:151], v[184:187], v[72:75]
    s_lshl_b32 s55, s55, 2
    s_add_u32 s55, s55, 0
    v_mfma_f32_16x16x32_bf16 v[52:55], v[144:147], v[184:187], v[52:55]
    s_lshl_b32 s55, s55, 5
    s_add_u32 s54, s54, s55
    v_mfma_f32_16x16x32_bf16 v[56:59], v[144:147], v[188:191], v[56:59]
    s_mov_b32 s56, 14336
    v_mfma_f32_16x16x32_bf16 v[76:79], v[148:151], v[188:191], v[76:79]
    s_waitcnt vmcnt(10)
    ds_read_b64_tr_b16 v[128:129], v1 offset:0
    ds_read_b64_tr_b16 v[130:131], v1 offset:2048
    v_mfma_f32_16x16x32_bf16 v[96:99], v[152:155], v[188:191], v[96:99]
    buffer_load_dwordx4 v28, s[12:15], s36 offen offset:2048  lds
    ds_read_b64_tr_b16 v[132:133], v2 offset:0
    v_mfma_f32_16x16x32_bf16 v[116:119], v[156:159], v[188:191], v[116:119]
    ds_read_b64_tr_b16 v[134:135], v2 offset:2048
    ds_read_b64_tr_b16 v[136:137], v3 offset:0
    v_mfma_f32_16x16x32_bf16 v[120:123], v[156:159], v[192:195], v[120:123]
    ds_read_b64_tr_b16 v[138:139], v3 offset:2048
    ds_read_b64_tr_b16 v[140:141], v4 offset:0
    v_mfma_f32_16x16x32_bf16 v[100:103], v[152:155], v[192:195], v[100:103]
    ds_read_b64_tr_b16 v[142:143], v4 offset:2048
    v_mfma_f32_16x16x32_bf16 v[80:83], v[148:151], v[192:195], v[80:83]
    s_cmp_eq_u32 s52, 4
    s_cselect_b32 s55, 128, s56
    v_mfma_f32_16x16x32_bf16 v[60:63], v[144:147], v[192:195], v[60:63]
    buffer_load_dwordx4 v29, s[12:15], s36 offen offset:3072  lds
    s_lshr_b32 s56, s3, 1
    v_mfma_f32_16x16x32_bf16 v[64:67], v[144:147], v[196:199], v[64:67]
    s_mul_i32 s55, s55, s56
    s_add_u32 s54, s54, s55
    v_mfma_f32_16x16x32_bf16 v[84:87], v[148:151], v[196:199], v[84:87]
    s_and_b32 s55, s3, 1
    s_mul_i32 s55, s55, 7168
    v_mfma_f32_16x16x32_bf16 v[104:107], v[152:155], v[196:199], v[104:107]
    s_add_u32 s54, s54, s55
    s_not_b32 s43, s43
    v_mfma_f32_16x16x32_bf16 v[124:127], v[156:159], v[196:199], v[124:127]
    s_mul_i32 s43, s43, s56
    v_lshrrev_b32 v42, 3, v0
    s_waitcnt lgkmcnt(0)
    v_mfma_f32_16x16x32_bf16 v[48:51], v[128:131], v[160:163], v[48:51]
    s_xor_b32 s36, s0, 131072
    s_mov_b32 m0, s28
    ds_read_b128 v[180:183], v10 offset:35840
    v_mfma_f32_16x16x32_bf16 v[68:71], v[132:135], v[160:163], v[68:71]
    buffer_load_dwordx4 v26, s[12:15], s36 offen offset:0  lds
    ds_read_b128 v[184:187], v10 offset:36864
    v_mfma_f32_16x16x32_bf16 v[88:91], v[136:139], v[160:163], v[88:91]
    ds_read_b128 v[188:191], v10 offset:37888
    v_and_b32 v43, 7, v0
    v_mfma_f32_16x16x32_bf16 v[108:111], v[140:143], v[160:163], v[108:111]
    ds_read_b128 v[192:195], v10 offset:38912
    v_lshlrev_b32 v43, 4, v43
    v_mfma_f32_16x16x32_bf16 v[112:115], v[140:143], v[164:167], v[112:115]
    ds_read_b128 v[196:199], v10 offset:39936
    v_mul_u32_u24 v251, 896, v42
    v_mfma_f32_16x16x32_bf16 v[92:95], v[136:139], v[164:167], v[92:95]
    buffer_load_dwordx4 v27, s[12:15], s36 offen offset:1024  lds
    v_add3_u32 v251, v251, v43, s54
    v_mfma_f32_16x16x32_bf16 v[72:75], v[132:135], v[164:167], v[72:75]
    s_mul_i32 s54, s3, 1152
    s_add_u32 s54, s54, 32768
    v_mfma_f32_16x16x32_bf16 v[52:55], v[128:131], v[164:167], v[52:55]
    v_mul_u32_u24 v42, 144, v42
    v_add3_u32 v252, v42, v43, s54
    v_mfma_f32_16x16x32_bf16 v[56:59], v[128:131], v[168:171], v[56:59]
    v_and_b32 v42, 31, v0
    v_mul_u32_u24 v42, 144, v42
    v_mfma_f32_16x16x32_bf16 v[76:79], v[132:135], v[168:171], v[76:79]
    s_waitcnt vmcnt(10)
    ds_read_b64_tr_b16 v[144:145], v1 offset:4096
    v_lshrrev_b32 v43, 5, v0
    v_mfma_f32_16x16x32_bf16 v[96:99], v[136:139], v[168:171], v[96:99]
    buffer_load_dwordx4 v28, s[12:15], s36 offen offset:2048  lds
    ds_read_b64_tr_b16 v[146:147], v1 offset:6144
    v_mfma_f32_16x16x32_bf16 v[116:119], v[140:143], v[168:171], v[116:119]
    ds_read_b64_tr_b16 v[148:149], v2 offset:4096
    v_lshl_add_u32 v42, v43, 4, v42
    v_mfma_f32_16x16x32_bf16 v[120:123], v[140:143], v[172:175], v[120:123]
    ds_read_b64_tr_b16 v[150:151], v2 offset:6144
    s_lshl_b32 s54, s3, 5
    v_mfma_f32_16x16x32_bf16 v[100:103], v[136:139], v[172:175], v[100:103]
    ds_read_b64_tr_b16 v[152:153], v3 offset:4096
    s_add_u32 s54, s54, 32768
    v_mfma_f32_16x16x32_bf16 v[80:83], v[132:135], v[172:175], v[80:83]
    ds_read_b64_tr_b16 v[154:155], v3 offset:6144
    v_add_u32 v12, s54, v42
    v_mfma_f32_16x16x32_bf16 v[60:63], v[128:131], v[172:175], v[60:63]
    buffer_load_dwordx4 v29, s[12:15], s36 offen offset:3072  lds
    ds_read_b64_tr_b16 v[156:157], v4 offset:4096
    v_mfma_f32_16x16x32_bf16 v[64:67], v[128:131], v[176:179], v[64:67]
    ds_read_b64_tr_b16 v[158:159], v4 offset:6144
    v_lshlrev_b32 v254, 2, v0
    v_mfma_f32_16x16x32_bf16 v[84:87], v[132:135], v[176:179], v[84:87]
    v_lshlrev_b32 v37, 13, v0
    v_mfma_f32_16x16x32_bf16 v[104:107], v[136:139], v[176:179], v[104:107]
    s_cmp_lg_u32 s33, 0
    s_cbranch_scc1 L_nowarm_5
    s_mov_b64 exec, 1
    buffer_atomic_or v253, v37, s[4:7], s40 offen offset:384 sc1
    buffer_atomic_or v253, v37, s[4:7], s40 offen offset:768 sc1
    s_mov_b64 exec, -1
L_nowarm_5:
    v_mfma_f32_16x16x32_bf16 v[124:127], v[140:143], v[176:179], v[124:127]
    s_waitcnt lgkmcnt(0)
    v_mfma_f32_16x16x32_bf16 v[48:51], v[144:147], v[180:183], v[48:51]
    s_xor_b32 s36, s0, 196608
    s_mov_b32 m0, s29
    ds_read_b128 v[160:163], v11 offset:0
    v_mfma_f32_16x16x32_bf16 v[68:71], v[148:151], v[180:183], v[68:71]
    buffer_load_dwordx4 v26, s[12:15], s36 offen offset:0  lds
    ds_read_b128 v[164:167], v11 offset:1024
    v_mfma_f32_16x16x32_bf16 v[88:91], v[152:155], v[180:183], v[88:91]
    ds_read_b128 v[168:171], v11 offset:2048
    ds_read_b128 v[172:175], v11 offset:3072
    v_mfma_f32_16x16x32_bf16 v[108:111], v[156:159], v[180:183], v[108:111]
    ds_read_b128 v[176:179], v11 offset:4096
    v_mfma_f32_16x16x32_bf16 v[112:115], v[156:159], v[184:187], v[112:115]
    v_mfma_f32_16x16x32_bf16 v[92:95], v[152:155], v[184:187], v[92:95]
    buffer_load_dwordx4 v27, s[12:15], s36 offen offset:1024  lds
    v_mfma_f32_16x16x32_bf16 v[72:75], v[148:151], v[184:187], v[72:75]
    v_mfma_f32_16x16x32_bf16 v[52:55], v[144:147], v[184:187], v[52:55]
    v_mfma_f32_16x16x32_bf16 v[56:59], v[144:147], v[188:191], v[56:59]
    v_mfma_f32_16x16x32_bf16 v[76:79], v[148:151], v[188:191], v[76:79]
    s_waitcnt vmcnt(10)
    ds_read_b64_tr_b16 v[128:129], v1 offset:8192
    ds_read_b64_tr_b16 v[130:131], v1 offset:10240
    v_mfma_f32_16x16x32_bf16 v[96:99], v[152:155], v[188:191], v[96:99]
    buffer_load_dwordx4 v28, s[12:15], s36 offen offset:2048  lds
    ds_read_b64_tr_b16 v[132:133], v2 offset:8192
    v_mfma_f32_16x16x32_bf16 v[116:119], v[156:159], v[188:191], v[116:119]
    ds_read_b64_tr_b16 v[134:135], v2 offset:10240
    ds_read_b64_tr_b16 v[136:137], v3 offset:8192
    v_mfma_f32_16x16x32_bf16 v[120:123], v[156:159], v[192:195], v[120:123]
    ds_read_b64_tr_b16 v[138:139], v3 offset:10240
    ds_read_b64_tr_b16 v[140:141], v4 offset:8192
    v_mfma_f32_16x16x32_bf16 v[100:103], v[152:155], v[192:195], v[100:103]
    ds_read_b64_tr_b16 v[142:143], v4 offset:10240
    v_mfma_f32_16x16x32_bf16 v[80:83], v[148:151], v[192:195], v[80:83]
    v_mfma_f32_16x16x32_bf16 v[60:63], v[144:147], v[192:195], v[60:63]
    buffer_load_dwordx4 v29, s[12:15], s36 offen offset:3072  lds
    v_mfma_f32_16x16x32_bf16 v[64:67], v[144:147], v[196:199], v[64:67]
    v_mfma_f32_16x16x32_bf16 v[84:87], v[148:151], v[196:199], v[84:87]
    v_mfma_f32_16x16x32_bf16 v[104:107], v[152:155], v[196:199], v[104:107]
    v_mfma_f32_16x16x32_bf16 v[124:127], v[156:159], v[196:199], v[124:127]
    s_waitcnt lgkmcnt(0)
    v_mfma_f32_16x16x32_bf16 v[48:51], v[128:131], v[160:163], v[48:51]
    ds_read_b128 v[180:183], v11 offset:5120
    ds_read_b128 v[184:187], v11 offset:6144
    v_mfma_f32_16x16x32_bf16 v[68:71], v[132:135], v[160:163], v[68:71]
    v_add_u32 v40, 16, v0
    v_bfe_u32 v41, v40, 1, 1
    v_lshlrev_b32 v41, 7, v41
    v_and_or_b32 v41, v40, 1, v41
    v_mul_u32_u24 v41, 896, v41
    v_lshrrev_b32 v40, 2, v40
    v_lshl_add_u32 v40, v40, 7, v41
    s_mul_i32 s35, s73, 1792
    s_mov_b64 exec, 0xfff
    buffer_load_dword v39, v40, s[20:23], s35 offen
    s_mov_b64 exec, -1
    v_mfma_f32_16x16x32_bf16 v[88:91], v[136:139], v[160:163], v[88:91]
    ds_read_b128 v[188:191], v11 offset:7168
    ds_read_b128 v[192:195], v11 offset:8192
    v_mfma_f32_16x16x32_bf16 v[108:111], v[140:143], v[160:163], v[108:111]
    s_xor_b32 s36, s0, 16384
    s_mov_b32 m0, s30
    ds_read_b128 v[196:199], v11 offset:9216
    v_mfma_f32_16x16x32_bf16 v[112:115], v[140:143], v[164:167], v[112:115]
    buffer_load_dwordx4 v26, s[12:15], s36 offen offset:0  lds
    v_mfma_f32_16x16x32_bf16 v[92:95], v[136:139], v[164:167], v[92:95]
    v_mfma_f32_16x16x32_bf16 v[72:75], v[132:135], v[164:167], v[72:75]
    v_mfma_f32_16x16x32_bf16 v[52:55], v[128:131], v[164:167], v[52:55]
    v_mfma_f32_16x16x32_bf16 v[56:59], v[128:131], v[168:171], v[56:59]
    buffer_load_dwordx4 v27, s[12:15], s36 offen offset:1024  lds
    v_mfma_f32_16x16x32_bf16 v[76:79], v[132:135], v[168:171], v[76:79]
    s_waitcnt vmcnt(11)
    ds_read_b64_tr_b16 v[144:145], v1 offset:12288
    ds_read_b64_tr_b16 v[146:147], v1 offset:14336
    v_mfma_f32_16x16x32_bf16 v[96:99], v[136:139], v[168:171], v[96:99]
    ds_read_b64_tr_b16 v[148:149], v2 offset:12288
    ds_read_b64_tr_b16 v[150:151], v2 offset:14336
    v_mfma_f32_16x16x32_bf16 v[116:119], v[140:143], v[168:171], v[116:119]
    ds_read_b64_tr_b16 v[152:153], v3 offset:12288
    ds_read_b64_tr_b16 v[154:155], v3 offset:14336
    v_mfma_f32_16x16x32_bf16 v[120:123], v[140:143], v[172:175], v[120:123]
    buffer_load_dwordx4 v28, s[12:15], s36 offen offset:2048  lds
    ds_read_b64_tr_b16 v[156:157], v4 offset:12288
    v_mfma_f32_16x16x32_bf16 v[100:103], v[136:139], v[172:175], v[100:103]
    ds_read_b64_tr_b16 v[158:159], v4 offset:14336
    v_mfma_f32_16x16x32_bf16 v[80:83], v[132:135], v[172:175], v[80:83]
    v_mfma_f32_16x16x32_bf16 v[60:63], v[128:131], v[172:175], v[60:63]
    v_mfma_f32_16x16x32_bf16 v[64:67], v[128:131], v[176:179], v[64:67]
    buffer_load_dwordx4 v29, s[12:15], s36 offen offset:3072  lds
    v_mfma_f32_16x16x32_bf16 v[84:87], v[132:135], v[176:179], v[84:87]
    v_mfma_f32_16x16x32_bf16 v[104:107], v[136:139], v[176:179], v[104:107]
    v_mfma_f32_16x16x32_bf16 v[124:127], v[140:143], v[176:179], v[124:127]
    s_waitcnt lgkmcnt(0)
    v_mfma_f32_16x16x32_bf16 v[48:51], v[144:147], v[180:183], v[48:51]
    s_xor_b32 s36, s0, 81920
    s_mov_b32 m0, s31
    ds_read_b128 v[160:163], v11 offset:10240
    v_mfma_f32_16x16x32_bf16 v[68:71], v[148:151], v[180:183], v[68:71]
    buffer_load_dwordx4 v26, s[12:15], s36 offen offset:0  lds
    ds_read_b128 v[164:167], v11 offset:11264
    v_mfma_f32_16x16x32_bf16 v[88:91], v[152:155], v[180:183], v[88:91]
    ds_read_b128 v[168:171], v11 offset:12288
    ds_read_b128 v[172:175], v11 offset:13312
    v_mfma_f32_16x16x32_bf16 v[108:111], v[156:159], v[180:183], v[108:111]
    ds_read_b128 v[176:179], v11 offset:14336
    v_mfma_f32_16x16x32_bf16 v[112:115], v[156:159], v[184:187], v[112:115]
    v_mfma_f32_16x16x32_bf16 v[92:95], v[152:155], v[184:187], v[92:95]
    buffer_load_dwordx4 v27, s[12:15], s36 offen offset:1024  lds
    v_mfma_f32_16x16x32_bf16 v[72:75], v[148:151], v[184:187], v[72:75]
    v_mfma_f32_16x16x32_bf16 v[52:55], v[144:147], v[184:187], v[52:55]
    v_mfma_f32_16x16x32_bf16 v[56:59], v[144:147], v[188:191], v[56:59]
    v_mfma_f32_16x16x32_bf16 v[76:79], v[148:151], v[188:191], v[76:79]
    s_waitcnt vmcnt(11)
    ds_read_b64_tr_b16 v[128:129], v1 offset:0
    ds_read_b64_tr_b16 v[130:131], v1 offset:2048
    v_mfma_f32_16x16x32_bf16 v[96:99], v[152:155], v[188:191], v[96:99]
    buffer_load_dwordx4 v28, s[12:15], s36 offen offset:2048  lds
    ds_read_b64_tr_b16 v[132:133], v2 offset:0
    v_mfma_f32_16x16x32_bf16 v[116:119], v[156:159], v[188:191], v[116:119]
    ds_read_b64_tr_b16 v[134:135], v2 offset:2048
    ds_read_b64_tr_b16 v[136:137], v3 offset:0
    v_mfma_f32_16x16x32_bf16 v[120:123], v[156:159], v[192:195], v[120:123]
    ds_read_b64_tr_b16 v[138:139], v3 offset:2048
    ds_read_b64_tr_b16 v[140:141], v4 offset:0
    v_mfma_f32_16x16x32_bf16 v[100:103], v[152:155], v[192:195], v[100:103]
    ds_read_b64_tr_b16 v[142:143], v4 offset:2048
    v_mfma_f32_16x16x32_bf16 v[80:83], v[148:151], v[192:195], v[80:83]
    v_mfma_f32_16x16x32_bf16 v[60:63], v[144:147], v[192:195], v[60:63]
    buffer_load_dwordx4 v29, s[12:15], s36 offen offset:3072  lds
    v_mfma_f32_16x16x32_bf16 v[64:67], v[144:147], v[196:199], v[64:67]
    v_mfma_f32_16x16x32_bf16 v[84:87], v[148:151], v[196:199], v[84:87]
    v_mfma_f32_16x16x32_bf16 v[104:107], v[152:155], v[196:199], v[104:107]
    v_mfma_f32_16x16x32_bf16 v[124:127], v[156:159], v[196:199], v[124:127]
    s_waitcnt lgkmcnt(0)
    v_mfma_f32_16x16x32_bf16 v[48:51], v[128:131], v[160:163], v[48:51]
    s_xor_b32 s36, s0, 147456
    s_mov_b32 m0, s28
    ds_read_b128 v[180:183], v11 offset:15360
    v_mfma_f32_16x16x32_bf16 v[68:71], v[132:135], v[160:163], v[68:71]
    buffer_load_dwordx4 v26, s[12:15], s36 offen offset:0  lds
    ds_read_b128 v[184:187], v11 offset:16384
    v_mfma_f32_16x16x32_bf16 v[88:91], v[136:139], v[160:163], v[88:91]
    ds_read_b128 v[188:191], v11 offset:17408
    ds_read_b128 v[192:195], v11 offset:18432
    v_mfma_f32_16x16x32_bf16 v[108:111], v[140:143], v[160:163], v[108:111]
    ds_read_b128 v[196:199], v11 offset:19456
    v_mfma_f32_16x16x32_bf16 v[112:115], v[140:143], v[164:167], v[112:115]
    v_mfma_f32_16x16x32_bf16 v[92:95], v[136:139], v[164:167], v[92:95]
    buffer_load_dwordx4 v27, s[12:15], s36 offen offset:1024  lds
    v_mfma_f32_16x16x32_bf16 v[72:75], v[132:135], v[164:167], v[72:75]
    v_mfma_f32_16x16x32_bf16 v[52:55], v[128:131], v[164:167], v[52:55]
    v_mfma_f32_16x16x32_bf16 v[56:59], v[128:131], v[168:171], v[56:59]
    v_mfma_f32_16x16x32_bf16 v[76:79], v[132:135], v[168:171], v[76:79]
    s_waitcnt vmcnt(11)
    ds_read_b64_tr_b16 v[144:145], v1 offset:4096
    ds_read_b64_tr_b16 v[146:147], v1 offset:6144
    v_mfma_f32_16x16x32_bf16 v[96:99], v[136:139], v[168:171], v[96:99]
    buffer_load_dwordx4 v28, s[12:15], s36 offen offset:2048  lds
    ds_read_b64_tr_b16 v[148:149], v2 offset:4096
    v_mfma_f32_16x16x32_bf16 v[116:119], v[140:143], v[168:171], v[116:119]
    ds_read_b64_tr_b16 v[150:151], v2 offset:6144
    ds_read_b64_tr_b16 v[152:153], v3 offset:4096
    v_mfma_f32_16x16x32_bf16 v[120:123], v[140:143], v[172:175], v[120:123]
    ds_read_b64_tr_b16 v[154:155], v3 offset:6144
    ds_read_b64_tr_b16 v[156:157], v4 offset:4096
    v_mfma_f32_16x16x32_bf16 v[100:103], v[136:139], v[172:175], v[100:103]
    ds_read_b64_tr_b16 v[158:159], v4 offset:6144
    v_mfma_f32_16x16x32_bf16 v[80:83], v[132:135], v[172:175], v[80:83]
    v_mfma_f32_16x16x32_bf16 v[60:63], v[128:131], v[172:175], v[60:63]
    buffer_load_dwordx4 v29, s[12:15], s36 offen offset:3072  lds
    v_mfma_f32_16x16x32_bf16 v[64:67], v[128:131], v[176:179], v[64:67]
    v_mfma_f32_16x16x32_bf16 v[84:87], v[132:135], v[176:179], v[84:87]
    v_mfma_f32_16x16x32_bf16 v[104:107], v[136:139], v[176:179], v[104:107]
    v_mfma_f32_16x16x32_bf16 v[124:127], v[140:143], v[176:179], v[124:127]
    s_waitcnt lgkmcnt(0)
    v_mfma_f32_16x16x32_bf16 v[48:51], v[144:147], v[180:183], v[48:51]
    s_xor_b32 s36, s0, 212992
    s_mov_b32 m0, s29
    ds_read_b128 v[160:163], v11 offset:20480
    v_mfma_f32_16x16x32_bf16 v[68:71], v[148:151], v[180:183], v[68:71]
    buffer_load_dwordx4 v26, s[12:15], s36 offen offset:0  lds
    ds_read_b128 v[164:167], v11 offset:21504
    v_mfma_f32_16x16x32_bf16 v[88:91], v[152:155], v[180:183], v[88:91]
    ds_read_b128 v[168:171], v11 offset:22528
    ds_read_b128 v[172:175], v11 offset:23552
    v_mfma_f32_16x16x32_bf16 v[108:111], v[156:159], v[180:183], v[108:111]
    ds_read_b128 v[176:179], v11 offset:24576
    v_mfma_f32_16x16x32_bf16 v[112:115], v[156:159], v[184:187], v[112:115]
    v_mfma_f32_16x16x32_bf16 v[92:95], v[152:155], v[184:187], v[92:95]
    buffer_load_dwordx4 v27, s[12:15], s36 offen offset:1024  lds
    v_mfma_f32_16x16x32_bf16 v[72:75], v[148:151], v[184:187], v[72:75]
    v_mfma_f32_16x16x32_bf16 v[52:55], v[144:147], v[184:187], v[52:55]
    v_mfma_f32_16x16x32_bf16 v[56:59], v[144:147], v[188:191], v[56:59]
    v_mfma_f32_16x16x32_bf16 v[76:79], v[148:151], v[188:191], v[76:79]
    s_waitcnt vmcnt(10)
    ds_read_b64_tr_b16 v[128:129], v1 offset:8192
    ds_read_b64_tr_b16 v[130:131], v1 offset:10240
    v_mfma_f32_16x16x32_bf16 v[96:99], v[152:155], v[188:191], v[96:99]
    buffer_load_dwordx4 v28, s[12:15], s36 offen offset:2048  lds
    ds_read_b64_tr_b16 v[132:133], v2 offset:8192
    v_mfma_f32_16x16x32_bf16 v[116:119], v[156:159], v[188:191], v[116:119]
    ds_read_b64_tr_b16 v[134:135], v2 offset:10240
    ds_read_b64_tr_b16 v[136:137], v3 offset:8192
    v_mfma_f32_16x16x32_bf16 v[120:123], v[156:159], v[192:195], v[120:123]
    ds_read_b64_tr_b16 v[138:139], v3 offset:10240
    ds_read_b64_tr_b16 v[140:141], v4 offset:8192
    v_mfma_f32_16x16x32_bf16 v[100:103], v[152:155], v[192:195], v[100:103]
    ds_read_b64_tr_b16 v[142:143], v4 offset:10240
    v_mfma_f32_16x16x32_bf16 v[80:83], v[148:151], v[192:195], v[80:83]
    v_mfma_f32_16x16x32_bf16 v[60:63], v[144:147], v[192:195], v[60:63]
    buffer_load_dwordx4 v29, s[12:15], s36 offen offset:3072  lds
    v_mfma_f32_16x16x32_bf16 v[64:67], v[144:147], v[196:199], v[64:67]
    v_mfma_f32_16x16x32_bf16 v[84:87], v[148:151], v[196:199], v[84:87]
    v_mfma_f32_16x16x32_bf16 v[104:107], v[152:155], v[196:199], v[104:107]
    v_mfma_f32_16x16x32_bf16 v[124:127], v[156:159], v[196:199], v[124:127]
    s_waitcnt lgkmcnt(0)
    v_mfma_f32_16x16x32_bf16 v[48:51], v[128:131], v[160:163], v[48:51]
    s_barrier
    ds_read_b128 v[180:183], v11 offset:25600
    ds_read_b128 v[184:187], v11 offset:26624
    v_mfma_f32_16x16x32_bf16 v[68:71], v[132:135], v[160:163], v[68:71]
    ds_read_b128 v[188:191], v11 offset:27648
    ds_read_b128 v[192:195], v11 offset:28672
    v_mfma_f32_16x16x32_bf16 v[88:91], v[136:139], v[160:163], v[88:91]
    ds_read_b128 v[196:199], v11 offset:29696
    v_mfma_f32_16x16x32_bf16 v[108:111], v[140:143], v[160:163], v[108:111]
    v_mfma_f32_16x16x32_bf16 v[112:115], v[140:143], v[164:167], v[112:115]
    v_mfma_f32_16x16x32_bf16 v[92:95], v[136:139], v[164:167], v[92:95]
    v_mfma_f32_16x16x32_bf16 v[72:75], v[132:135], v[164:167], v[72:75]
    v_mfma_f32_16x16x32_bf16 v[52:55], v[128:131], v[164:167], v[52:55]
    v_mfma_f32_16x16x32_bf16 v[56:59], v[128:131], v[168:171], v[56:59]
    v_mfma_f32_16x16x32_bf16 v[76:79], v[132:135], v[168:171], v[76:79]
    s_waitcnt vmcnt(8)
    ds_read_b64_tr_b16 v[144:145], v1 offset:12288
    ds_read_b64_tr_b16 v[146:147], v1 offset:14336
    v_mfma_f32_16x16x32_bf16 v[96:99], v[136:139], v[168:171], v[96:99]
    ds_read_b64_tr_b16 v[148:149], v2 offset:12288
    ds_read_b64_tr_b16 v[150:151], v2 offset:14336
    v_mfma_f32_16x16x32_bf16 v[116:119], v[140:143], v[168:171], v[116:119]
    ds_read_b64_tr_b16 v[152:153], v3 offset:12288
    ds_read_b64_tr_b16 v[154:155], v3 offset:14336
    v_mfma_f32_16x16x32_bf16 v[120:123], v[140:143], v[172:175], v[120:123]
    ds_read_b64_tr_b16 v[156:157], v4 offset:12288
    ds_read_b64_tr_b16 v[158:159], v4 offset:14336
    v_mfma_f32_16x16x32_bf16 v[100:103], v[136:139], v[172:175], v[100:103]
    v_mfma_f32_16x16x32_bf16 v[80:83], v[132:135], v[172:175], v[80:83]
    v_mfma_f32_16x16x32_bf16 v[60:63], v[128:131], v[172:175], v[60:63]
    v_mfma_f32_16x16x32_bf16 v[64:67], v[128:131], v[176:179], v[64:67]
    v_mfma_f32_16x16x32_bf16 v[84:87], v[132:135], v[176:179], v[84:87]
    v_mfma_f32_16x16x32_bf16 v[104:107], v[136:139], v[176:179], v[104:107]
    v_mfma_f32_16x16x32_bf16 v[124:127], v[140:143], v[176:179], v[124:127]
    s_waitcnt lgkmcnt(0)
    v_mfma_f32_16x16x32_bf16 v[48:51], v[144:147], v[180:183], v[48:51]
    ds_read_b128 v[160:163], v11 offset:30720
    ds_read_b128 v[164:167], v11 offset:31744
    v_mfma_f32_16x16x32_bf16 v[68:71], v[148:151], v[180:183], v[68:71]
    ds_read_b128 v[168:171], v11 offset:32768
    ds_read_b128 v[172:175], v11 offset:33792
    v_mfma_f32_16x16x32_bf16 v[88:91], v[152:155], v[180:183], v[88:91]
    ds_read_b128 v[176:179], v11 offset:34816
    v_mfma_f32_16x16x32_bf16 v[108:111], v[156:159], v[180:183], v[108:111]
    v_mfma_f32_16x16x32_bf16 v[112:115], v[156:159], v[184:187], v[112:115]
    v_mfma_f32_16x16x32_bf16 v[92:95], v[152:155], v[184:187], v[92:95]
    v_mfma_f32_16x16x32_bf16 v[72:75], v[148:151], v[184:187], v[72:75]
    v_mfma_f32_16x16x32_bf16 v[52:55], v[144:147], v[184:187], v[52:55]
    v_mfma_f32_16x16x32_bf16 v[56:59], v[144:147], v[188:191], v[56:59]
    v_mfma_f32_16x16x32_bf16 v[76:79], v[148:151], v[188:191], v[76:79]
    v_mfma_f32_16x16x32_bf16 v[96:99], v[152:155], v[188:191], v[96:99]
    v_mfma_f32_16x16x32_bf16 v[116:119], v[156:159], v[188:191], v[116:119]
    v_mfma_f32_16x16x32_bf16 v[120:123], v[156:159], v[192:195], v[120:123]
    v_mfma_f32_16x16x32_bf16 v[100:103], v[152:155], v[192:195], v[100:103]
    v_mfma_f32_16x16x32_bf16 v[80:83], v[148:151], v[192:195], v[80:83]
    v_mfma_f32_16x16x32_bf16 v[60:63], v[144:147], v[192:195], v[60:63]
    v_mfma_f32_16x16x32_bf16 v[64:67], v[144:147], v[196:199], v[64:67]
    v_mfma_f32_16x16x32_bf16 v[84:87], v[148:151], v[196:199], v[84:87]
    v_mfma_f32_16x16x32_bf16 v[104:107], v[152:155], v[196:199], v[104:107]
    v_mfma_f32_16x16x32_bf16 v[124:127], v[156:159], v[196:199], v[124:127]
    s_waitcnt vmcnt(4)
    ds_read_b64_tr_b16 v[128:129], v1 offset:0
    ds_read_b64_tr_b16 v[130:131], v1 offset:2048
    ds_read_b64_tr_b16 v[132:133], v2 offset:0
    ds_read_b64_tr_b16 v[134:135], v2 offset:2048
    ds_read_b64_tr_b16 v[136:137], v3 offset:0
    ds_read_b64_tr_b16 v[138:139], v3 offset:2048
    ds_read_b64_tr_b16 v[140:141], v4 offset:0
    ds_read_b64_tr_b16 v[142:143], v4 offset:2048
    s_waitcnt lgkmcnt(0)
    v_mfma_f32_16x16x32_bf16 v[48:51], v[128:131], v[160:163], v[48:51]
    s_mov_b32 s36, 512
    s_mov_b32 m0, s30
    ds_read_b128 v[180:183], v11 offset:35840
    v_mfma_f32_16x16x32_bf16 v[68:71], v[132:135], v[160:163], v[68:71]
    buffer_load_dwordx4 v30, s[20:23], s36 offen offset:0  lds
    ds_read_b128 v[184:187], v11 offset:36864
    v_mfma_f32_16x16x32_bf16 v[88:91], v[136:139], v[160:163], v[88:91]
    ds_read_b128 v[188:191], v11 offset:37888
    ds_read_b128 v[192:195], v11 offset:38912
    v_mfma_f32_16x16x32_bf16 v[108:111], v[140:143], v[160:163], v[108:111]
    ds_read_b128 v[196:199], v11 offset:39936
    v_mfma_f32_16x16x32_bf16 v[112:115], v[140:143], v[164:167], v[112:115]
    v_mfma_f32_16x16x32_bf16 v[92:95], v[136:139], v[164:167], v[92:95]
    buffer_load_dwordx4 v31, s[20:23], s36 offen offset:1024  lds
    v_mfma_f32_16x16x32_bf16 v[72:75], v[132:135], v[164:167], v[72:75]
    v_mfma_f32_16x16x32_bf16 v[52:55], v[128:131], v[164:167], v[52:55]
    v_mfma_f32_16x16x32_bf16 v[56:59], v[128:131], v[168:171], v[56:59]
    v_mfma_f32_16x16x32_bf16 v[76:79], v[132:135], v[168:171], v[76:79]
    v_mfma_f32_16x16x32_bf16 v[96:99], v[136:139], v[168:171], v[96:99]
    buffer_load_dwordx4 v32, s[20:23], s36 offen offset:2048  lds
    v_mfma_f32_16x16x32_bf16 v[116:119], v[140:143], v[168:171], v[116:119]
    v_mfma_f32_16x16x32_bf16 v[120:123], v[140:143], v[172:175], v[120:123]
    v_mfma_f32_16x16x32_bf16 v[100:103], v[136:139], v[172:175], v[100:103]
    v_mfma_f32_16x16x32_bf16 v[80:83], v[132:135], v[172:175], v[80:83]
    v_mfma_f32_16x16x32_bf16 v[60:63], v[128:131], v[172:175], v[60:63]
    buffer_load_dwordx4 v33, s[20:23], s36 offen offset:3072  lds
    v_mfma_f32_16x16x32_bf16 v[64:67], v[128:131], v[176:179], v[64:67]
    v_mfma_f32_16x16x32_bf16 v[84:87], v[132:135], v[176:179], v[84:87]
    v_mfma_f32_16x16x32_bf16 v[104:107], v[136:139], v[176:179], v[104:107]
    v_mfma_f32_16x16x32_bf16 v[124:127], v[140:143], v[176:179], v[124:127]
    s_waitcnt vmcnt(4)
    ds_read_b64_tr_b16 v[144:145], v1 offset:4096
    ds_read_b64_tr_b16 v[146:147], v1 offset:6144
    ds_read_b64_tr_b16 v[148:149], v2 offset:4096
    ds_read_b64_tr_b16 v[150:151], v2 offset:6144
    ds_read_b64_tr_b16 v[152:153], v3 offset:4096
    ds_read_b64_tr_b16 v[154:155], v3 offset:6144
    ds_read_b64_tr_b16 v[156:157], v4 offset:4096
    ds_read_b64_tr_b16 v[158:159], v4 offset:6144
    s_waitcnt lgkmcnt(0)
    v_mfma_f32_16x16x32_bf16 v[48:51], v[144:147], v[180:183], v[48:51]
    s_mov_b32 s36, 115200
    s_mov_b32 m0, s31
    v_mfma_f32_16x16x32_bf16 v[68:71], v[148:151], v[180:183], v[68:71]
    buffer_load_dwordx4 v30, s[20:23], s36 offen offset:0  lds
    v_mfma_f32_16x16x32_bf16 v[88:91], v[152:155], v[180:183], v[88:91]
    v_mfma_f32_16x16x32_bf16 v[108:111], v[156:159], v[180:183], v[108:111]
    v_mfma_f32_16x16x32_bf16 v[52:55], v[144:147], v[184:187], v[52:55]
    s_nop 0
    v_cvt_pk_bf16_f32 v48, v48, v49
    v_cvt_pk_bf16_f32 v49, v50, v51
    v_mfma_f32_16x16x32_bf16 v[72:75], v[148:151], v[184:187], v[72:75]
    buffer_load_dwordx4 v31, s[20:23], s36 offen offset:1024  lds
    v_cvt_pk_bf16_f32 v50, v68, v69
    v_mfma_f32_16x16x32_bf16 v[92:95], v[152:155], v[184:187], v[92:95]
    v_cvt_pk_bf16_f32 v51, v70, v71
    ds_write_b128 v17, v[48:51] offset:0
    v_mfma_f32_16x16x32_bf16 v[112:115], v[156:159], v[184:187], v[112:115]
    v_cvt_pk_bf16_f32 v88, v88, v89
    v_cvt_pk_bf16_f32 v89, v90, v91
    v_mfma_f32_16x16x32_bf16 v[56:59], v[144:147], v[188:191], v[56:59]
    v_cvt_pk_bf16_f32 v90, v108, v109
    v_cvt_pk_bf16_f32 v91, v110, v111
    v_mfma_f32_16x16x32_bf16 v[76:79], v[148:151], v[188:191], v[76:79]
    ds_write_b128 v17, v[88:91] offset:5120
    v_cvt_pk_bf16_f32 v52, v52, v53
    v_mfma_f32_16x16x32_bf16 v[96:99], v[152:155], v[188:191], v[96:99]
    buffer_load_dwordx4 v32, s[20:23], s36 offen offset:2048  lds
    v_cvt_pk_bf16_f32 v53, v54, v55
    v_mfma_f32_16x16x32_bf16 v[116:119], v[156:159], v[188:191], v[116:119]
    v_cvt_pk_bf16_f32 v54, v72, v73
    v_cvt_pk_bf16_f32 v55, v74, v75
    v_mfma_f32_16x16x32_bf16 v[60:63], v[144:147], v[192:195], v[60:63]
    ds_write_b128 v17, v[52:55] offset:1024
    v_cvt_pk_bf16_f32 v92, v92, v93
    v_mfma_f32_16x16x32_bf16 v[80:83], v[148:151], v[192:195], v[80:83]
    v_cvt_pk_bf16_f32 v93, v94, v95
    v_cvt_pk_bf16_f32 v94, v112, v113
    v_mfma_f32_16x16x32_bf16 v[100:103], v[152:155], v[192:195], v[100:103]
    v_cvt_pk_bf16_f32 v95, v114, v115
    ds_write_b128 v17, v[92:95] offset:6144
    v_mfma_f32_16x16x32_bf16 v[120:123], v[156:159], v[192:195], v[120:123]
    buffer_load_dwordx4 v33, s[20:23], s36 offen offset:3072  lds
    v_cvt_pk_bf16_f32 v56, v56, v57
    v_mfma_f32_16x16x32_bf16 v[64:67], v[144:147], v[196:199], v[64:67]
    v_cvt_pk_bf16_f32 v57, v58, v59
    v_cvt_pk_bf16_f32 v58, v76, v77
    v_mfma_f32_16x16x32_bf16 v[84:87], v[148:151], v[196:199], v[84:87]
    v_cvt_pk_bf16_f32 v59, v78, v79
    ds_write_b128 v17, v[56:59] offset:2048
    v_mfma_f32_16x16x32_bf16 v[104:107], v[152:155], v[196:199], v[104:107]
    v_cvt_pk_bf16_f32 v96, v96, v97
    v_cvt_pk_bf16_f32 v97, v98, v99
    v_mfma_f32_16x16x32_bf16 v[124:127], v[156:159], v[196:199], v[124:127]
    v_cvt_pk_bf16_f32 v98, v116, v117
    v_cvt_pk_bf16_f32 v99, v118, v119
    ds_write_b128 v17, v[96:99] offset:7168
    v_cvt_pk_bf16_f32 v60, v60, v61
    v_cvt_pk_bf16_f32 v61, v62, v63
    v_cvt_pk_bf16_f32 v62, v80, v81
    v_cvt_pk_bf16_f32 v63, v82, v83
    ds_write_b128 v17, v[60:63] offset:3072
    v_cvt_pk_bf16_f32 v100, v100, v101
    v_cvt_pk_bf16_f32 v101, v102, v103
    v_cvt_pk_bf16_f32 v102, v120, v121
    v_cvt_pk_bf16_f32 v103, v122, v123
    ds_write_b128 v17, v[100:103] offset:8192
    v_cvt_pk_bf16_f32 v64, v64, v65
    v_cvt_pk_bf16_f32 v65, v66, v67
    v_cvt_pk_bf16_f32 v66, v84, v85
    v_cvt_pk_bf16_f32 v67, v86, v87
    ds_write_b128 v17, v[64:67] offset:4096
    v_cvt_pk_bf16_f32 v104, v104, v105
    v_cvt_pk_bf16_f32 v105, v106, v107
    v_cvt_pk_bf16_f32 v106, v124, v125
    v_cvt_pk_bf16_f32 v107, v126, v127
    ds_write_b128 v17, v[104:107] offset:9216
    s_mov_b32 s36, 640
    s_mov_b32 m0, s28
    s_nop 0
    buffer_load_dwordx4 v30, s[20:23], s36 offen offset:0  lds
    buffer_load_dwordx4 v31, s[20:23], s36 offen offset:1024  lds
    buffer_load_dwordx4 v32, s[20:23], s36 offen offset:2048  lds
    buffer_load_dwordx4 v33, s[20:23], s36 offen offset:3072  lds
    s_lshl_b32 s37, s3, 12
    s_waitcnt lgkmcnt(0)
    s_barrier
    ds_read_b128 a[0:3], v10 offset:0
    ds_read_b128 a[20:23], v10 offset:5120
    ds_read_b128 a[40:43], v10 offset:10240
    ds_read_b128 a[60:63], v10 offset:15360
    ds_read_b128 a[4:7], v10 offset:1024
    ds_read_b128 a[24:27], v10 offset:6144
    ds_read_b128 a[44:47], v10 offset:11264
    ds_read_b128 a[64:67], v10 offset:16384
    ds_read_b128 a[8:11], v10 offset:2048
    ds_read_b128 a[28:31], v10 offset:7168
    s_waitcnt lgkmcnt(9)
    v_mfma_f32_16x16x32_bf16 v[48:51], a[160:163], a[0:3], 0
    ds_read_b128 a[48:51], v10 offset:12288
    ds_read_b128 a[68:71], v10 offset:17408
    s_waitcnt lgkmcnt(10)
    v_mfma_f32_16x16x32_bf16 v[48:51], a[164:167], a[20:23], v[48:51]
    s_mov_b32 s36, 115328
    s_mov_b32 m0, s29
    ds_read_b128 a[12:15], v10 offset:3072
    s_waitcnt lgkmcnt(10)
    v_mfma_f32_16x16x32_bf16 v[48:51], a[168:171], a[40:43], v[48:51]
    ds_read_b128 a[32:35], v10 offset:8192
    buffer_load_dwordx4 v30, s[20:23], s36 offen offset:0  lds
    s_waitcnt lgkmcnt(10)
    v_mfma_f32_16x16x32_bf16 v[48:51], a[172:175], a[60:63], v[48:51]
    ds_read_b128 a[52:55], v10 offset:13312
    ds_read_b128 a[72:75], v10 offset:18432
    s_waitcnt lgkmcnt(11)
    v_mfma_f32_16x16x32_bf16 v[52:55], a[160:163], a[4:7], 0
    ds_read_b128 a[16:19], v10 offset:4096
    ds_read_b128 a[36:39], v10 offset:9216
    s_waitcnt lgkmcnt(12)
    v_mfma_f32_16x16x32_bf16 v[52:55], a[164:167], a[24:27], v[52:55]
    ds_read_b128 a[56:59], v10 offset:14336
    ds_read_b128 a[76:79], v10 offset:19456
    s_waitcnt lgkmcnt(13)
    v_mfma_f32_16x16x32_bf16 v[52:55], a[168:171], a[44:47], v[52:55]
    ds_read_b128 a[80:83], v10 offset:20480
    buffer_load_dwordx4 v31, s[20:23], s36 offen offset:1024  lds
    s_waitcnt lgkmcnt(13)
    v_mfma_f32_16x16x32_bf16 v[52:55], a[172:175], a[64:67], v[52:55]
    ds_read_b128 a[100:103], v10 offset:25600
    ds_read_b128 a[120:123], v10 offset:30720
    s_waitcnt lgkmcnt(14)
    v_mfma_f32_16x16x32_bf16 v[56:59], a[160:163], a[8:11], 0
    ds_read_b128 a[140:143], v10 offset:35840
    ds_read_b128 a[84:87], v10 offset:21504
    s_waitcnt lgkmcnt(14)
    v_mfma_f32_16x16x32_bf16 v[56:59], a[164:167], a[28:31], v[56:59]
    ds_read_b128 a[104:107], v10 offset:26624
    ds_read_b128 a[124:127], v10 offset:31744
    v_mfma_f32_16x16x32_bf16 v[56:59], a[168:171], a[48:51], v[56:59]
    ds_read_b128 a[144:147], v10 offset:36864
    ds_read_b128 a[88:91], v10 offset:22528
    s_waitcnt lgkmcnt(14)
    v_mfma_f32_16x16x32_bf16 v[56:59], a[172:175], a[68:71], v[56:59]
    ds_read_b128 a[108:111], v10 offset:27648
    buffer_load_dwordx4 v32, s[20:23], s36 offen offset:2048  lds
    v_mfma_f32_16x16x32_bf16 v[60:63], a[160:163], a[12:15], 0
    v_mfma_f32_16x16x32_bf16 v[60:63], a[164:167], a[32:35], v[60:63]
    v_mfma_f32_16x16x32_bf16 v[60:63], a[168:171], a[52:55], v[60:63]
    s_waitcnt lgkmcnt(14)
    v_mfma_f32_16x16x32_bf16 v[60:63], a[172:175], a[72:75], v[60:63]
    buffer_load_dwordx4 v33, s[20:23], s36 offen offset:3072  lds
    s_waitcnt lgkmcnt(13)
    v_mfma_f32_16x16x32_bf16 v[64:67], a[160:163], a[16:19], 0
    s_waitcnt lgkmcnt(12)
    v_mfma_f32_16x16x32_bf16 v[64:67], a[164:167], a[36:39], v[64:67]
    s_waitcnt lgkmcnt(11)
    v_mfma_f32_16x16x32_bf16 v[64:67], a[168:171], a[56:59], v[64:67]
    s_waitcnt lgkmcnt(10)
    v_mfma_f32_16x16x32_bf16 v[64:67], a[172:175], a[76:79], v[64:67]
    s_waitcnt lgkmcnt(9)
    v_mfma_f32_16x16x32_bf16 v[48:51], a[176:179], a[80:83], v[48:51]
    ds_read_b128 a[128:131], v10 offset:32768
    ds_read_b128 a[148:151], v10 offset:37888
    s_waitcnt lgkmcnt(10)
    v_mfma_f32_16x16x32_bf16 v[48:51], a[180:183], a[100:103], v[48:51]
    s_mov_b32 s36, 768
    s_add_u32 m0, s37, 40960
    ds_read_b128 a[92:95], v10 offset:23552
    s_waitcnt lgkmcnt(10)
    v_mfma_f32_16x16x32_bf16 v[48:51], a[184:187], a[120:123], v[48:51]
    ds_read_b128 a[112:115], v10 offset:28672
    buffer_load_dwordx4 v30, s[20:23], s36 offen offset:0  lds
    s_waitcnt lgkmcnt(10)
    v_mfma_f32_16x16x32_bf16 v[48:51], a[188:191], a[140:143], v[48:51]
    ds_read_b128 a[132:135], v10 offset:33792
    ds_read_b128 a[152:155], v10 offset:38912
    s_waitcnt lgkmcnt(11)
    v_mfma_f32_16x16x32_bf16 v[52:55], a[176:179], a[84:87], v[52:55]
    ds_read_b128 a[96:99], v10 offset:24576
    ds_read_b128 a[116:119], v10 offset:29696
    s_waitcnt lgkmcnt(12)
    v_mfma_f32_16x16x32_bf16 v[52:55], a[180:183], a[104:107], v[52:55]
    ds_read_b128 a[136:139], v10 offset:34816
    ds_read_b128 a[156:159], v10 offset:39936
    s_waitcnt lgkmcnt(13)
    v_mfma_f32_16x16x32_bf16 v[52:55], a[184:187], a[124:127], v[52:55]
    buffer_load_dwordx4 v31, s[20:23], s36 offen offset:1024  lds
    s_waitcnt lgkmcnt(12)
    v_mfma_f32_16x16x32_bf16 v[52:55], a[188:191], a[144:147], v[52:55]
    v_mul_f32 v48, v48, v240
    v_mul_f32 v49, v49, v240
    s_waitcnt lgkmcnt(11)
    v_mfma_f32_16x16x32_bf16 v[56:59], a[176:179], a[88:91], v[56:59]
    v_mul_f32 v50, v50, v240
    v_mul_f32 v51, v51, v240
    s_waitcnt lgkmcnt(10)
    v_mfma_f32_16x16x32_bf16 v[56:59], a[180:183], a[108:111], v[56:59]
    v_cvt_pk_bf16_f32 v160, v48, v49
    v_cvt_pk_bf16_f32 v161, v50, v51
    s_waitcnt lgkmcnt(9)
    v_mfma_f32_16x16x32_bf16 v[56:59], a[184:187], a[128:131], v[56:59]
    s_waitcnt lgkmcnt(8)
    v_mfma_f32_16x16x32_bf16 v[56:59], a[188:191], a[148:151], v[56:59]
    v_mul_f32 v52, v52, v241
    buffer_load_dwordx4 v32, s[20:23], s36 offen offset:2048  lds
    s_waitcnt lgkmcnt(7)
    v_mfma_f32_16x16x32_bf16 v[60:63], a[176:179], a[92:95], v[60:63]
    v_mul_f32 v53, v53, v241
    v_mul_f32 v54, v54, v241
    s_waitcnt lgkmcnt(6)
    v_mfma_f32_16x16x32_bf16 v[60:63], a[180:183], a[112:115], v[60:63]
    v_mul_f32 v55, v55, v241
    v_cvt_pk_bf16_f32 v162, v52, v53
    s_waitcnt lgkmcnt(5)
    v_mfma_f32_16x16x32_bf16 v[60:63], a[184:187], a[132:135], v[60:63]
    v_cvt_pk_bf16_f32 v163, v54, v55
    s_xor_b32 s78, s60, 0
    buffer_store_dwordx4 v[160:163], v10, s[24:27], s78 offen sc1
    s_waitcnt lgkmcnt(4)
    v_mfma_f32_16x16x32_bf16 v[60:63], a[188:191], a[152:155], v[60:63]
    v_mul_f32 v56, v56, v242
    buffer_load_dwordx4 v33, s[20:23], s36 offen offset:3072  lds
    s_waitcnt lgkmcnt(3)
    v_mfma_f32_16x16x32_bf16 v[64:67], a[176:179], a[96:99], v[64:67]
    v_mul_f32 v57, v57, v242
    v_mul_f32 v58, v58, v242
    s_waitcnt lgkmcnt(2)
    v_mfma_f32_16x16x32_bf16 v[64:67], a[180:183], a[116:119], v[64:67]
    v_mul_f32 v59, v59, v242
    v_cvt_pk_bf16_f32 v164, v56, v57
    s_waitcnt lgkmcnt(1)
    v_mfma_f32_16x16x32_bf16 v[64:67], a[184:187], a[136:139], v[64:67]
    v_cvt_pk_bf16_f32 v165, v58, v59
    s_waitcnt lgkmcnt(0)
    v_mfma_f32_16x16x32_bf16 v[64:67], a[188:191], a[156:159], v[64:67]
    v_mul_f32 v60, v60, v243
    v_mul_f32 v61, v61, v243
    v_mfma_f32_16x16x32_bf16 v[68:71], a[192:195], a[0:3], 0
    v_mul_f32 v62, v62, v243
    v_mul_f32 v63, v63, v243
    v_mfma_f32_16x16x32_bf16 v[68:71], a[196:199], a[20:23], v[68:71]
    s_mov_b32 s36, 115456
    s_add_u32 m0, s37, 57344
    v_cvt_pk_bf16_f32 v166, v60, v61
    v_mfma_f32_16x16x32_bf16 v[68:71], a[200:203], a[40:43], v[68:71]
    buffer_load_dwordx4 v30, s[20:23], s36 offen offset:0  lds
    v_cvt_pk_bf16_f32 v167, v62, v63
    v_mfma_f32_16x16x32_bf16 v[68:71], a[204:207], a[60:63], v[68:71]
    s_xor_b32 s78, s60, 8192
    buffer_store_dwordx4 v[164:167], v10, s[24:27], s78 offen sc1
    v_mul_f32 v64, v64, v244
    v_mfma_f32_16x16x32_bf16 v[72:75], a[192:195], a[4:7], 0
    v_mul_f32 v65, v65, v244
    v_mul_f32 v66, v66, v244
    v_mfma_f32_16x16x32_bf16 v[72:75], a[196:199], a[24:27], v[72:75]
    v_mul_f32 v67, v67, v244
    v_cvt_pk_bf16_f32 v184, v64, v65
    v_mfma_f32_16x16x32_bf16 v[72:75], a[200:203], a[44:47], v[72:75]
    buffer_load_dwordx4 v31, s[20:23], s36 offen offset:1024  lds
    v_cvt_pk_bf16_f32 v185, v66, v67
    v_mfma_f32_16x16x32_bf16 v[72:75], a[204:207], a[64:67], v[72:75]
    v_mfma_f32_16x16x32_bf16 v[76:79], a[192:195], a[8:11], 0
    v_mfma_f32_16x16x32_bf16 v[76:79], a[196:199], a[28:31], v[76:79]
    v_mfma_f32_16x16x32_bf16 v[76:79], a[200:203], a[48:51], v[76:79]
    v_mfma_f32_16x16x32_bf16 v[76:79], a[204:207], a[68:71], v[76:79]
    buffer_load_dwordx4 v32, s[20:23], s36 offen offset:2048  lds
    v_mfma_f32_16x16x32_bf16 v[80:83], a[192:195], a[12:15], 0
    v_mfma_f32_16x16x32_bf16 v[80:83], a[196:199], a[32:35], v[80:83]
    v_mfma_f32_16x16x32_bf16 v[80:83], a[200:203], a[52:55], v[80:83]
    v_mfma_f32_16x16x32_bf16 v[80:83], a[204:207], a[72:75], v[80:83]
    buffer_load_dwordx4 v33, s[20:23], s36 offen offset:3072  lds
    v_mfma_f32_16x16x32_bf16 v[84:87], a[192:195], a[16:19], 0
    v_mfma_f32_16x16x32_bf16 v[84:87], a[196:199], a[36:39], v[84:87]
    v_mfma_f32_16x16x32_bf16 v[84:87], a[200:203], a[56:59], v[84:87]
    v_mfma_f32_16x16x32_bf16 v[84:87], a[204:207], a[76:79], v[84:87]
    v_mfma_f32_16x16x32_bf16 v[68:71], a[208:211], a[80:83], v[68:71]
    v_mfma_f32_16x16x32_bf16 v[68:71], a[212:215], a[100:103], v[68:71]
    v_mfma_f32_16x16x32_bf16 v[68:71], a[216:219], a[120:123], v[68:71]
    v_mfma_f32_16x16x32_bf16 v[68:71], a[220:223], a[140:143], v[68:71]
    v_mfma_f32_16x16x32_bf16 v[72:75], a[208:211], a[84:87], v[72:75]
    v_mfma_f32_16x16x32_bf16 v[72:75], a[212:215], a[104:107], v[72:75]
    v_mfma_f32_16x16x32_bf16 v[72:75], a[216:219], a[124:127], v[72:75]
    v_mfma_f32_16x16x32_bf16 v[72:75], a[220:223], a[144:147], v[72:75]
    s_nop 3
    v_mul_f32 v68, v68, v240
    v_mul_f32 v69, v69, v240
    v_mfma_f32_16x16x32_bf16 v[76:79], a[208:211], a[88:91], v[76:79]
    v_mul_f32 v70, v70, v240
    v_mul_f32 v71, v71, v240
    v_mfma_f32_16x16x32_bf16 v[76:79], a[212:215], a[108:111], v[76:79]
    v_cvt_pk_bf16_f32 v168, v68, v69
    v_cvt_pk_bf16_f32 v169, v70, v71
    v_mfma_f32_16x16x32_bf16 v[76:79], a[216:219], a[128:131], v[76:79]
    v_mfma_f32_16x16x32_bf16 v[76:79], a[220:223], a[148:151], v[76:79]
    v_mul_f32 v72, v72, v241
    v_mul_f32 v73, v73, v241
    v_mfma_f32_16x16x32_bf16 v[80:83], a[208:211], a[92:95], v[80:83]
    v_mul_f32 v74, v74, v241
    v_mul_f32 v75, v75, v241
    v_mfma_f32_16x16x32_bf16 v[80:83], a[212:215], a[112:115], v[80:83]
    v_cvt_pk_bf16_f32 v170, v72, v73
    v_cvt_pk_bf16_f32 v171, v74, v75
    v_mfma_f32_16x16x32_bf16 v[80:83], a[216:219], a[132:135], v[80:83]
    s_xor_b32 s78, s60, 4096
    buffer_store_dwordx4 v[168:171], v10, s[24:27], s78 offen sc1
    v_mfma_f32_16x16x32_bf16 v[80:83], a[220:223], a[152:155], v[80:83]
    v_mul_f32 v76, v76, v242
    v_mul_f32 v77, v77, v242
    v_mfma_f32_16x16x32_bf16 v[84:87], a[208:211], a[96:99], v[84:87]
    v_mul_f32 v78, v78, v242
    v_mul_f32 v79, v79, v242
    v_mfma_f32_16x16x32_bf16 v[84:87], a[212:215], a[116:119], v[84:87]
    v_cvt_pk_bf16_f32 v172, v76, v77
    v_cvt_pk_bf16_f32 v173, v78, v79
    v_mfma_f32_16x16x32_bf16 v[84:87], a[216:219], a[136:139], v[84:87]
    v_mfma_f32_16x16x32_bf16 v[84:87], a[220:223], a[156:159], v[84:87]
    v_mul_f32 v80, v80, v243
    v_mul_f32 v81, v81, v243
    v_mfma_f32_16x16x32_bf16 v[48:51], a[224:227], a[0:3], 0
    v_mul_f32 v82, v82, v243
    v_mul_f32 v83, v83, v243
    v_mfma_f32_16x16x32_bf16 v[48:51], a[228:231], a[20:23], v[48:51]
    v_cvt_pk_bf16_f32 v174, v80, v81
    v_cvt_pk_bf16_f32 v175, v82, v83
    v_mfma_f32_16x16x32_bf16 v[48:51], a[232:235], a[40:43], v[48:51]
    s_xor_b32 s78, s60, 12288
    buffer_store_dwordx4 v[172:175], v10, s[24:27], s78 offen sc1
    v_mul_f32 v84, v84, v244
    v_mfma_f32_16x16x32_bf16 v[48:51], a[236:239], a[60:63], v[48:51]
    v_mul_f32 v85, v85, v244
    v_mul_f32 v86, v86, v244
    v_mfma_f32_16x16x32_bf16 v[52:55], a[224:227], a[4:7], 0
    v_mul_f32 v87, v87, v244
    v_cvt_pk_bf16_f32 v186, v84, v85
    v_mfma_f32_16x16x32_bf16 v[52:55], a[228:231], a[24:27], v[52:55]
    v_cvt_pk_bf16_f32 v187, v86, v87
    s_xor_b32 s78, s60, 53248
    buffer_store_dwordx4 v[184:187], v10, s[24:27], s78 offen sc1
    v_mfma_f32_16x16x32_bf16 v[52:55], a[232:235], a[44:47], v[52:55]
    v_mfma_f32_16x16x32_bf16 v[52:55], a[236:239], a[64:67], v[52:55]
    v_mfma_f32_16x16x32_bf16 v[56:59], a[224:227], a[8:11], 0
    v_mfma_f32_16x16x32_bf16 v[56:59], a[228:231], a[28:31], v[56:59]
    v_mfma_f32_16x16x32_bf16 v[56:59], a[232:235], a[48:51], v[56:59]
    v_mfma_f32_16x16x32_bf16 v[56:59], a[236:239], a[68:71], v[56:59]
    v_mfma_f32_16x16x32_bf16 v[60:63], a[224:227], a[12:15], 0
    v_mfma_f32_16x16x32_bf16 v[60:63], a[228:231], a[32:35], v[60:63]
    v_mfma_f32_16x16x32_bf16 v[60:63], a[232:235], a[52:55], v[60:63]
    v_mfma_f32_16x16x32_bf16 v[60:63], a[236:239], a[72:75], v[60:63]
    v_mfma_f32_16x16x32_bf16 v[64:67], a[224:227], a[16:19], 0
    v_mfma_f32_16x16x32_bf16 v[64:67], a[228:231], a[36:39], v[64:67]
    v_mfma_f32_16x16x32_bf16 v[64:67], a[232:235], a[56:59], v[64:67]
    v_mfma_f32_16x16x32_bf16 v[64:67], a[236:239], a[76:79], v[64:67]
    v_mfma_f32_16x16x32_bf16 v[48:51], a[240:243], a[80:83], v[48:51]
    v_mfma_f32_16x16x32_bf16 v[48:51], a[244:247], a[100:103], v[48:51]
    v_mfma_f32_16x16x32_bf16 v[48:51], a[248:251], a[120:123], v[48:51]
    v_mfma_f32_16x16x32_bf16 v[48:51], a[252:255], a[140:143], v[48:51]
    v_mfma_f32_16x16x32_bf16 v[52:55], a[240:243], a[84:87], v[52:55]
    v_mfma_f32_16x16x32_bf16 v[52:55], a[244:247], a[104:107], v[52:55]
    v_mfma_f32_16x16x32_bf16 v[52:55], a[248:251], a[124:127], v[52:55]
    v_mfma_f32_16x16x32_bf16 v[52:55], a[252:255], a[144:147], v[52:55]
    s_nop 3
    v_mul_f32 v48, v48, v240
    v_mul_f32 v49, v49, v240
    v_mfma_f32_16x16x32_bf16 v[56:59], a[240:243], a[88:91], v[56:59]
    v_mul_f32 v50, v50, v240
    v_mul_f32 v51, v51, v240
    v_mfma_f32_16x16x32_bf16 v[56:59], a[244:247], a[108:111], v[56:59]
    v_cvt_pk_bf16_f32 v176, v48, v49
    v_cvt_pk_bf16_f32 v177, v50, v51
    v_mfma_f32_16x16x32_bf16 v[56:59], a[248:251], a[128:131], v[56:59]
    v_mfma_f32_16x16x32_bf16 v[56:59], a[252:255], a[148:151], v[56:59]
    v_mul_f32 v52, v52, v241
    v_mul_f32 v53, v53, v241
    v_mfma_f32_16x16x32_bf16 v[60:63], a[240:243], a[92:95], v[60:63]
    v_mul_f32 v54, v54, v241
    v_mul_f32 v55, v55, v241
    v_mfma_f32_16x16x32_bf16 v[60:63], a[244:247], a[112:115], v[60:63]
    v_cvt_pk_bf16_f32 v178, v52, v53
    v_cvt_pk_bf16_f32 v179, v54, v55
    v_mfma_f32_16x16x32_bf16 v[60:63], a[248:251], a[132:135], v[60:63]
    s_xor_b32 s78, s60, 16384
    buffer_store_dwordx4 v[176:179], v10, s[24:27], s78 offen sc1
    v_mfma_f32_16x16x32_bf16 v[60:63], a[252:255], a[152:155], v[60:63]
    v_mul_f32 v56, v56, v242
    v_mul_f32 v57, v57, v242
    v_mfma_f32_16x16x32_bf16 v[64:67], a[240:243], a[96:99], v[64:67]
    v_mul_f32 v58, v58, v242
    v_mul_f32 v59, v59, v242
    v_mfma_f32_16x16x32_bf16 v[64:67], a[244:247], a[116:119], v[64:67]
    v_cvt_pk_bf16_f32 v180, v56, v57
    v_cvt_pk_bf16_f32 v181, v58, v59
    v_mfma_f32_16x16x32_bf16 v[64:67], a[248:251], a[136:139], v[64:67]
    v_mfma_f32_16x16x32_bf16 v[64:67], a[252:255], a[156:159], v[64:67]
    v_mul_f32 v60, v60, v243
    v_mul_f32 v61, v61, v243
    v_mfma_f32_16x16x32_bf16 v[68:71], v[224:227], a[0:3], 0
    v_mul_f32 v62, v62, v243
    v_mul_f32 v63, v63, v243
    v_mfma_f32_16x16x32_bf16 v[68:71], v[228:231], a[20:23], v[68:71]
    v_cvt_pk_bf16_f32 v182, v60, v61
    v_cvt_pk_bf16_f32 v183, v62, v63
    v_mfma_f32_16x16x32_bf16 v[68:71], v[232:235], a[40:43], v[68:71]
    s_xor_b32 s78, s60, 24576
    buffer_store_dwordx4 v[180:183], v10, s[24:27], s78 offen sc1
    v_mul_f32 v64, v64, v244
    v_mfma_f32_16x16x32_bf16 v[68:71], v[236:239], a[60:63], v[68:71]
    v_mul_f32 v65, v65, v244
    v_mul_f32 v66, v66, v244
    v_mfma_f32_16x16x32_bf16 v[72:75], v[224:227], a[4:7], 0
    v_mul_f32 v67, v67, v244
    v_cvt_pk_bf16_f32 v188, v64, v65
    v_mfma_f32_16x16x32_bf16 v[72:75], v[228:231], a[24:27], v[72:75]
    v_cvt_pk_bf16_f32 v189, v66, v67
    v_mfma_f32_16x16x32_bf16 v[72:75], v[232:235], a[44:47], v[72:75]
    v_mfma_f32_16x16x32_bf16 v[72:75], v[236:239], a[64:67], v[72:75]
    v_mfma_f32_16x16x32_bf16 v[76:79], v[224:227], a[8:11], 0
    v_mfma_f32_16x16x32_bf16 v[76:79], v[228:231], a[28:31], v[76:79]
    v_mfma_f32_16x16x32_bf16 v[76:79], v[232:235], a[48:51], v[76:79]
    v_mfma_f32_16x16x32_bf16 v[76:79], v[236:239], a[68:71], v[76:79]
    v_mfma_f32_16x16x32_bf16 v[80:83], v[224:227], a[12:15], 0
    v_mfma_f32_16x16x32_bf16 v[80:83], v[228:231], a[32:35], v[80:83]
    v_mfma_f32_16x16x32_bf16 v[80:83], v[232:235], a[52:55], v[80:83]
    v_mfma_f32_16x16x32_bf16 v[80:83], v[236:239], a[72:75], v[80:83]
    v_mfma_f32_16x16x32_bf16 v[84:87], v[224:227], a[16:19], 0
    v_mfma_f32_16x16x32_bf16 v[84:87], v[228:231], a[36:39], v[84:87]
    v_mfma_f32_16x16x32_bf16 v[84:87], v[232:235], a[56:59], v[84:87]
    v_mfma_f32_16x16x32_bf16 v[84:87], v[236:239], a[76:79], v[84:87]
    v_mfma_f32_16x16x32_bf16 v[68:71], v[200:203], a[80:83], v[68:71]
    v_mfma_f32_16x16x32_bf16 v[68:71], v[204:207], a[100:103], v[68:71]
    s_waitcnt vmcnt(5)
    s_barrier
    v_mfma_f32_16x16x32_bf16 v[68:71], v[208:211], a[120:123], v[68:71]
    ds_read_b64_tr_b16 v[128:129], v5 offset:8192
    ds_read_b64_tr_b16 v[130:131], v5 offset:10240
    v_mfma_f32_16x16x32_bf16 v[68:71], v[212:215], a[140:143], v[68:71]
    ds_read_b64_tr_b16 v[132:133], v5 offset:24576
    ds_read_b64_tr_b16 v[134:135], v5 offset:26624
    v_mfma_f32_16x16x32_bf16 v[72:75], v[200:203], a[84:87], v[72:75]
    ds_read_b64_tr_b16 v[136:137], v5 offset:40960
    ds_read_b64_tr_b16 v[138:139], v5 offset:43008
    v_mfma_f32_16x16x32_bf16 v[72:75], v[204:207], a[104:107], v[72:75]
    ds_read_b64_tr_b16 v[140:141], v5 offset:57344
    ds_read_b64_tr_b16 v[142:143], v5 offset:59392
    v_mfma_f32_16x16x32_bf16 v[72:75], v[208:211], a[124:127], v[72:75]
    v_mfma_f32_16x16x32_bf16 v[72:75], v[212:215], a[144:147], v[72:75]
    v_mul_f32 v68, v68, v240
    v_mul_f32 v69, v69, v240
    v_mfma_f32_16x16x32_bf16 v[76:79], v[200:203], a[88:91], v[76:79]
    v_mul_f32 v70, v70, v240
    v_mul_f32 v71, v71, v240
    v_mfma_f32_16x16x32_bf16 v[76:79], v[204:207], a[108:111], v[76:79]
    v_cvt_pk_bf16_f32 v160, v68, v69
    v_cvt_pk_bf16_f32 v161, v70, v71
    v_mfma_f32_16x16x32_bf16 v[76:79], v[208:211], a[128:131], v[76:79]
    v_mfma_f32_16x16x32_bf16 v[76:79], v[212:215], a[148:151], v[76:79]
    v_mul_f32 v72, v72, v241
    v_mul_f32 v73, v73, v241
    v_mfma_f32_16x16x32_bf16 v[80:83], v[200:203], a[92:95], v[80:83]
    v_mul_f32 v74, v74, v241
    v_mul_f32 v75, v75, v241
    v_mfma_f32_16x16x32_bf16 v[80:83], v[204:207], a[112:115], v[80:83]
    v_cvt_pk_bf16_f32 v162, v72, v73
    v_cvt_pk_bf16_f32 v163, v74, v75
    v_mfma_f32_16x16x32_bf16 v[80:83], v[208:211], a[132:135], v[80:83]
    s_xor_b32 s78, s60, 20480
    buffer_store_dwordx4 v[160:163], v10, s[24:27], s78 offen sc1
    v_mfma_f32_16x16x32_bf16 v[80:83], v[212:215], a[152:155], v[80:83]
    v_mul_f32 v76, v76, v242
    v_mul_f32 v77, v77, v242
    v_mfma_f32_16x16x32_bf16 v[84:87], v[200:203], a[96:99], v[84:87]
    v_mul_f32 v78, v78, v242
    v_mul_f32 v79, v79, v242
    v_mfma_f32_16x16x32_bf16 v[84:87], v[204:207], a[116:119], v[84:87]
    v_cvt_pk_bf16_f32 v164, v76, v77
    v_cvt_pk_bf16_f32 v165, v78, v79
    v_mfma_f32_16x16x32_bf16 v[84:87], v[208:211], a[136:139], v[84:87]
    v_mfma_f32_16x16x32_bf16 v[84:87], v[212:215], a[156:159], v[84:87]
    v_mul_f32 v80, v80, v243
    v_mul_f32 v81, v81, v243
    s_waitcnt lgkmcnt(0)
    v_mfma_f32_16x16x32_bf16 v[48:51], v[128:131], a[0:3], 0
    v_mul_f32 v82, v82, v243
    v_mul_f32 v83, v83, v243
    v_mfma_f32_16x16x32_bf16 v[48:51], v[132:135], a[20:23], v[48:51]
    ds_read_b64_tr_b16 v[144:145], v5 offset:12288
    v_cvt_pk_bf16_f32 v166, v80, v81
    v_mfma_f32_16x16x32_bf16 v[48:51], v[136:139], a[40:43], v[48:51]
    ds_read_b64_tr_b16 v[146:147], v5 offset:14336
    v_cvt_pk_bf16_f32 v167, v82, v83
    v_mfma_f32_16x16x32_bf16 v[48:51], v[140:143], a[60:63], v[48:51]
    ds_read_b64_tr_b16 v[148:149], v5 offset:28672
    s_xor_b32 s78, s60, 28672
    buffer_store_dwordx4 v[164:167], v10, s[24:27], s78 offen sc1
    v_mfma_f32_16x16x32_bf16 v[52:55], v[128:131], a[4:7], 0
    ds_read_b64_tr_b16 v[150:151], v5 offset:30720
    v_mul_f32 v84, v84, v244
    v_mfma_f32_16x16x32_bf16 v[52:55], v[132:135], a[24:27], v[52:55]
    ds_read_b64_tr_b16 v[152:153], v5 offset:45056
    v_mul_f32 v85, v85, v244
    v_mfma_f32_16x16x32_bf16 v[52:55], v[136:139], a[44:47], v[52:55]
    ds_read_b64_tr_b16 v[154:155], v5 offset:47104
    v_mul_f32 v86, v86, v244
    v_mfma_f32_16x16x32_bf16 v[52:55], v[140:143], a[64:67], v[52:55]
    ds_read_b64_tr_b16 v[156:157], v5 offset:61440
    v_mul_f32 v87, v87, v244
    v_mfma_f32_16x16x32_bf16 v[56:59], v[128:131], a[8:11], 0
    ds_read_b64_tr_b16 v[158:159], v5 offset:63488
    v_cvt_pk_bf16_f32 v190, v84, v85
    v_mfma_f32_16x16x32_bf16 v[56:59], v[132:135], a[28:31], v[56:59]
    v_cvt_pk_bf16_f32 v191, v86, v87
    s_xor_b32 s78, s60, 61440
    buffer_store_dwordx4 v[188:191], v10, s[24:27], s78 offen sc1
    v_mfma_f32_16x16x32_bf16 v[56:59], v[136:139], a[48:51], v[56:59]
    v_mfma_f32_16x16x32_bf16 v[56:59], v[140:143], a[68:71], v[56:59]
    v_mfma_f32_16x16x32_bf16 v[60:63], v[128:131], a[12:15], 0
    v_mfma_f32_16x16x32_bf16 v[60:63], v[132:135], a[32:35], v[60:63]
    v_mfma_f32_16x16x32_bf16 v[60:63], v[136:139], a[52:55], v[60:63]
    v_mfma_f32_16x16x32_bf16 v[60:63], v[140:143], a[72:75], v[60:63]
    v_mfma_f32_16x16x32_bf16 v[64:67], v[128:131], a[16:19], 0
    v_mfma_f32_16x16x32_bf16 v[64:67], v[132:135], a[36:39], v[64:67]
    v_mfma_f32_16x16x32_bf16 v[64:67], v[136:139], a[56:59], v[64:67]
    v_mfma_f32_16x16x32_bf16 v[64:67], v[140:143], a[76:79], v[64:67]
    s_waitcnt lgkmcnt(0)
    v_mfma_f32_16x16x32_bf16 v[48:51], v[144:147], a[80:83], v[48:51]
    v_mfma_f32_16x16x32_bf16 v[48:51], v[148:151], a[100:103], v[48:51]
    ds_read_b64_tr_b16 v[128:129], v5 offset:0
    ds_read_b64_tr_b16 v[130:131], v5 offset:2048
    v_mfma_f32_16x16x32_bf16 v[48:51], v[152:155], a[120:123], v[48:51]
    ds_read_b64_tr_b16 v[132:133], v5 offset:16384
    ds_read_b64_tr_b16 v[134:135], v5 offset:18432
    v_mfma_f32_16x16x32_bf16 v[48:51], v[156:159], a[140:143], v[48:51]
    ds_read_b64_tr_b16 v[136:137], v5 offset:32768
    ds_read_b64_tr_b16 v[138:139], v5 offset:34816
    v_mfma_f32_16x16x32_bf16 v[52:55], v[144:147], a[84:87], v[52:55]
    ds_read_b64_tr_b16 v[140:141], v5 offset:49152
    ds_read_b64_tr_b16 v[142:143], v5 offset:51200
    v_mfma_f32_16x16x32_bf16 v[52:55], v[148:151], a[104:107], v[52:55]
    v_mfma_f32_16x16x32_bf16 v[52:55], v[152:155], a[124:127], v[52:55]
    v_mfma_f32_16x16x32_bf16 v[52:55], v[156:159], a[144:147], v[52:55]
    v_mul_f32 v48, v48, v240
    v_mul_f32 v49, v49, v240
    v_mfma_f32_16x16x32_bf16 v[56:59], v[144:147], a[88:91], v[56:59]
    v_mul_f32 v50, v50, v240
    v_mul_f32 v51, v51, v240
    v_mfma_f32_16x16x32_bf16 v[56:59], v[148:151], a[108:111], v[56:59]
    v_cvt_pk_bf16_f32 v168, v48, v49
    v_cvt_pk_bf16_f32 v169, v50, v51
    v_mfma_f32_16x16x32_bf16 v[56:59], v[152:155], a[128:131], v[56:59]
    v_mfma_f32_16x16x32_bf16 v[56:59], v[156:159], a[148:151], v[56:59]
    v_mul_f32 v52, v52, v241
    v_mul_f32 v53, v53, v241
    v_mfma_f32_16x16x32_bf16 v[60:63], v[144:147], a[92:95], v[60:63]
    v_mul_f32 v54, v54, v241
    v_mul_f32 v55, v55, v241
    v_mfma_f32_16x16x32_bf16 v[60:63], v[148:151], a[112:115], v[60:63]
    v_cvt_pk_bf16_f32 v170, v52, v53
    v_cvt_pk_bf16_f32 v171, v54, v55
    v_mfma_f32_16x16x32_bf16 v[60:63], v[152:155], a[132:135], v[60:63]
    s_xor_b32 s78, s60, 32768
    buffer_store_dwordx4 v[168:171], v10, s[24:27], s78 offen sc1
    v_mfma_f32_16x16x32_bf16 v[60:63], v[156:159], a[152:155], v[60:63]
    v_mul_f32 v56, v56, v242
    v_mul_f32 v57, v57, v242
    v_mfma_f32_16x16x32_bf16 v[64:67], v[144:147], a[96:99], v[64:67]
    v_mul_f32 v58, v58, v242
    v_mul_f32 v59, v59, v242
    v_mfma_f32_16x16x32_bf16 v[64:67], v[148:151], a[116:119], v[64:67]
    v_cvt_pk_bf16_f32 v172, v56, v57
    v_cvt_pk_bf16_f32 v173, v58, v59
    v_mfma_f32_16x16x32_bf16 v[64:67], v[152:155], a[136:139], v[64:67]
    v_mfma_f32_16x16x32_bf16 v[64:67], v[156:159], a[156:159], v[64:67]
    v_mul_f32 v60, v60, v243
    v_mul_f32 v61, v61, v243
    s_waitcnt lgkmcnt(0)
    v_mfma_f32_16x16x32_bf16 v[68:71], v[128:131], a[0:3], 0
    v_mul_f32 v62, v62, v243
    v_mul_f32 v63, v63, v243
    v_mfma_f32_16x16x32_bf16 v[68:71], v[132:135], a[20:23], v[68:71]
    ds_read_b64_tr_b16 v[144:145], v5 offset:4096
    v_cvt_pk_bf16_f32 v174, v60, v61
    v_mfma_f32_16x16x32_bf16 v[68:71], v[136:139], a[40:43], v[68:71]
    ds_read_b64_tr_b16 v[146:147], v5 offset:6144
    v_cvt_pk_bf16_f32 v175, v62, v63
    v_mfma_f32_16x16x32_bf16 v[68:71], v[140:143], a[60:63], v[68:71]
    ds_read_b64_tr_b16 v[148:149], v5 offset:20480
    s_xor_b32 s78, s60, 40960
    buffer_store_dwordx4 v[172:175], v10, s[24:27], s78 offen sc1
    v_mfma_f32_16x16x32_bf16 v[72:75], v[128:131], a[4:7], 0
    ds_read_b64_tr_b16 v[150:151], v5 offset:22528
    v_mul_f32 v64, v64, v244
    v_mfma_f32_16x16x32_bf16 v[72:75], v[132:135], a[24:27], v[72:75]
    ds_read_b64_tr_b16 v[152:153], v5 offset:36864
    v_mul_f32 v65, v65, v244
    v_mfma_f32_16x16x32_bf16 v[72:75], v[136:139], a[44:47], v[72:75]
    ds_read_b64_tr_b16 v[154:155], v5 offset:38912
    v_mul_f32 v66, v66, v244
    v_mfma_f32_16x16x32_bf16 v[72:75], v[140:143], a[64:67], v[72:75]
    ds_read_b64_tr_b16 v[156:157], v5 offset:53248
    v_mul_f32 v67, v67, v244
    v_mfma_f32_16x16x32_bf16 v[76:79], v[128:131], a[8:11], 0
    ds_read_b64_tr_b16 v[158:159], v5 offset:55296
    v_cvt_pk_bf16_f32 v184, v64, v65
    v_mfma_f32_16x16x32_bf16 v[76:79], v[132:135], a[28:31], v[76:79]
    v_cvt_pk_bf16_f32 v185, v66, v67
    v_mfma_f32_16x16x32_bf16 v[76:79], v[136:139], a[48:51], v[76:79]
    s_waitcnt vmcnt(2)
    s_mov_b64 exec, 1
    buffer_atomic_swap v250, v37, s[4:7], s40 offen offset:384 sc1
    s_mov_b64 exec, -1
    v_mfma_f32_16x16x32_bf16 v[76:79], v[140:143], a[68:71], v[76:79]
    v_mfma_f32_16x16x32_bf16 v[80:83], v[128:131], a[12:15], 0
    v_mfma_f32_16x16x32_bf16 v[80:83], v[132:135], a[32:35], v[80:83]
    v_mfma_f32_16x16x32_bf16 v[80:83], v[136:139], a[52:55], v[80:83]
    v_mfma_f32_16x16x32_bf16 v[80:83], v[140:143], a[72:75], v[80:83]
    v_mfma_f32_16x16x32_bf16 v[84:87], v[128:131], a[16:19], 0
    v_mfma_f32_16x16x32_bf16 v[84:87], v[132:135], a[36:39], v[84:87]
    v_mfma_f32_16x16x32_bf16 v[84:87], v[136:139], a[56:59], v[84:87]
    v_mfma_f32_16x16x32_bf16 v[84:87], v[140:143], a[76:79], v[84:87]
    s_waitcnt lgkmcnt(0)
    v_mfma_f32_16x16x32_bf16 v[68:71], v[144:147], a[80:83], v[68:71]
    v_mfma_f32_16x16x32_bf16 v[68:71], v[148:151], a[100:103], v[68:71]
    ds_read_b64_tr_b16 v[128:129], v255 offset:0
    ds_read_b64_tr_b16 v[130:131], v255 offset:2048
    v_mfma_f32_16x16x32_bf16 v[68:71], v[152:155], a[120:123], v[68:71]
    ds_read_b64_tr_b16 v[132:133], v255 offset:4096
    ds_read_b64_tr_b16 v[134:135], v255 offset:6144
    v_mfma_f32_16x16x32_bf16 v[68:71], v[156:159], a[140:143], v[68:71]
    ds_read_b64_tr_b16 v[136:137], v255 offset:8192
    ds_read_b64_tr_b16 v[138:139], v255 offset:10240
    v_mfma_f32_16x16x32_bf16 v[72:75], v[144:147], a[84:87], v[72:75]
    ds_read_b64_tr_b16 v[140:141], v255 offset:12288
    ds_read_b64_tr_b16 v[142:143], v255 offset:14336
    v_mfma_f32_16x16x32_bf16 v[72:75], v[148:151], a[104:107], v[72:75]
    v_mfma_f32_16x16x32_bf16 v[72:75], v[152:155], a[124:127], v[72:75]
    v_mfma_f32_16x16x32_bf16 v[72:75], v[156:159], a[144:147], v[72:75]
    v_mul_f32 v68, v68, v240
    v_mul_f32 v69, v69, v240
    v_mfma_f32_16x16x32_bf16 v[76:79], v[144:147], a[88:91], v[76:79]
    v_mul_f32 v70, v70, v240
    v_mul_f32 v71, v71, v240
    v_mfma_f32_16x16x32_bf16 v[76:79], v[148:151], a[108:111], v[76:79]
    v_cvt_pk_bf16_f32 v176, v68, v69
    v_cvt_pk_bf16_f32 v177, v70, v71
    v_mfma_f32_16x16x32_bf16 v[76:79], v[152:155], a[128:131], v[76:79]
    v_mfma_f32_16x16x32_bf16 v[76:79], v[156:159], a[148:151], v[76:79]
    v_mul_f32 v72, v72, v241
    v_mul_f32 v73, v73, v241
    v_mfma_f32_16x16x32_bf16 v[80:83], v[144:147], a[92:95], v[80:83]
    v_mul_f32 v74, v74, v241
    v_mul_f32 v75, v75, v241
    v_mfma_f32_16x16x32_bf16 v[80:83], v[148:151], a[112:115], v[80:83]
    v_cvt_pk_bf16_f32 v178, v72, v73
    v_cvt_pk_bf16_f32 v179, v74, v75
    v_mfma_f32_16x16x32_bf16 v[80:83], v[152:155], a[132:135], v[80:83]
    s_xor_b32 s78, s60, 36864
    buffer_store_dwordx4 v[176:179], v10, s[24:27], s78 offen sc1
    v_mfma_f32_16x16x32_bf16 v[80:83], v[156:159], a[152:155], v[80:83]
    v_mul_f32 v76, v76, v242
    v_mul_f32 v77, v77, v242
    v_mfma_f32_16x16x32_bf16 v[84:87], v[144:147], a[96:99], v[84:87]
    v_mul_f32 v78, v78, v242
    v_mul_f32 v79, v79, v242
    v_mfma_f32_16x16x32_bf16 v[84:87], v[148:151], a[116:119], v[84:87]
    v_cvt_pk_bf16_f32 v180, v76, v77
    v_cvt_pk_bf16_f32 v181, v78, v79
    v_mfma_f32_16x16x32_bf16 v[84:87], v[152:155], a[136:139], v[84:87]
    v_mfma_f32_16x16x32_bf16 v[84:87], v[156:159], a[156:159], v[84:87]
    v_mul_f32 v80, v80, v243
    v_mul_f32 v81, v81, v243
    s_waitcnt lgkmcnt(0)
    v_mfma_f32_16x16x32_bf16 v[48:51], v[128:131], a[0:3], 0
    v_mul_f32 v82, v82, v243
    v_mul_f32 v83, v83, v243
    v_mfma_f32_16x16x32_bf16 v[48:51], v[132:135], a[20:23], v[48:51]
    ds_read_b64_tr_b16 v[144:145], v255 offset:16384
    v_cvt_pk_bf16_f32 v182, v80, v81
    v_mfma_f32_16x16x32_bf16 v[48:51], v[136:139], a[40:43], v[48:51]
    ds_read_b64_tr_b16 v[146:147], v255 offset:18432
    v_cvt_pk_bf16_f32 v183, v82, v83
    v_mfma_f32_16x16x32_bf16 v[48:51], v[140:143], a[60:63], v[48:51]
    ds_read_b64_tr_b16 v[148:149], v255 offset:20480
    s_xor_b32 s78, s60, 45056
    buffer_store_dwordx4 v[180:183], v10, s[24:27], s78 offen sc1
    v_mfma_f32_16x16x32_bf16 v[52:55], v[128:131], a[4:7], 0
    ds_read_b64_tr_b16 v[150:151], v255 offset:22528
    v_mul_f32 v84, v84, v244
    v_mfma_f32_16x16x32_bf16 v[52:55], v[132:135], a[24:27], v[52:55]
    ds_read_b64_tr_b16 v[152:153], v255 offset:24576
    v_mul_f32 v85, v85, v244
    v_mfma_f32_16x16x32_bf16 v[52:55], v[136:139], a[44:47], v[52:55]
    ds_read_b64_tr_b16 v[154:155], v255 offset:26624
    v_mul_f32 v86, v86, v244
    v_mfma_f32_16x16x32_bf16 v[52:55], v[140:143], a[64:67], v[52:55]
    ds_read_b64_tr_b16 v[156:157], v255 offset:28672
    v_mul_f32 v87, v87, v244
    v_mfma_f32_16x16x32_bf16 v[56:59], v[128:131], a[8:11], 0
    ds_read_b64_tr_b16 v[158:159], v255 offset:30720
    v_cvt_pk_bf16_f32 v186, v84, v85
    v_mfma_f32_16x16x32_bf16 v[56:59], v[132:135], a[28:31], v[56:59]
    v_cvt_pk_bf16_f32 v187, v86, v87
    s_xor_b32 s78, s60, 118784
    buffer_store_dwordx4 v[184:187], v10, s[24:27], s78 offen sc1
    v_mfma_f32_16x16x32_bf16 v[56:59], v[136:139], a[48:51], v[56:59]
    v_mfma_f32_16x16x32_bf16 v[56:59], v[140:143], a[68:71], v[56:59]
    v_mfma_f32_16x16x32_bf16 v[60:63], v[128:131], a[12:15], 0
    v_mfma_f32_16x16x32_bf16 v[60:63], v[132:135], a[32:35], v[60:63]
    v_mfma_f32_16x16x32_bf16 v[60:63], v[136:139], a[52:55], v[60:63]
    v_mfma_f32_16x16x32_bf16 v[60:63], v[140:143], a[72:75], v[60:63]
    v_mfma_f32_16x16x32_bf16 v[64:67], v[128:131], a[16:19], 0
    v_mfma_f32_16x16x32_bf16 v[64:67], v[132:135], a[36:39], v[64:67]
    v_mfma_f32_16x16x32_bf16 v[64:67], v[136:139], a[56:59], v[64:67]
    v_mfma_f32_16x16x32_bf16 v[64:67], v[140:143], a[76:79], v[64:67]
    s_waitcnt lgkmcnt(0)
    v_mfma_f32_16x16x32_bf16 v[48:51], v[144:147], a[80:83], v[48:51]
    v_mfma_f32_16x16x32_bf16 v[48:51], v[148:151], a[100:103], v[48:51]
    v_mfma_f32_16x16x32_bf16 v[48:51], v[152:155], a[120:123], v[48:51]
    v_mfma_f32_16x16x32_bf16 v[48:51], v[156:159], a[140:143], v[48:51]
    v_mfma_f32_16x16x32_bf16 v[52:55], v[144:147], a[84:87], v[52:55]
    v_mfma_f32_16x16x32_bf16 v[52:55], v[148:151], a[104:107], v[52:55]
    v_mfma_f32_16x16x32_bf16 v[52:55], v[152:155], a[124:127], v[52:55]
    v_mfma_f32_16x16x32_bf16 v[52:55], v[156:159], a[144:147], v[52:55]
    s_nop 3
    v_mul_f32 v48, v48, v240
    v_mul_f32 v49, v49, v240
    v_mfma_f32_16x16x32_bf16 v[56:59], v[144:147], a[88:91], v[56:59]
    v_mul_f32 v50, v50, v240
    v_mul_f32 v51, v51, v240
    v_mfma_f32_16x16x32_bf16 v[56:59], v[148:151], a[108:111], v[56:59]
    v_cvt_pk_bf16_f32 v160, v48, v49
    v_cvt_pk_bf16_f32 v161, v50, v51
    v_mfma_f32_16x16x32_bf16 v[56:59], v[152:155], a[128:131], v[56:59]
    v_mfma_f32_16x16x32_bf16 v[56:59], v[156:159], a[148:151], v[56:59]
    v_mul_f32 v52, v52, v241
    v_mul_f32 v53, v53, v241
    v_mfma_f32_16x16x32_bf16 v[60:63], v[144:147], a[92:95], v[60:63]
    v_mul_f32 v54, v54, v241
    v_mul_f32 v55, v55, v241
    v_mfma_f32_16x16x32_bf16 v[60:63], v[148:151], a[112:115], v[60:63]
    v_cvt_pk_bf16_f32 v162, v52, v53
    v_cvt_pk_bf16_f32 v163, v54, v55
    v_mfma_f32_16x16x32_bf16 v[60:63], v[152:155], a[132:135], v[60:63]
    s_xor_b32 s78, s60, 49152
    buffer_store_dwordx4 v[160:163], v10, s[24:27], s78 offen sc1
    v_mfma_f32_16x16x32_bf16 v[60:63], v[156:159], a[152:155], v[60:63]
    v_mul_f32 v56, v56, v242
    v_mul_f32 v57, v57, v242
    v_mfma_f32_16x16x32_bf16 v[64:67], v[144:147], a[96:99], v[64:67]
    v_mul_f32 v58, v58, v242
    v_mul_f32 v59, v59, v242
    v_mfma_f32_16x16x32_bf16 v[64:67], v[148:151], a[116:119], v[64:67]
    v_cvt_pk_bf16_f32 v164, v56, v57
    v_cvt_pk_bf16_f32 v165, v58, v59
    v_mfma_f32_16x16x32_bf16 v[64:67], v[152:155], a[136:139], v[64:67]
    v_mfma_f32_16x16x32_bf16 v[64:67], v[156:159], a[156:159], v[64:67]
    v_mul_f32 v60, v60, v243
    v_mul_f32 v61, v61, v243
    v_mul_f32 v62, v62, v243
    v_mul_f32 v63, v63, v243
    v_cvt_pk_bf16_f32 v166, v60, v61
    v_cvt_pk_bf16_f32 v167, v62, v63
    s_xor_b32 s78, s60, 57344
    buffer_store_dwordx4 v[164:167], v10, s[24:27], s78 offen sc1
    v_mul_f32 v64, v64, v244
    v_mul_f32 v65, v65, v244
    v_mul_f32 v66, v66, v244
    v_mul_f32 v67, v67, v244
    v_cvt_pk_bf16_f32 v188, v64, v65
    v_cvt_pk_bf16_f32 v189, v66, v67
    s_xor_b32 s78, s60, 126976
    buffer_store_dwordx4 v[188:191], v10, s[24:27], s78 offen sc1
    s_waitcnt vmcnt(0)
    s_mov_b64 exec, 1
    buffer_atomic_swap v250, v37, s[4:7], s40 offen offset:768 sc1
    s_mov_b64 exec, -1
    s_mov_b32 s79, 0x100000
    s_mov_b32 s77, 0xffff
L_poll_h:
    s_mov_b32 exec_lo, s77
    s_mov_b32 exec_hi, 0
    v_mov_b32 v38, 0
    buffer_atomic_or v38, v254, s[4:7], s41 offen sc0 sc1
    s_sub_u32 s79, s79, 1
    s_cbranch_scc1 L_k1_end
    s_waitcnt vmcnt(0)
    v_cmp_eq_u32 vcc, v38, v250
    s_mov_b32 exec_lo, -1
    s_nop 0
    s_andn2_b32 s77, s77, vcc_lo
    s_cbranch_scc1 L_poll_h
    s_mov_b32 exec_hi, -1
    s_xor_b32 s78, s42, 0
    buffer_load_dwordx4 v[64:67], v10, s[4:7], s78 offen sc1
    s_xor_b32 s78, s42, 135168
    buffer_load_dwordx4 v[68:71], v10, s[4:7], s78 offen sc1
    s_xor_b32 s78, s61, 278528
    buffer_load_dwordx4 v[72:75], v10, s[4:7], s78 offen sc1
    s_xor_b32 s78, s61, 413696
    buffer_load_dwordx4 v[76:79], v10, s[4:7], s78 offen sc1
    s_xor_b32 s78, s42, 557056
    buffer_load_dwordx4 v[80:83], v10, s[4:7], s78 offen sc1
    s_xor_b32 s78, s42, 692224
    buffer_load_dwordx4 v[84:87], v10, s[4:7], s78 offen sc1
    s_xor_b32 s78, s61, 835584
    buffer_load_dwordx4 v[88:91], v10, s[4:7], s78 offen sc1
    s_xor_b32 s78, s61, 970752
    buffer_load_dwordx4 v[92:95], v10, s[4:7], s78 offen sc1
    s_xor_b32 s78, s42, 1114112
    buffer_load_dwordx4 v[96:99], v10, s[4:7], s78 offen sc1
    s_xor_b32 s78, s42, 1249280
    buffer_load_dwordx4 v[100:103], v10, s[4:7], s78 offen sc1
    s_xor_b32 s78, s61, 1392640
    buffer_load_dwordx4 v[104:107], v10, s[4:7], s78 offen sc1
    s_xor_b32 s78, s61, 1527808
    buffer_load_dwordx4 v[108:111], v10, s[4:7], s78 offen sc1
    s_xor_b32 s78, s42, 1671168
    buffer_load_dwordx4 v[112:115], v10, s[4:7], s78 offen sc1
    s_xor_b32 s78, s42, 1806336
    buffer_load_dwordx4 v[116:119], v10, s[4:7], s78 offen sc1
    s_xor_b32 s78, s61, 1949696
    buffer_load_dwordx4 v[120:123], v10, s[4:7], s78 offen sc1
    s_xor_b32 s78, s61, 2084864
    buffer_load_dwordx4 v[124:127], v10, s[4:7], s78 offen sc1
L_sum_h:
    s_mov_b32 s35, 0x00003f80
    s_mov_b32 s76, 0x3f800000
    s_waitcnt vmcnt(15)
    v_lshlrev_b32 v128, 16, v64
    v_and_b32 v129, 0xffff0000, v64
    v_lshlrev_b32 v130, 16, v65
    v_and_b32 v131, 0xffff0000, v65
    v_lshlrev_b32 v132, 16, v66
    v_and_b32 v133, 0xffff0000, v66
    v_lshlrev_b32 v134, 16, v67
    v_and_b32 v135, 0xffff0000, v67
    s_waitcnt vmcnt(14)
    v_dot2c_f32_bf16 v128, s35, v68
    v_dot2c_f32_bf16 v129, s76, v68
    v_dot2c_f32_bf16 v130, s35, v69
    v_dot2c_f32_bf16 v131, s76, v69
    v_dot2c_f32_bf16 v132, s35, v70
    v_dot2c_f32_bf16 v133, s76, v70
    v_dot2c_f32_bf16 v134, s35, v71
    v_dot2c_f32_bf16 v135, s76, v71
    s_waitcnt vmcnt(13)
    v_dot2c_f32_bf16 v128, s35, v72
    v_dot2c_f32_bf16 v129, s76, v72
    v_dot2c_f32_bf16 v130, s35, v73
    v_dot2c_f32_bf16 v131, s76, v73
    v_dot2c_f32_bf16 v132, s35, v74
    v_dot2c_f32_bf16 v133, s76, v74
    v_dot2c_f32_bf16 v134, s35, v75
    v_dot2c_f32_bf16 v135, s76, v75
    s_waitcnt vmcnt(12)
    v_dot2c_f32_bf16 v128, s35, v76
    v_dot2c_f32_bf16 v129, s76, v76
    v_dot2c_f32_bf16 v130, s35, v77
    v_dot2c_f32_bf16 v131, s76, v77
    v_dot2c_f32_bf16 v132, s35, v78
    v_dot2c_f32_bf16 v133, s76, v78
    v_dot2c_f32_bf16 v134, s35, v79
    v_dot2c_f32_bf16 v135, s76, v79
    s_waitcnt vmcnt(11)
    v_dot2c_f32_bf16 v128, s35, v80
    v_dot2c_f32_bf16 v129, s76, v80
    v_dot2c_f32_bf16 v130, s35, v81
    v_dot2c_f32_bf16 v131, s76, v81
    v_dot2c_f32_bf16 v132, s35, v82
    v_dot2c_f32_bf16 v133, s76, v82
    v_dot2c_f32_bf16 v134, s35, v83
    v_dot2c_f32_bf16 v135, s76, v83
    s_waitcnt vmcnt(10)
    v_dot2c_f32_bf16 v128, s35, v84
    v_dot2c_f32_bf16 v129, s76, v84
    v_dot2c_f32_bf16 v130, s35, v85
    v_dot2c_f32_bf16 v131, s76, v85
    v_dot2c_f32_bf16 v132, s35, v86
    v_dot2c_f32_bf16 v133, s76, v86
    v_dot2c_f32_bf16 v134, s35, v87
    v_dot2c_f32_bf16 v135, s76, v87
    s_waitcnt vmcnt(9)
    v_dot2c_f32_bf16 v128, s35, v88
    v_dot2c_f32_bf16 v129, s76, v88
    v_dot2c_f32_bf16 v130, s35, v89
    v_dot2c_f32_bf16 v131, s76, v89
    v_dot2c_f32_bf16 v132, s35, v90
    v_dot2c_f32_bf16 v133, s76, v90
    v_dot2c_f32_bf16 v134, s35, v91
    v_dot2c_f32_bf16 v135, s76, v91
    s_waitcnt vmcnt(8)
    v_dot2c_f32_bf16 v128, s35, v92
    v_dot2c_f32_bf16 v129, s76, v92
    v_dot2c_f32_bf16 v130, s35, v93
    v_dot2c_f32_bf16 v131, s76, v93
    v_dot2c_f32_bf16 v132, s35, v94
    v_dot2c_f32_bf16 v133, s76, v94
    v_dot2c_f32_bf16 v134, s35, v95
    v_dot2c_f32_bf16 v135, s76, v95
    s_waitcnt vmcnt(7)
    v_dot2c_f32_bf16 v128, s35, v96
    v_dot2c_f32_bf16 v129, s76, v96
    v_dot2c_f32_bf16 v130, s35, v97
    v_dot2c_f32_bf16 v131, s76, v97
    v_dot2c_f32_bf16 v132, s35, v98
    v_dot2c_f32_bf16 v133, s76, v98
    v_dot2c_f32_bf16 v134, s35, v99
    v_dot2c_f32_bf16 v135, s76, v99
    s_waitcnt vmcnt(6)
    v_dot2c_f32_bf16 v128, s35, v100
    v_dot2c_f32_bf16 v129, s76, v100
    v_dot2c_f32_bf16 v130, s35, v101
    v_dot2c_f32_bf16 v131, s76, v101
    v_dot2c_f32_bf16 v132, s35, v102
    v_dot2c_f32_bf16 v133, s76, v102
    v_dot2c_f32_bf16 v134, s35, v103
    v_dot2c_f32_bf16 v135, s76, v103
    s_waitcnt vmcnt(5)
    v_dot2c_f32_bf16 v128, s35, v104
    v_dot2c_f32_bf16 v129, s76, v104
    v_dot2c_f32_bf16 v130, s35, v105
    v_dot2c_f32_bf16 v131, s76, v105
    v_dot2c_f32_bf16 v132, s35, v106
    v_dot2c_f32_bf16 v133, s76, v106
    v_dot2c_f32_bf16 v134, s35, v107
    v_dot2c_f32_bf16 v135, s76, v107
    s_waitcnt vmcnt(4)
    v_dot2c_f32_bf16 v128, s35, v108
    v_dot2c_f32_bf16 v129, s76, v108
    v_dot2c_f32_bf16 v130, s35, v109
    v_dot2c_f32_bf16 v131, s76, v109
    v_dot2c_f32_bf16 v132, s35, v110
    v_dot2c_f32_bf16 v133, s76, v110
    v_dot2c_f32_bf16 v134, s35, v111
    v_dot2c_f32_bf16 v135, s76, v111
    s_waitcnt vmcnt(3)
    v_dot2c_f32_bf16 v128, s35, v112
    v_dot2c_f32_bf16 v129, s76, v112
    v_dot2c_f32_bf16 v130, s35, v113
    v_dot2c_f32_bf16 v131, s76, v113
    v_dot2c_f32_bf16 v132, s35, v114
    v_dot2c_f32_bf16 v133, s76, v114
    v_dot2c_f32_bf16 v134, s35, v115
    v_dot2c_f32_bf16 v135, s76, v115
    s_waitcnt vmcnt(2)
    v_dot2c_f32_bf16 v128, s35, v116
    v_dot2c_f32_bf16 v129, s76, v116
    v_dot2c_f32_bf16 v130, s35, v117
    v_dot2c_f32_bf16 v131, s76, v117
    v_dot2c_f32_bf16 v132, s35, v118
    v_dot2c_f32_bf16 v133, s76, v118
    v_dot2c_f32_bf16 v134, s35, v119
    v_dot2c_f32_bf16 v135, s76, v119
    s_waitcnt vmcnt(1)
    v_dot2c_f32_bf16 v128, s35, v120
    v_dot2c_f32_bf16 v129, s76, v120
    v_dot2c_f32_bf16 v130, s35, v121
    v_dot2c_f32_bf16 v131, s76, v121
    v_dot2c_f32_bf16 v132, s35, v122
    v_dot2c_f32_bf16 v133, s76, v122
    v_dot2c_f32_bf16 v134, s35, v123
    v_dot2c_f32_bf16 v135, s76, v123
    s_waitcnt vmcnt(0)
    v_dot2c_f32_bf16 v128, s35, v124
    v_dot2c_f32_bf16 v129, s76, v124
    v_dot2c_f32_bf16 v130, s35, v125
    v_dot2c_f32_bf16 v131, s76, v125
    v_dot2c_f32_bf16 v132, s35, v126
    v_dot2c_f32_bf16 v133, s76, v126
    v_dot2c_f32_bf16 v134, s35, v127
    v_dot2c_f32_bf16 v135, s76, v127
    s_nop 2
    v_cvt_pk_bf16_f32 v140, v128, v129
    v_cvt_pk_bf16_f32 v141, v130, v131
    v_cvt_pk_bf16_f32 v142, v132, v133
    v_cvt_pk_bf16_f32 v143, v134, v135
    s_nop 0
    v_permlane16_swap_b32 v140, v142
    v_permlane16_swap_b32 v141, v143
    ds_write_b128 v12, v[140:143]
    s_cmp_lg_u32 s43, 0
    s_waitcnt lgkmcnt(0)
    s_barrier
    s_cbranch_scc1 L_exp1_h
    ds_read_b128 v[140:143], v252
    s_waitcnt lgkmcnt(0)
    buffer_store_dwordx4 v[140:143], v251, s[16:19], 0 offen sc1
L_exp1_h:
L_end_h:
    s_endpgm
.p2align 6
L_light:
    s_xor_b32 s60, s59, 0x40000
    s_add_u32 s79, s79, 1
    s_cmp_eq_u32 s79, 7
    s_cselect_b32 s79, 0, s79
    s_lshl_b32 s53, s79, 7
    s_lshl1_add_u32 s35, s79, s34
    s_lshl_b32 s61, s35, 18
    s_xor_b32 s62, s61, 0x40000
    s_add_u32 s79, s79, 1
    s_cmp_eq_u32 s79, 7
    s_cselect_b32 s79, 0, s79
    s_lshl_b32 s54, s79, 7
    s_lshl1_add_u32 s35, s79, s34
    s_lshl_b32 s63, s35, 18
    s_xor_b32 s64, s63, 0x40000
    s_add_u32 s79, s79, 1
    s_cmp_eq_u32 s79, 7
    s_cselect_b32 s79, 0, s79
    s_lshl_b32 s55, s79, 7
    s_lshl1_add_u32 s35, s79, s34
    s_lshl_b32 s65, s35, 18
    s_xor_b32 s66, s65, 0x40000
    s_add_u32 s79, s79, 1
    s_cmp_eq_u32 s79, 7
    s_cselect_b32 s79, 0, s79
    s_lshl_b32 s56, s79, 7
    s_lshl1_add_u32 s35, s79, s34
    s_lshl_b32 s67, s35, 18
    s_xor_b32 s68, s67, 0x40000
    s_add_u32 s79, s79, 1
    s_cmp_eq_u32 s79, 7
    s_cselect_b32 s79, 0, s79
    s_lshl_b32 s57, s79, 7
    s_lshl1_add_u32 s35, s79, s34
    s_lshl_b32 s69, s35, 18
    s_xor_b32 s70, s69, 0x40000
    s_add_u32 s79, s79, 1
    s_cmp_eq_u32 s79, 7
    s_cselect_b32 s79, 0, s79
    s_lshl_b32 s58, s79, 7
    s_lshl1_add_u32 s35, s79, s34
    s_lshl_b32 s71, s35, 18
    s_xor_b32 s72, s71, 0x40000
    s_add_u32 s29, s28, 4096
    s_add_u32 s30, s28, 8192
    s_add_u32 s31, s28, 12288
    s_lshl_b32 s1, s32, 13
    s_and_b32 s0, s1, 0xc000
    s_and_b32 s76, s33, 1
    s_lshl_b32 s76, s76, 12
    s_and_b32 s77, s1, 0x2000
    s_or_b32 s77, s77, s76
    v_add_u32 v30, v41, v43
    v_lshl_add_u32 v43, v38, 9, v43
    s_xor_b32 s35, s77, 0
    s_add_u32 s35, s35, 3072
    v_add_u32 v26, s35, v43
    s_xor_b32 s35, s77, 4096
    s_add_u32 s35, s35, 2048
    v_add_u32 v27, s35, v43
    s_xor_b32 s35, s77, 8192
    s_add_u32 s35, s35, 1024
    v_add_u32 v28, s35, v43
    s_xor_b32 s35, s77, 12288
    s_add_u32 s35, s35, 0
    v_add_u32 v29, s35, v43
    v_lshl_add_u32 v40, v38, 9, v40
    v_lshl_add_u32 v42, v38, 9, v42
    s_xor_b32 s35, s76, 0
    s_add_u32 s35, s35, 3072
    v_add_u32 v22, s35, v40
    s_xor_b32 s35, s76, 4096
    s_add_u32 s35, s35, 2048
    v_add_u32 v23, s35, v42
    s_xor_b32 s35, s76, 0
    s_add_u32 s35, s35, 1152
    v_add_u32 v24, s35, v40
    s_xor_b32 s35, s76, 4096
    s_add_u32 s35, s35, 128
    v_add_u32 v25, s35, v42
    s_lshl4_add_u32 s77, s32, s33
    s_lshl_b32 s35, s77, 18
    s_lshl_b32 s76, s3, 7
    s_add_u32 s76, s35, s76
    s_sub_u32 s40, s40, 3072
    s_subb_u32 s41, s41, 0
    s_add_u32 s12, s40, s76
    s_addc_u32 s13, s41, 0
    s_sub_u32 s14, 33557504, s76
    s_mov_b32 s15, 0x20000
    s_lshl_b32 s76, s3, 16
    s_add_u32 s35, s35, s76
    s_sub_u32 s38, s38, 3072
    s_subb_u32 s39, s39, 0
    s_add_u32 s8, s38, s35
    s_addc_u32 s9, s39, 0
    s_sub_u32 s10, 33557504, s35
    s_mov_b32 s11, 0x20000
    s_lshl3_add_u32 s35, s33, s3
    s_mul_i32 s35, s35, 28672
    s_add_u32 s20, s44, s35
    s_addc_u32 s21, s45, 0
    s_sub_u32 s22, 3670016, s35
    s_mov_b32 s23, 0x20000
    s_mul_i32 s35, s77, 131072
    s_add_u32 s24, s50, s35
    s_addc_u32 s25, s51, 0
    s_sub_u32 s26, 268435456, s35
    s_mov_b32 s27, 0x20000
    s_lshl_b32 s38, s3, 9
    s_add_u32 s38, s38, 8192
    s_lshl2_add_u32 s35, s2, s3
    s_cmp_eq_u32 s35, 32
    s_cbranch_scc1 L_tag0
L_tag0done:
    v_add_u32 v31, 6144, v30
    v_add_u32 v32, 12288, v30
    v_add_u32 v33, 18432, v30
    v_lshrrev_b32 v41, 4, v0
    v_and_b32 v42, 15, v0
    v_lshrrev_b32 v38, 2, v0
    v_and_b32 v39, 6, v38
    v_bfe_u32 v40, v0, 1, 1
    v_or_b32 v39, v39, v40
    v_lshlrev_b32 v39, 4, v39
    v_lshl_add_u32 v39, v38, 7, v39
    v_and_b32 v40, 1, v0
    v_lshl_add_u32 v39, v40, 3, v39
    v_xor_b32 v40, 0, v39
    v_add_u32 v1, s28, v40
    v_xor_b32 v40, 32, v39
    v_add_u32 v2, s28, v40
    v_xor_b32 v40, 64, v39
    v_add_u32 v3, s28, v40
    v_xor_b32 v40, 96, v39
    v_add_u32 v4, s28, v40
    s_lshl_b32 s35, s3, 5
    v_xor_b32 v40, s35, v39
    v_add_u32 v5, 94208, v40
    v_add_u32 v255, 40960, v40
    v_lshrrev_b32 v38, 1, v42
    v_xor_b32 v38, v38, v41
    v_lshlrev_b32 v38, 4, v38
    v_lshl_add_u32 v8, v42, 7, v38
    v_xor_b32 v9, 64, v8
    v_add_u32 v6, s28, v8
    v_add_u32 v7, s28, v9
    v_lshlrev_b32 v10, 4, v0
    v_add_u32 v11, 49152, v10
    v_lshrrev_b32 v38, 1, v41
    v_lshl_add_u32 v38, v38, 4, v42
    v_lshlrev_b32 v38, 4, v38
    v_and_b32 v39, 1, v41
    v_lshl_add_u32 v38, v39, 3, v38
    s_mul_i32 s35, s3, 8192
    v_add_u32 v12, s35, v38
    v_add_u32 v17, s35, v10
    s_mul_i32 s35, s3, 4096
    v_add_u32 v15, s35, v10
    v_add_u32 v16, s35, v11
    v_lshlrev_b32 v38, 4, v42
    v_add_u32 v14, 90112, v38
    s_lshl_b32 s35, s3, 2
    v_add_u32 v13, s35, v14
    v_mov_b32 v44, 0x3f803f80
    v_mov_b32 v45, 0x3f803f80
    v_mov_b32 v46, 0x3f803f80
    v_mov_b32 v47, 0x3f803f80
    s_mov_b32 s74, 0x3db8aa3b
    s_mov_b32 s75, 0x3db8aa3b
    s_mov_b32 s39, 0
    s_waitcnt vmcnt(0)
    s_barrier
    ds_read_b128 v[160:163], v9 offset:0
    ds_read_b128 v[164:167], v9 offset:2048
    ds_read_b128 v[168:171], v9 offset:4096
    ds_read_b128 v[172:175], v9 offset:6144
    ds_read_b64_tr_b16 v[128:129], v1 offset:0
    ds_read_b64_tr_b16 v[130:131], v1 offset:2048
    ds_read_b64_tr_b16 v[132:133], v2 offset:0
    ds_read_b64_tr_b16 v[134:135], v2 offset:2048
    ds_read_b64_tr_b16 v[136:137], v3 offset:0
    ds_read_b64_tr_b16 v[138:139], v3 offset:2048
    ds_read_b64_tr_b16 v[140:141], v4 offset:0
    ds_read_b64_tr_b16 v[142:143], v4 offset:2048
    s_mov_b32 m0, s29
    s_nop 0
    buffer_load_dwordx4 v18, s[16:19], s60 offen offset:0  lds
    buffer_load_dwordx4 v19, s[16:19], s60 offen offset:1024  lds
    buffer_load_dwordx4 v20, s[16:19], s60 offen offset:2048  lds
    buffer_load_dwordx4 v21, s[16:19], s60 offen offset:3072  lds
    s_add_u32 m0, s37, 8192
    s_nop 0
    buffer_load_dwordx4 v34, s[4:7], s53 offen  lds
    buffer_load_dwordx4 v35, s[4:7], s53 offen offset:1024  lds
    s_mov_b32 m0, s30
    s_nop 0
    buffer_load_dwordx4 v18, s[16:19], s61 offen offset:0  lds
    buffer_load_dwordx4 v19, s[16:19], s61 offen offset:1024  lds
    buffer_load_dwordx4 v20, s[16:19], s61 offen offset:2048  lds
    buffer_load_dwordx4 v21, s[16:19], s61 offen offset:3072  lds
    s_waitcnt lgkmcnt(0)
    v_mfma_f32_16x16x32_bf16 v[48:51], v[128:131], v[160:163], 0
    s_mov_b32 m0, s31
    ds_read_b128 v[180:183], v8 offset:0
    ds_read_b128 v[184:187], v8 offset:2048
    v_mfma_f32_16x16x32_bf16 v[64:67], v[132:135], v[160:163], 0
    buffer_load_dwordx4 v18, s[16:19], s62 offen offset:0  lds
    ds_read_b128 v[188:191], v8 offset:4096
    v_mfma_f32_16x16x32_bf16 v[80:83], v[136:139], v[160:163], 0
    buffer_load_dwordx4 v19, s[16:19], s62 offen offset:1024  lds
    ds_read_b128 v[192:195], v8 offset:6144
    v_mfma_f32_16x16x32_bf16 v[96:99], v[140:143], v[160:163], 0
    v_mfma_f32_16x16x32_bf16 v[100:103], v[140:143], v[164:167], 0
    s_waitcnt vmcnt(8)
    buffer_load_dwordx4 v20, s[16:19], s62 offen offset:2048  lds
    ds_read_b64_tr_b16 v[144:145], v1 offset:4096
    v_mfma_f32_16x16x32_bf16 v[84:87], v[136:139], v[164:167], 0
    buffer_load_dwordx4 v21, s[16:19], s62 offen offset:3072  lds
    ds_read_b64_tr_b16 v[146:147], v1 offset:6144
    v_mfma_f32_16x16x32_bf16 v[68:71], v[132:135], v[164:167], 0
    s_add_u32 m0, s37, 16384
    ds_read_b64_tr_b16 v[148:149], v2 offset:4096
    ds_read_b64_tr_b16 v[150:151], v2 offset:6144
    v_mfma_f32_16x16x32_bf16 v[52:55], v[128:131], v[164:167], 0
    buffer_load_dwordx4 v34, s[4:7], s54 offen  lds
    ds_read_b64_tr_b16 v[152:153], v3 offset:4096
    v_mfma_f32_16x16x32_bf16 v[56:59], v[128:131], v[168:171], 0
    buffer_load_dwordx4 v35, s[4:7], s54 offen offset:1024  lds
    ds_read_b64_tr_b16 v[154:155], v3 offset:6144
    v_mfma_f32_16x16x32_bf16 v[72:75], v[132:135], v[168:171], 0
    s_mov_b32 m0, s28
    ds_read_b64_tr_b16 v[156:157], v4 offset:4096
    ds_read_b64_tr_b16 v[158:159], v4 offset:6144
    v_mfma_f32_16x16x32_bf16 v[88:91], v[136:139], v[168:171], 0
    buffer_load_dwordx4 v18, s[16:19], s63 offen offset:0  lds
    v_mfma_f32_16x16x32_bf16 v[104:107], v[140:143], v[168:171], 0
    buffer_load_dwordx4 v19, s[16:19], s63 offen offset:1024  lds
    v_mfma_f32_16x16x32_bf16 v[108:111], v[140:143], v[172:175], 0
    v_mfma_f32_16x16x32_bf16 v[92:95], v[136:139], v[172:175], 0
    buffer_load_dwordx4 v20, s[16:19], s63 offen offset:2048  lds
    v_mfma_f32_16x16x32_bf16 v[76:79], v[132:135], v[172:175], 0
    buffer_load_dwordx4 v21, s[16:19], s63 offen offset:3072  lds
    v_mfma_f32_16x16x32_bf16 v[60:63], v[128:131], v[172:175], 0
    s_waitcnt lgkmcnt(0)
    v_mfma_f32_16x16x32_bf16 v[48:51], v[144:147], v[180:183], v[48:51]
    s_mov_b32 m0, s29
    v_mfma_f32_16x16x32_bf16 v[64:67], v[148:151], v[180:183], v[64:67]
    s_waitcnt vmcnt(10)
    s_barrier
    buffer_load_dwordx4 v18, s[16:19], s64 offen offset:0  lds
    v_mfma_f32_16x16x32_bf16 v[80:83], v[152:155], v[180:183], v[80:83]
    ds_read_b128 v[160:163], v9 offset:8192
    ds_read_b128 v[164:167], v9 offset:10240
    v_mfma_f32_16x16x32_bf16 v[96:99], v[156:159], v[180:183], v[96:99]
    ds_read_b128 v[168:171], v9 offset:12288
    ds_read_b128 v[172:175], v9 offset:14336
    v_mfma_f32_16x16x32_bf16 v[100:103], v[156:159], v[184:187], v[100:103]
    buffer_load_dwordx4 v19, s[16:19], s64 offen offset:1024  lds
    ds_read_b64_tr_b16 v[128:129], v1 offset:8192
    v_mfma_f32_16x16x32_bf16 v[84:87], v[152:155], v[184:187], v[84:87]
    ds_read_b64_tr_b16 v[130:131], v1 offset:10240
    ds_read_b64_tr_b16 v[132:133], v2 offset:8192
    v_mfma_f32_16x16x32_bf16 v[68:71], v[148:151], v[184:187], v[68:71]
    ds_read_b64_tr_b16 v[134:135], v2 offset:10240
    ds_read_b64_tr_b16 v[136:137], v3 offset:8192
    v_mfma_f32_16x16x32_bf16 v[52:55], v[144:147], v[184:187], v[52:55]
    ds_read_b64_tr_b16 v[138:139], v3 offset:10240
    ds_read_b64_tr_b16 v[140:141], v4 offset:8192
    v_mfma_f32_16x16x32_bf16 v[56:59], v[144:147], v[188:191], v[56:59]
    buffer_load_dwordx4 v20, s[16:19], s64 offen offset:2048  lds
    ds_read_b64_tr_b16 v[142:143], v4 offset:10240
    v_mfma_f32_16x16x32_bf16 v[72:75], v[148:151], v[188:191], v[72:75]
    v_mfma_f32_16x16x32_bf16 v[88:91], v[152:155], v[188:191], v[88:91]
    v_mfma_f32_16x16x32_bf16 v[104:107], v[156:159], v[188:191], v[104:107]
    v_mfma_f32_16x16x32_bf16 v[108:111], v[156:159], v[192:195], v[108:111]
    buffer_load_dwordx4 v21, s[16:19], s64 offen offset:3072  lds
    v_mfma_f32_16x16x32_bf16 v[92:95], v[152:155], v[192:195], v[92:95]
    v_mfma_f32_16x16x32_bf16 v[76:79], v[148:151], v[192:195], v[76:79]
    v_mfma_f32_16x16x32_bf16 v[60:63], v[144:147], v[192:195], v[60:63]
    s_waitcnt lgkmcnt(0)
    v_mfma_f32_16x16x32_bf16 v[48:51], v[128:131], v[160:163], v[48:51]
    s_add_u32 m0, s37, 24576
    ds_read_b128 v[180:183], v8 offset:8192
    ds_read_b128 v[184:187], v8 offset:10240
    v_mfma_f32_16x16x32_bf16 v[64:67], v[132:135], v[160:163], v[64:67]
    buffer_load_dwordx4 v34, s[4:7], s55 offen  lds
    ds_read_b128 v[188:191], v8 offset:12288
    v_mfma_f32_16x16x32_bf16 v[80:83], v[136:139], v[160:163], v[80:83]
    ds_read_b128 v[192:195], v8 offset:14336
    v_mfma_f32_16x16x32_bf16 v[96:99], v[140:143], v[160:163], v[96:99]
    buffer_load_dwordx4 v35, s[4:7], s55 offen offset:1024  lds
    v_mfma_f32_16x16x32_bf16 v[100:103], v[140:143], v[164:167], v[100:103]
    s_waitcnt vmcnt(12)
    ds_read_b64_tr_b16 v[144:145], v1 offset:12288
    ds_read_b64_tr_b16 v[146:147], v1 offset:14336
    v_mfma_f32_16x16x32_bf16 v[84:87], v[136:139], v[164:167], v[84:87]
    s_mov_b32 m0, s30
    ds_read_b64_tr_b16 v[148:149], v2 offset:12288
    ds_read_b64_tr_b16 v[150:151], v2 offset:14336
    v_mfma_f32_16x16x32_bf16 v[68:71], v[132:135], v[164:167], v[68:71]
    buffer_load_dwordx4 v18, s[16:19], s65 offen offset:0  lds
    ds_read_b64_tr_b16 v[152:153], v3 offset:12288
    v_mfma_f32_16x16x32_bf16 v[52:55], v[128:131], v[164:167], v[52:55]
    ds_read_b64_tr_b16 v[154:155], v3 offset:14336
    ds_read_b64_tr_b16 v[156:157], v4 offset:12288
    v_mfma_f32_16x16x32_bf16 v[56:59], v[128:131], v[168:171], v[56:59]
    buffer_load_dwordx4 v19, s[16:19], s65 offen offset:1024  lds
    ds_read_b64_tr_b16 v[158:159], v4 offset:14336
    v_mfma_f32_16x16x32_bf16 v[72:75], v[132:135], v[168:171], v[72:75]
    v_mfma_f32_16x16x32_bf16 v[88:91], v[136:139], v[168:171], v[88:91]
    v_mfma_f32_16x16x32_bf16 v[104:107], v[140:143], v[168:171], v[104:107]
    buffer_load_dwordx4 v20, s[16:19], s65 offen offset:2048  lds
    v_mfma_f32_16x16x32_bf16 v[108:111], v[140:143], v[172:175], v[108:111]
    v_mfma_f32_16x16x32_bf16 v[92:95], v[136:139], v[172:175], v[92:95]
    buffer_load_dwordx4 v21, s[16:19], s65 offen offset:3072  lds
    v_mfma_f32_16x16x32_bf16 v[76:79], v[132:135], v[172:175], v[76:79]
    v_mfma_f32_16x16x32_bf16 v[60:63], v[128:131], v[172:175], v[60:63]
    s_waitcnt lgkmcnt(0)
    v_mfma_f32_16x16x32_bf16 v[48:51], v[144:147], v[180:183], v[48:51]
    s_mov_b32 m0, s31
    v_mfma_f32_16x16x32_bf16 v[64:67], v[148:151], v[180:183], v[64:67]
    s_waitcnt vmcnt(10)
    s_barrier
    buffer_load_dwordx4 v18, s[16:19], s66 offen offset:0  lds
    v_mfma_f32_16x16x32_bf16 v[80:83], v[152:155], v[180:183], v[80:83]
    ds_read_b128 v[160:163], v9 offset:16384
    ds_read_b128 v[164:167], v9 offset:18432
    v_mfma_f32_16x16x32_bf16 v[96:99], v[156:159], v[180:183], v[96:99]
    ds_read_b128 v[168:171], v9 offset:20480
    ds_read_b128 v[172:175], v9 offset:22528
    v_mfma_f32_16x16x32_bf16 v[100:103], v[156:159], v[184:187], v[100:103]
    buffer_load_dwordx4 v19, s[16:19], s66 offen offset:1024  lds
    ds_read_b64_tr_b16 v[128:129], v1 offset:0
    v_mfma_f32_16x16x32_bf16 v[84:87], v[152:155], v[184:187], v[84:87]
    ds_read_b64_tr_b16 v[130:131], v1 offset:2048
    ds_read_b64_tr_b16 v[132:133], v2 offset:0
    v_mfma_f32_16x16x32_bf16 v[68:71], v[148:151], v[184:187], v[68:71]
    ds_read_b64_tr_b16 v[134:135], v2 offset:2048
    ds_read_b64_tr_b16 v[136:137], v3 offset:0
    v_mfma_f32_16x16x32_bf16 v[52:55], v[144:147], v[184:187], v[52:55]
    ds_read_b64_tr_b16 v[138:139], v3 offset:2048
    ds_read_b64_tr_b16 v[140:141], v4 offset:0
    v_mfma_f32_16x16x32_bf16 v[56:59], v[144:147], v[188:191], v[56:59]
    buffer_load_dwordx4 v20, s[16:19], s66 offen offset:2048  lds
    ds_read_b64_tr_b16 v[142:143], v4 offset:2048
    v_mfma_f32_16x16x32_bf16 v[72:75], v[148:151], v[188:191], v[72:75]
    v_mfma_f32_16x16x32_bf16 v[88:91], v[152:155], v[188:191], v[88:91]
    v_mfma_f32_16x16x32_bf16 v[104:107], v[156:159], v[188:191], v[104:107]
    v_mfma_f32_16x16x32_bf16 v[108:111], v[156:159], v[192:195], v[108:111]
    buffer_load_dwordx4 v21, s[16:19], s66 offen offset:3072  lds
    v_mfma_f32_16x16x32_bf16 v[92:95], v[152:155], v[192:195], v[92:95]
    v_mfma_f32_16x16x32_bf16 v[76:79], v[148:151], v[192:195], v[76:79]
    v_mfma_f32_16x16x32_bf16 v[60:63], v[144:147], v[192:195], v[60:63]
    s_lshl2_add_u32 s35, s2, s3
    s_cmp_eq_u32 s35, 32
    s_waitcnt lgkmcnt(0)
    s_cbranch_scc1 L_tag
L_tagdone:
    v_mfma_f32_16x16x32_bf16 v[48:51], v[128:131], v[160:163], v[48:51]
    s_add_u32 m0, s37, 32768
    ds_read_b128 v[180:183], v8 offset:16384
    ds_read_b128 v[184:187], v8 offset:18432
    v_mfma_f32_16x16x32_bf16 v[64:67], v[132:135], v[160:163], v[64:67]
    buffer_load_dwordx4 v34, s[4:7], s56 offen  lds
    ds_read_b128 v[188:191], v8 offset:20480
    v_mfma_f32_16x16x32_bf16 v[80:83], v[136:139], v[160:163], v[80:83]
    ds_read_b128 v[192:195], v8 offset:22528
    v_mfma_f32_16x16x32_bf16 v[96:99], v[140:143], v[160:163], v[96:99]
    buffer_load_dwordx4 v35, s[4:7], s56 offen offset:1024  lds
    v_mfma_f32_16x16x32_bf16 v[100:103], v[140:143], v[164:167], v[100:103]
    s_waitcnt vmcnt(12)
    ds_read_b64_tr_b16 v[144:145], v1 offset:4096
    ds_read_b64_tr_b16 v[146:147], v1 offset:6144
    v_mfma_f32_16x16x32_bf16 v[84:87], v[136:139], v[164:167], v[84:87]
    s_mov_b32 m0, s28
    ds_read_b64_tr_b16 v[148:149], v2 offset:4096
    ds_read_b64_tr_b16 v[150:151], v2 offset:6144
    v_mfma_f32_16x16x32_bf16 v[68:71], v[132:135], v[164:167], v[68:71]
    buffer_load_dwordx4 v18, s[16:19], s67 offen offset:0  lds
    ds_read_b64_tr_b16 v[152:153], v3 offset:4096
    v_mfma_f32_16x16x32_bf16 v[52:55], v[128:131], v[164:167], v[52:55]
    ds_read_b64_tr_b16 v[154:155], v3 offset:6144
    ds_read_b64_tr_b16 v[156:157], v4 offset:4096
    v_mfma_f32_16x16x32_bf16 v[56:59], v[128:131], v[168:171], v[56:59]
    buffer_load_dwordx4 v19, s[16:19], s67 offen offset:1024  lds
    ds_read_b64_tr_b16 v[158:159], v4 offset:6144
    v_mfma_f32_16x16x32_bf16 v[72:75], v[132:135], v[168:171], v[72:75]
    v_mfma_f32_16x16x32_bf16 v[88:91], v[136:139], v[168:171], v[88:91]
    v_mfma_f32_16x16x32_bf16 v[104:107], v[140:143], v[168:171], v[104:107]
    buffer_load_dwordx4 v20, s[16:19], s67 offen offset:2048  lds
    v_mfma_f32_16x16x32_bf16 v[108:111], v[140:143], v[172:175], v[108:111]
    v_mfma_f32_16x16x32_bf16 v[92:95], v[136:139], v[172:175], v[92:95]
    buffer_load_dwordx4 v21, s[16:19], s67 offen offset:3072  lds
    v_mfma_f32_16x16x32_bf16 v[76:79], v[132:135], v[172:175], v[76:79]
    v_mfma_f32_16x16x32_bf16 v[60:63], v[128:131], v[172:175], v[60:63]
    s_waitcnt lgkmcnt(0)
    v_mfma_f32_16x16x32_bf16 v[48:51], v[144:147], v[180:183], v[48:51]
    s_mov_b32 m0, s29
    v_mfma_f32_16x16x32_bf16 v[64:67], v[148:151], v[180:183], v[64:67]
    s_waitcnt vmcnt(10)
    s_barrier
    buffer_load_dwordx4 v18, s[16:19], s68 offen offset:0  lds
    v_mfma_f32_16x16x32_bf16 v[80:83], v[152:155], v[180:183], v[80:83]
    ds_read_b128 v[160:163], v9 offset:24576
    ds_read_b128 v[164:167], v9 offset:26624
    v_mfma_f32_16x16x32_bf16 v[96:99], v[156:159], v[180:183], v[96:99]
    ds_read_b128 v[168:171], v9 offset:28672
    ds_read_b128 v[172:175], v9 offset:30720
    v_mfma_f32_16x16x32_bf16 v[100:103], v[156:159], v[184:187], v[100:103]
    buffer_load_dwordx4 v19, s[16:19], s68 offen offset:1024  lds
    ds_read_b64_tr_b16 v[128:129], v1 offset:8192
    v_mfma_f32_16x16x32_bf16 v[84:87], v[152:155], v[184:187], v[84:87]
    ds_read_b64_tr_b16 v[130:131], v1 offset:10240
    ds_read_b64_tr_b16 v[132:133], v2 offset:8192
    v_mfma_f32_16x16x32_bf16 v[68:71], v[148:151], v[184:187], v[68:71]
    ds_read_b64_tr_b16 v[134:135], v2 offset:10240
    ds_read_b64_tr_b16 v[136:137], v3 offset:8192
    v_mfma_f32_16x16x32_bf16 v[52:55], v[144:147], v[184:187], v[52:55]
    ds_read_b64_tr_b16 v[138:139], v3 offset:10240
    ds_read_b64_tr_b16 v[140:141], v4 offset:8192
    v_mfma_f32_16x16x32_bf16 v[56:59], v[144:147], v[188:191], v[56:59]
    buffer_load_dwordx4 v20, s[16:19], s68 offen offset:2048  lds
    ds_read_b64_tr_b16 v[142:143], v4 offset:10240
    v_mfma_f32_16x16x32_bf16 v[72:75], v[148:151], v[188:191], v[72:75]
    v_mfma_f32_16x16x32_bf16 v[88:91], v[152:155], v[188:191], v[88:91]
    v_mfma_f32_16x16x32_bf16 v[104:107], v[156:159], v[188:191], v[104:107]
    v_mfma_f32_16x16x32_bf16 v[108:111], v[156:159], v[192:195], v[108:111]
    buffer_load_dwordx4 v21, s[16:19], s68 offen offset:3072  lds
    v_mfma_f32_16x16x32_bf16 v[92:95], v[152:155], v[192:195], v[92:95]
    v_mfma_f32_16x16x32_bf16 v[76:79], v[148:151], v[192:195], v[76:79]
    v_mfma_f32_16x16x32_bf16 v[60:63], v[144:147], v[192:195], v[60:63]
    s_waitcnt lgkmcnt(0)
    v_mfma_f32_16x16x32_bf16 v[48:51], v[128:131], v[160:163], v[48:51]
    s_add_u32 m0, s37, 40960
    ds_read_b128 v[180:183], v8 offset:24576
    ds_read_b128 v[184:187], v8 offset:26624
    v_mfma_f32_16x16x32_bf16 v[64:67], v[132:135], v[160:163], v[64:67]
    buffer_load_dwordx4 v34, s[4:7], s57 offen  lds
    ds_read_b128 v[188:191], v8 offset:28672
    v_mfma_f32_16x16x32_bf16 v[80:83], v[136:139], v[160:163], v[80:83]
    ds_read_b128 v[192:195], v8 offset:30720
    v_mfma_f32_16x16x32_bf16 v[96:99], v[140:143], v[160:163], v[96:99]
    buffer_load_dwordx4 v35, s[4:7], s57 offen offset:1024  lds
    v_mfma_f32_16x16x32_bf16 v[100:103], v[140:143], v[164:167], v[100:103]
    s_waitcnt vmcnt(12)
    ds_read_b64_tr_b16 v[144:145], v1 offset:12288
    ds_read_b64_tr_b16 v[146:147], v1 offset:14336
    v_mfma_f32_16x16x32_bf16 v[84:87], v[136:139], v[164:167], v[84:87]
    s_mov_b32 m0, s30
    ds_read_b64_tr_b16 v[148:149], v2 offset:12288
    ds_read_b64_tr_b16 v[150:151], v2 offset:14336
    v_mfma_f32_16x16x32_bf16 v[68:71], v[132:135], v[164:167], v[68:71]
    buffer_load_dwordx4 v18, s[16:19], s69 offen offset:0  lds
    ds_read_b64_tr_b16 v[152:153], v3 offset:12288
    v_mfma_f32_16x16x32_bf16 v[52:55], v[128:131], v[164:167], v[52:55]
    ds_read_b64_tr_b16 v[154:155], v3 offset:14336
    ds_read_b64_tr_b16 v[156:157], v4 offset:12288
    v_mfma_f32_16x16x32_bf16 v[56:59], v[128:131], v[168:171], v[56:59]
    buffer_load_dwordx4 v19, s[16:19], s69 offen offset:1024  lds
    ds_read_b64_tr_b16 v[158:159], v4 offset:14336
    v_mfma_f32_16x16x32_bf16 v[72:75], v[132:135], v[168:171], v[72:75]
    v_mfma_f32_16x16x32_bf16 v[88:91], v[136:139], v[168:171], v[88:91]
    v_mfma_f32_16x16x32_bf16 v[104:107], v[140:143], v[168:171], v[104:107]
    buffer_load_dwordx4 v20, s[16:19], s69 offen offset:2048  lds
    v_mfma_f32_16x16x32_bf16 v[108:111], v[140:143], v[172:175], v[108:111]
    v_mfma_f32_16x16x32_bf16 v[92:95], v[136:139], v[172:175], v[92:95]
    buffer_load_dwordx4 v21, s[16:19], s69 offen offset:3072  lds
    v_mfma_f32_16x16x32_bf16 v[76:79], v[132:135], v[172:175], v[76:79]
    v_mfma_f32_16x16x32_bf16 v[60:63], v[128:131], v[172:175], v[60:63]
    s_waitcnt lgkmcnt(0)
    v_mfma_f32_16x16x32_bf16 v[48:51], v[144:147], v[180:183], v[48:51]
    s_mov_b32 m0, s31
    v_mfma_f32_16x16x32_bf16 v[64:67], v[148:151], v[180:183], v[64:67]
    s_waitcnt vmcnt(10)
    s_barrier
    buffer_load_dwordx4 v18, s[16:19], s70 offen offset:0  lds
    v_mfma_f32_16x16x32_bf16 v[80:83], v[152:155], v[180:183], v[80:83]
    v_add_u32 v8, 32768, v8
    v_add_u32 v9, 32768, v9
    v_mfma_f32_16x16x32_bf16 v[96:99], v[156:159], v[180:183], v[96:99]
    ds_read_b128 v[160:163], v9 offset:0
    ds_read_b128 v[164:167], v9 offset:2048
    v_mfma_f32_16x16x32_bf16 v[100:103], v[156:159], v[184:187], v[100:103]
    buffer_load_dwordx4 v19, s[16:19], s70 offen offset:1024  lds
    ds_read_b128 v[168:171], v9 offset:4096
    v_mfma_f32_16x16x32_bf16 v[84:87], v[152:155], v[184:187], v[84:87]
    ds_read_b128 v[172:175], v9 offset:6144
    ds_read_b64_tr_b16 v[128:129], v1 offset:0
    v_mfma_f32_16x16x32_bf16 v[68:71], v[148:151], v[184:187], v[68:71]
    ds_read_b64_tr_b16 v[130:131], v1 offset:2048
    ds_read_b64_tr_b16 v[132:133], v2 offset:0
    v_mfma_f32_16x16x32_bf16 v[52:55], v[144:147], v[184:187], v[52:55]
    ds_read_b64_tr_b16 v[134:135], v2 offset:2048
    ds_read_b64_tr_b16 v[136:137], v3 offset:0
    v_mfma_f32_16x16x32_bf16 v[56:59], v[144:147], v[188:191], v[56:59]
    buffer_load_dwordx4 v20, s[16:19], s70 offen offset:2048  lds
    ds_read_b64_tr_b16 v[138:139], v3 offset:2048
    v_mfma_f32_16x16x32_bf16 v[72:75], v[148:151], v[188:191], v[72:75]
    ds_read_b64_tr_b16 v[140:141], v4 offset:0
    ds_read_b64_tr_b16 v[142:143], v4 offset:2048
    v_mfma_f32_16x16x32_bf16 v[88:91], v[152:155], v[188:191], v[88:91]
    v_mfma_f32_16x16x32_bf16 v[104:107], v[156:159], v[188:191], v[104:107]
    v_mfma_f32_16x16x32_bf16 v[108:111], v[156:159], v[192:195], v[108:111]
    buffer_load_dwordx4 v21, s[16:19], s70 offen offset:3072  lds
    v_mfma_f32_16x16x32_bf16 v[92:95], v[152:155], v[192:195], v[92:95]
    v_mfma_f32_16x16x32_bf16 v[76:79], v[148:151], v[192:195], v[76:79]
    v_mfma_f32_16x16x32_bf16 v[60:63], v[144:147], v[192:195], v[60:63]
    s_waitcnt lgkmcnt(0)
    v_mfma_f32_16x16x32_bf16 v[48:51], v[128:131], v[160:163], v[48:51]
    s_add_u32 m0, s37, 49152
    ds_read_b128 v[180:183], v8 offset:0
    ds_read_b128 v[184:187], v8 offset:2048
    v_mfma_f32_16x16x32_bf16 v[64:67], v[132:135], v[160:163], v[64:67]
    buffer_load_dwordx4 v34, s[4:7], s58 offen  lds
    ds_read_b128 v[188:191], v8 offset:4096
    v_mfma_f32_16x16x32_bf16 v[80:83], v[136:139], v[160:163], v[80:83]
    ds_read_b128 v[192:195], v8 offset:6144
    v_mfma_f32_16x16x32_bf16 v[96:99], v[140:143], v[160:163], v[96:99]
    buffer_load_dwordx4 v35, s[4:7], s58 offen offset:1024  lds
    v_mfma_f32_16x16x32_bf16 v[100:103], v[140:143], v[164:167], v[100:103]
    s_waitcnt vmcnt(12)
    ds_read_b64_tr_b16 v[144:145], v1 offset:4096
    ds_read_b64_tr_b16 v[146:147], v1 offset:6144
    v_mfma_f32_16x16x32_bf16 v[84:87], v[136:139], v[164:167], v[84:87]
    s_mov_b32 m0, s28
    ds_read_b64_tr_b16 v[148:149], v2 offset:4096
    ds_read_b64_tr_b16 v[150:151], v2 offset:6144
    v_mfma_f32_16x16x32_bf16 v[68:71], v[132:135], v[164:167], v[68:71]
    buffer_load_dwordx4 v18, s[16:19], s71 offen offset:0  lds
    ds_read_b64_tr_b16 v[152:153], v3 offset:4096
    v_mfma_f32_16x16x32_bf16 v[52:55], v[128:131], v[164:167], v[52:55]
    ds_read_b64_tr_b16 v[154:155], v3 offset:6144
    ds_read_b64_tr_b16 v[156:157], v4 offset:4096
    v_mfma_f32_16x16x32_bf16 v[56:59], v[128:131], v[168:171], v[56:59]
    buffer_load_dwordx4 v19, s[16:19], s71 offen offset:1024  lds
    ds_read_b64_tr_b16 v[158:159], v4 offset:6144
    v_mfma_f32_16x16x32_bf16 v[72:75], v[132:135], v[168:171], v[72:75]
    v_mfma_f32_16x16x32_bf16 v[88:91], v[136:139], v[168:171], v[88:91]
    v_mfma_f32_16x16x32_bf16 v[104:107], v[140:143], v[168:171], v[104:107]
    buffer_load_dwordx4 v20, s[16:19], s71 offen offset:2048  lds
    v_mfma_f32_16x16x32_bf16 v[108:111], v[140:143], v[172:175], v[108:111]
    v_mfma_f32_16x16x32_bf16 v[92:95], v[136:139], v[172:175], v[92:95]
    buffer_load_dwordx4 v21, s[16:19], s71 offen offset:3072  lds
    v_mfma_f32_16x16x32_bf16 v[76:79], v[132:135], v[172:175], v[76:79]
    v_mfma_f32_16x16x32_bf16 v[60:63], v[128:131], v[172:175], v[60:63]
    s_waitcnt lgkmcnt(0)
    v_mfma_f32_16x16x32_bf16 v[48:51], v[144:147], v[180:183], v[48:51]
    s_mov_b32 m0, s29
    v_mfma_f32_16x16x32_bf16 v[64:67], v[148:151], v[180:183], v[64:67]
    s_waitcnt vmcnt(10)
    s_barrier
    buffer_load_dwordx4 v18, s[16:19], s72 offen offset:0  lds
    v_mfma_f32_16x16x32_bf16 v[80:83], v[152:155], v[180:183], v[80:83]
    ds_read_b128 v[160:163], v9 offset:8192
    ds_read_b128 v[164:167], v9 offset:10240
    v_mfma_f32_16x16x32_bf16 v[96:99], v[156:159], v[180:183], v[96:99]
    ds_read_b128 v[168:171], v9 offset:12288
    ds_read_b128 v[172:175], v9 offset:14336
    v_mfma_f32_16x16x32_bf16 v[100:103], v[156:159], v[184:187], v[100:103]
    buffer_load_dwordx4 v19, s[16:19], s72 offen offset:1024  lds
    ds_read_b64_tr_b16 v[128:129], v1 offset:8192
    v_mfma_f32_16x16x32_bf16 v[84:87], v[152:155], v[184:187], v[84:87]
    ds_read_b64_tr_b16 v[130:131], v1 offset:10240
    ds_read_b64_tr_b16 v[132:133], v2 offset:8192
    v_mfma_f32_16x16x32_bf16 v[68:71], v[148:151], v[184:187], v[68:71]
    ds_read_b64_tr_b16 v[134:135], v2 offset:10240
    ds_read_b64_tr_b16 v[136:137], v3 offset:8192
    v_mfma_f32_16x16x32_bf16 v[52:55], v[144:147], v[184:187], v[52:55]
    ds_read_b64_tr_b16 v[138:139], v3 offset:10240
    ds_read_b64_tr_b16 v[140:141], v4 offset:8192
    v_mfma_f32_16x16x32_bf16 v[56:59], v[144:147], v[188:191], v[56:59]
    buffer_load_dwordx4 v20, s[16:19], s72 offen offset:2048  lds
    ds_read_b64_tr_b16 v[142:143], v4 offset:10240
    v_mfma_f32_16x16x32_bf16 v[72:75], v[148:151], v[188:191], v[72:75]
    v_mfma_f32_16x16x32_bf16 v[88:91], v[152:155], v[188:191], v[88:91]
    v_mfma_f32_16x16x32_bf16 v[104:107], v[156:159], v[188:191], v[104:107]
    v_mfma_f32_16x16x32_bf16 v[108:111], v[156:159], v[192:195], v[108:111]
    buffer_load_dwordx4 v21, s[16:19], s72 offen offset:3072  lds
    v_mfma_f32_16x16x32_bf16 v[92:95], v[152:155], v[192:195], v[92:95]
    v_mfma_f32_16x16x32_bf16 v[76:79], v[148:151], v[192:195], v[76:79]
    v_mfma_f32_16x16x32_bf16 v[60:63], v[144:147], v[192:195], v[60:63]
    s_waitcnt lgkmcnt(0)
    v_mfma_f32_16x16x32_bf16 v[48:51], v[128:131], v[160:163], v[48:51]
    s_xor_b32 s36, s1, 0
    s_mov_b32 m0, s30
    ds_read_b128 v[180:183], v8 offset:8192
    v_mfma_f32_16x16x32_bf16 v[64:67], v[132:135], v[160:163], v[64:67]
    buffer_load_dwordx4 v22, s[8:11], s36 offen offset:0  lds
    ds_read_b128 v[184:187], v8 offset:10240
    v_mfma_f32_16x16x32_bf16 v[80:83], v[136:139], v[160:163], v[80:83]
    ds_read_b128 v[188:191], v8 offset:12288
    ds_read_b128 v[192:195], v8 offset:14336
    v_mfma_f32_16x16x32_bf16 v[96:99], v[140:143], v[160:163], v[96:99]
    v_mfma_f32_16x16x32_bf16 v[100:103], v[140:143], v[164:167], v[100:103]
    s_waitcnt vmcnt(11)
    buffer_load_dwordx4 v23, s[8:11], s36 offen offset:1024  lds
    ds_read_b64_tr_b16 v[144:145], v1 offset:12288
    v_mfma_f32_16x16x32_bf16 v[84:87], v[136:139], v[164:167], v[84:87]
    ds_read_b64_tr_b16 v[146:147], v1 offset:14336
    ds_read_b64_tr_b16 v[148:149], v2 offset:12288
    v_mfma_f32_16x16x32_bf16 v[68:71], v[132:135], v[164:167], v[68:71]
    ds_read_b64_tr_b16 v[150:151], v2 offset:14336
    ds_read_b64_tr_b16 v[152:153], v3 offset:12288
    v_mfma_f32_16x16x32_bf16 v[52:55], v[128:131], v[164:167], v[52:55]
    ds_read_b64_tr_b16 v[154:155], v3 offset:14336
    ds_read_b64_tr_b16 v[156:157], v4 offset:12288
    v_mfma_f32_16x16x32_bf16 v[56:59], v[128:131], v[168:171], v[56:59]
    buffer_load_dwordx4 v24, s[8:11], s36 offen offset:2048  lds
    ds_read_b64_tr_b16 v[158:159], v4 offset:14336
    v_mfma_f32_16x16x32_bf16 v[72:75], v[132:135], v[168:171], v[72:75]
    v_mfma_f32_16x16x32_bf16 v[88:91], v[136:139], v[168:171], v[88:91]
    v_mfma_f32_16x16x32_bf16 v[104:107], v[140:143], v[168:171], v[104:107]
    v_mfma_f32_16x16x32_bf16 v[108:111], v[140:143], v[172:175], v[108:111]
    buffer_load_dwordx4 v25, s[8:11], s36 offen offset:3072  lds
    v_mfma_f32_16x16x32_bf16 v[92:95], v[136:139], v[172:175], v[92:95]
    v_mfma_f32_16x16x32_bf16 v[76:79], v[132:135], v[172:175], v[76:79]
    v_mfma_f32_16x16x32_bf16 v[60:63], v[128:131], v[172:175], v[60:63]
    s_waitcnt lgkmcnt(0)
    v_mfma_f32_16x16x32_bf16 v[48:51], v[144:147], v[180:183], v[48:51]
    s_xor_b32 s36, s1, 256
    s_mov_b32 m0, s31
    v_mfma_f32_16x16x32_bf16 v[64:67], v[148:151], v[180:183], v[64:67]
    s_waitcnt vmcnt(8)
    s_barrier
    buffer_load_dwordx4 v22, s[8:11], s36 offen offset:0  lds
    v_mfma_f32_16x16x32_bf16 v[80:83], v[152:155], v[180:183], v[80:83]
    ds_read_b128 v[160:163], v9 offset:16384
    ds_read_b128 v[164:167], v9 offset:18432
    v_mfma_f32_16x16x32_bf16 v[96:99], v[156:159], v[180:183], v[96:99]
    ds_read_b128 v[168:171], v9 offset:20480
    ds_read_b128 v[172:175], v9 offset:22528
    v_mfma_f32_16x16x32_bf16 v[100:103], v[156:159], v[184:187], v[100:103]
    buffer_load_dwordx4 v23, s[8:11], s36 offen offset:1024  lds
    ds_read_b64_tr_b16 v[128:129], v1 offset:0
    v_mfma_f32_16x16x32_bf16 v[84:87], v[152:155], v[184:187], v[84:87]
    ds_read_b64_tr_b16 v[130:131], v1 offset:2048
    ds_read_b64_tr_b16 v[132:133], v2 offset:0
    v_mfma_f32_16x16x32_bf16 v[68:71], v[148:151], v[184:187], v[68:71]
    ds_read_b64_tr_b16 v[134:135], v2 offset:2048
    ds_read_b64_tr_b16 v[136:137], v3 offset:0
    v_mfma_f32_16x16x32_bf16 v[52:55], v[144:147], v[184:187], v[52:55]
    ds_read_b64_tr_b16 v[138:139], v3 offset:2048
    ds_read_b64_tr_b16 v[140:141], v4 offset:0
    v_mfma_f32_16x16x32_bf16 v[56:59], v[144:147], v[188:191], v[56:59]
    buffer_load_dwordx4 v24, s[8:11], s36 offen offset:2048  lds
    ds_read_b64_tr_b16 v[142:143], v4 offset:2048
    v_mfma_f32_16x16x32_bf16 v[72:75], v[148:151], v[188:191], v[72:75]
    v_mfma_f32_16x16x32_bf16 v[88:91], v[152:155], v[188:191], v[88:91]
    v_mfma_f32_16x16x32_bf16 v[104:107], v[156:159], v[188:191], v[104:107]
    v_mfma_f32_16x16x32_bf16 v[108:111], v[156:159], v[192:195], v[108:111]
    buffer_load_dwordx4 v25, s[8:11], s36 offen offset:3072  lds
    v_mfma_f32_16x16x32_bf16 v[92:95], v[152:155], v[192:195], v[92:95]
    v_mfma_f32_16x16x32_bf16 v[76:79], v[148:151], v[192:195], v[76:79]
    v_mfma_f32_16x16x32_bf16 v[60:63], v[144:147], v[192:195], v[60:63]
    s_waitcnt lgkmcnt(0)
    v_mfma_f32_16x16x32_bf16 v[48:51], v[128:131], v[160:163], v[48:51]
    s_xor_b32 s36, s1, 16384
    s_mov_b32 m0, s28
    ds_read_b128 v[180:183], v8 offset:16384
    v_mfma_f32_16x16x32_bf16 v[64:67], v[132:135], v[160:163], v[64:67]
    buffer_load_dwordx4 v22, s[8:11], s36 offen offset:0  lds
    ds_read_b128 v[184:187], v8 offset:18432
    v_mfma_f32_16x16x32_bf16 v[80:83], v[136:139], v[160:163], v[80:83]
    ds_read_b128 v[188:191], v8 offset:20480
    ds_read_b128 v[192:195], v8 offset:22528
    v_mfma_f32_16x16x32_bf16 v[96:99], v[140:143], v[160:163], v[96:99]
    v_mfma_f32_16x16x32_bf16 v[100:103], v[140:143], v[164:167], v[100:103]
    s_waitcnt vmcnt(9)
    buffer_load_dwordx4 v23, s[8:11], s36 offen offset:1024  lds
    ds_read_b64_tr_b16 v[144:145], v1 offset:4096
    v_mfma_f32_16x16x32_bf16 v[84:87], v[136:139], v[164:167], v[84:87]
    ds_read_b64_tr_b16 v[146:147], v1 offset:6144
    ds_read_b64_tr_b16 v[148:149], v2 offset:4096
    v_mfma_f32_16x16x32_bf16 v[68:71], v[132:135], v[164:167], v[68:71]
    ds_read_b64_tr_b16 v[150:151], v2 offset:6144
    ds_read_b64_tr_b16 v[152:153], v3 offset:4096
    v_mfma_f32_16x16x32_bf16 v[52:55], v[128:131], v[164:167], v[52:55]
    ds_read_b64_tr_b16 v[154:155], v3 offset:6144
    ds_read_b64_tr_b16 v[156:157], v4 offset:4096
    v_mfma_f32_16x16x32_bf16 v[56:59], v[128:131], v[168:171], v[56:59]
    buffer_load_dwordx4 v24, s[8:11], s36 offen offset:2048  lds
    ds_read_b64_tr_b16 v[158:159], v4 offset:6144
    v_mfma_f32_16x16x32_bf16 v[72:75], v[132:135], v[168:171], v[72:75]
    v_mfma_f32_16x16x32_bf16 v[88:91], v[136:139], v[168:171], v[88:91]
    v_mfma_f32_16x16x32_bf16 v[104:107], v[140:143], v[168:171], v[104:107]
    v_mfma_f32_16x16x32_bf16 v[108:111], v[140:143], v[172:175], v[108:111]
    buffer_load_dwordx4 v25, s[8:11], s36 offen offset:3072  lds
    v_mfma_f32_16x16x32_bf16 v[92:95], v[136:139], v[172:175], v[92:95]
    v_mfma_f32_16x16x32_bf16 v[76:79], v[132:135], v[172:175], v[76:79]
    v_mfma_f32_16x16x32_bf16 v[60:63], v[128:131], v[172:175], v[60:63]
    s_waitcnt lgkmcnt(0)
    v_mfma_f32_16x16x32_bf16 v[48:51], v[144:147], v[180:183], v[48:51]
    s_waitcnt vmcnt(8)
    s_xor_b32 s36, s1, 16640
    s_mov_b32 m0, s29
    v_mfma_f32_16x16x32_bf16 v[64:67], v[148:151], v[180:183], v[64:67]
    buffer_load_dwordx4 v22, s[8:11], s36 offen offset:0  lds
    ds_read_b128 a[160:163], v6 offset:8192
    v_mfma_f32_16x16x32_bf16 v[80:83], v[152:155], v[180:183], v[80:83]
    buffer_load_dwordx4 v23, s[8:11], s36 offen offset:1024  lds
    ds_read_b128 a[164:167], v7 offset:8192
    v_mfma_f32_16x16x32_bf16 v[96:99], v[156:159], v[180:183], v[96:99]
    buffer_load_dwordx4 v24, s[8:11], s36 offen offset:2048  lds
    ds_read_b128 a[168:171], v6 offset:10240
    v_mfma_f32_16x16x32_bf16 v[52:55], v[144:147], v[184:187], v[52:55]
    buffer_load_dwordx4 v25, s[8:11], s36 offen offset:3072  lds
    ds_read_b128 a[172:175], v7 offset:10240
    v_mfma_f32_16x16x32_bf16 v[68:71], v[148:151], v[184:187], v[68:71]
    s_waitcnt vmcnt(8)
    ds_read_b128 a[176:179], v6 offset:12288
    v_pk_mul_f32 v[48:49], v[48:49], s[74:75]
    v_mfma_f32_16x16x32_bf16 v[84:87], v[152:155], v[184:187], v[84:87]
    ds_read_b128 a[180:183], v7 offset:12288
    v_pk_mul_f32 v[50:51], v[50:51], s[74:75]
    v_mfma_f32_16x16x32_bf16 v[100:103], v[156:159], v[184:187], v[100:103]
    ds_read_b128 a[184:187], v6 offset:14336
    v_cvt_pk_bf16_f32 v200, v48, v49
    v_mfma_f32_16x16x32_bf16 v[56:59], v[144:147], v[188:191], v[56:59]
    ds_read_b128 a[188:191], v7 offset:14336
    s_xor_b32 s36, s1, 8192
    v_mfma_f32_16x16x32_bf16 v[72:75], v[148:151], v[188:191], v[72:75]
    s_mov_b32 m0, s30
    s_waitcnt lgkmcnt(4)
    buffer_load_dwordx4 v22, s[8:11], s36 offen offset:0  lds
    v_cvt_pk_bf16_f32 v201, v50, v51
    v_mfma_f32_16x16x32_bf16 v[88:91], v[152:155], v[188:191], v[88:91]
    buffer_load_dwordx4 v23, s[8:11], s36 offen offset:1024  lds
    ds_write_b64 v12, v[200:201] offset:0
    v_mfma_f32_16x16x32_bf16 v[104:107], v[156:159], v[188:191], v[104:107]
    buffer_load_dwordx4 v24, s[8:11], s36 offen offset:2048  lds
    v_pk_mul_f32 v[64:65], v[64:65], s[74:75]
    v_mfma_f32_16x16x32_bf16 v[60:63], v[144:147], v[192:195], v[60:63]
    buffer_load_dwordx4 v25, s[8:11], s36 offen offset:3072  lds
    s_waitcnt vmcnt(8)
    v_mfma_f32_16x16x32_bf16 v[76:79], v[148:151], v[192:195], v[76:79]
    ds_read_b128 a[192:195], v6 offset:0
    v_pk_mul_f32 v[66:67], v[66:67], s[74:75]
    v_mfma_f32_16x16x32_bf16 v[92:95], v[152:155], v[192:195], v[92:95]
    ds_read_b128 a[196:199], v7 offset:0
    v_cvt_pk_bf16_f32 v202, v64, v65
    v_mfma_f32_16x16x32_bf16 v[108:111], v[156:159], v[192:195], v[108:111]
    ds_read_b128 a[200:203], v6 offset:2048
    v_cvt_pk_bf16_f32 v203, v66, v67
    ds_read_b128 a[204:207], v7 offset:2048
    s_xor_b32 s36, s1, 8448
    s_mov_b32 m0, s31
    s_waitcnt lgkmcnt(5)
    buffer_load_dwordx4 v22, s[8:11], s36 offen offset:0  lds
    buffer_load_dwordx4 v23, s[8:11], s36 offen offset:1024  lds
    buffer_load_dwordx4 v24, s[8:11], s36 offen offset:2048  lds
    buffer_load_dwordx4 v25, s[8:11], s36 offen offset:3072  lds
    ds_write_b64 v12, v[202:203] offset:512
    v_pk_mul_f32 v[80:81], v[80:81], s[74:75]
    v_pk_mul_f32 v[82:83], v[82:83], s[74:75]
    v_cvt_pk_bf16_f32 v204, v80, v81
    v_cvt_pk_bf16_f32 v205, v82, v83
    ds_write_b64 v12, v[204:205] offset:4096
    v_pk_mul_f32 v[96:97], v[96:97], s[74:75]
    v_pk_mul_f32 v[98:99], v[98:99], s[74:75]
    v_cvt_pk_bf16_f32 v206, v96, v97
    v_cvt_pk_bf16_f32 v207, v98, v99
    ds_write_b64 v12, v[206:207] offset:4608
    v_pk_mul_f32 v[52:53], v[52:53], s[74:75]
    v_pk_mul_f32 v[54:55], v[54:55], s[74:75]
    v_cvt_pk_bf16_f32 v208, v52, v53
    v_cvt_pk_bf16_f32 v209, v54, v55
    ds_write_b64 v12, v[208:209] offset:1024
    v_pk_mul_f32 v[68:69], v[68:69], s[74:75]
    v_pk_mul_f32 v[70:71], v[70:71], s[74:75]
    v_cvt_pk_bf16_f32 v210, v68, v69
    v_cvt_pk_bf16_f32 v211, v70, v71
    ds_write_b64 v12, v[210:211] offset:1536
    v_pk_mul_f32 v[84:85], v[84:85], s[74:75]
    v_pk_mul_f32 v[86:87], v[86:87], s[74:75]
    v_cvt_pk_bf16_f32 v212, v84, v85
    v_cvt_pk_bf16_f32 v213, v86, v87
    ds_write_b64 v12, v[212:213] offset:5120
    v_pk_mul_f32 v[100:101], v[100:101], s[74:75]
    v_pk_mul_f32 v[102:103], v[102:103], s[74:75]
    v_cvt_pk_bf16_f32 v214, v100, v101
    v_cvt_pk_bf16_f32 v215, v102, v103
    ds_write_b64 v12, v[214:215] offset:5632
    v_pk_mul_f32 v[56:57], v[56:57], s[74:75]
    v_pk_mul_f32 v[58:59], v[58:59], s[74:75]
    v_cvt_pk_bf16_f32 v200, v56, v57
    v_cvt_pk_bf16_f32 v201, v58, v59
    ds_write_b64 v12, v[200:201] offset:2048
    v_pk_mul_f32 v[72:73], v[72:73], s[74:75]
    v_pk_mul_f32 v[74:75], v[74:75], s[74:75]
    v_cvt_pk_bf16_f32 v202, v72, v73
    v_cvt_pk_bf16_f32 v203, v74, v75
    ds_write_b64 v12, v[202:203] offset:2560
    v_pk_mul_f32 v[88:89], v[88:89], s[74:75]
    v_pk_mul_f32 v[90:91], v[90:91], s[74:75]
    v_cvt_pk_bf16_f32 v204, v88, v89
    v_cvt_pk_bf16_f32 v205, v90, v91
    ds_write_b64 v12, v[204:205] offset:6144
    v_pk_mul_f32 v[104:105], v[104:105], s[74:75]
    v_pk_mul_f32 v[106:107], v[106:107], s[74:75]
    v_cvt_pk_bf16_f32 v206, v104, v105
    v_cvt_pk_bf16_f32 v207, v106, v107
    ds_write_b64 v12, v[206:207] offset:6656
    v_pk_mul_f32 v[60:61], v[60:61], s[74:75]
    v_pk_mul_f32 v[62:63], v[62:63], s[74:75]
    v_cvt_pk_bf16_f32 v208, v60, v61
    v_cvt_pk_bf16_f32 v209, v62, v63
    ds_write_b64 v12, v[208:209] offset:3072
    v_pk_mul_f32 v[76:77], v[76:77], s[74:75]
    v_pk_mul_f32 v[78:79], v[78:79], s[74:75]
    v_cvt_pk_bf16_f32 v210, v76, v77
    v_cvt_pk_bf16_f32 v211, v78, v79
    ds_write_b64 v12, v[210:211] offset:3584
    v_pk_mul_f32 v[92:93], v[92:93], s[74:75]
    v_pk_mul_f32 v[94:95], v[94:95], s[74:75]
    v_cvt_pk_bf16_f32 v212, v92, v93
    v_cvt_pk_bf16_f32 v213, v94, v95
    ds_write_b64 v12, v[212:213] offset:7168
    v_pk_mul_f32 v[108:109], v[108:109], s[74:75]
    v_pk_mul_f32 v[110:111], v[110:111], s[74:75]
    v_cvt_pk_bf16_f32 v214, v108, v109
    v_cvt_pk_bf16_f32 v215, v110, v111
    ds_write_b64 v12, v[214:215] offset:7680
    s_xor_b32 s36, s1, 24576
    s_mov_b32 m0, s28
    s_waitcnt lgkmcnt(14)
    buffer_load_dwordx4 v22, s[8:11], s36 offen offset:0  lds
    buffer_load_dwordx4 v23, s[8:11], s36 offen offset:1024  lds
    buffer_load_dwordx4 v24, s[8:11], s36 offen offset:2048  lds
    buffer_load_dwordx4 v25, s[8:11], s36 offen offset:3072  lds
    s_waitcnt vmcnt(12)
    ds_read_b128 a[208:211], v6 offset:4096
    ds_read_b128 a[212:215], v7 offset:4096
    ds_read_b128 a[216:219], v6 offset:6144
    ds_read_b128 a[220:223], v7 offset:6144
    s_waitcnt lgkmcnt(0)
    s_barrier
    ds_read_b128 a[0:3], v10 offset:0
    ds_read_b128 a[16:19], v10 offset:4096
    ds_read_b128 a[32:35], v10 offset:8192
    ds_read_b128 a[48:51], v10 offset:12288
    ds_read_b128 a[4:7], v10 offset:1024
    ds_read_b128 a[20:23], v10 offset:5120
    ds_read_b128 a[36:39], v10 offset:9216
    ds_read_b128 a[52:55], v10 offset:13312
    ds_read_b128 a[8:11], v10 offset:2048
    ds_read_b128 a[24:27], v10 offset:6144
    s_waitcnt lgkmcnt(9)
    v_mfma_f32_16x16x32_bf16 v[48:51], a[160:163], a[0:3], 0
    s_xor_b32 s36, s1, 24832
    s_mov_b32 m0, s29
    ds_read_b128 a[40:43], v10 offset:10240
    s_waitcnt lgkmcnt(9)
    v_mfma_f32_16x16x32_bf16 v[48:51], a[164:167], a[16:19], v[48:51]
    ds_read_b128 a[56:59], v10 offset:14336
    buffer_load_dwordx4 v22, s[8:11], s36 offen offset:0  lds
    s_waitcnt lgkmcnt(9)
    v_mfma_f32_16x16x32_bf16 v[48:51], a[168:171], a[32:35], v[48:51]
    ds_read_b128 a[12:15], v10 offset:3072
    ds_read_b128 a[28:31], v10 offset:7168
    s_waitcnt lgkmcnt(10)
    v_mfma_f32_16x16x32_bf16 v[48:51], a[172:175], a[48:51], v[48:51]
    ds_read_b128 a[44:47], v10 offset:11264
    ds_read_b128 a[60:63], v10 offset:15360
    s_waitcnt lgkmcnt(11)
    v_mfma_f32_16x16x32_bf16 v[52:55], a[160:163], a[4:7], 0
    ds_read_b128 a[64:67], v10 offset:16384
    buffer_load_dwordx4 v23, s[8:11], s36 offen offset:1024  lds
    s_waitcnt lgkmcnt(11)
    v_mfma_f32_16x16x32_bf16 v[52:55], a[164:167], a[20:23], v[52:55]
    ds_read_b128 a[80:83], v10 offset:20480
    ds_read_b128 a[96:99], v10 offset:24576
    s_waitcnt lgkmcnt(12)
    v_mfma_f32_16x16x32_bf16 v[52:55], a[168:171], a[36:39], v[52:55]
    ds_read_b128 a[112:115], v10 offset:28672
    ds_read_b128 a[68:71], v10 offset:17408
    s_waitcnt lgkmcnt(13)
    v_mfma_f32_16x16x32_bf16 v[52:55], a[172:175], a[52:55], v[52:55]
    ds_read_b128 a[84:87], v10 offset:21504
    ds_read_b128 a[100:103], v10 offset:25600
    s_waitcnt lgkmcnt(14)
    v_mfma_f32_16x16x32_bf16 v[56:59], a[160:163], a[8:11], 0
    ds_read_b128 a[116:119], v10 offset:29696
    buffer_load_dwordx4 v24, s[8:11], s36 offen offset:2048  lds
    s_waitcnt lgkmcnt(14)
    v_mfma_f32_16x16x32_bf16 v[56:59], a[164:167], a[24:27], v[56:59]
    ds_read_b128 a[72:75], v10 offset:18432
    ds_read_b128 a[88:91], v10 offset:22528
    s_waitcnt lgkmcnt(14)
    v_mfma_f32_16x16x32_bf16 v[56:59], a[168:171], a[40:43], v[56:59]
    v_mfma_f32_16x16x32_bf16 v[56:59], a[172:175], a[56:59], v[56:59]
    s_waitcnt lgkmcnt(13)
    v_mfma_f32_16x16x32_bf16 v[60:63], a[160:163], a[12:15], 0
    buffer_load_dwordx4 v25, s[8:11], s36 offen offset:3072  lds
    s_waitcnt lgkmcnt(12)
    v_mfma_f32_16x16x32_bf16 v[60:63], a[164:167], a[28:31], v[60:63]
    s_waitcnt lgkmcnt(11)
    v_mfma_f32_16x16x32_bf16 v[60:63], a[168:171], a[44:47], v[60:63]
    s_waitcnt lgkmcnt(10)
    v_mfma_f32_16x16x32_bf16 v[60:63], a[172:175], a[60:63], v[60:63]
    s_waitcnt lgkmcnt(9)
    v_mfma_f32_16x16x32_bf16 v[48:51], a[176:179], a[64:67], v[48:51]
    ds_read_b128 a[104:107], v10 offset:26624
    ds_read_b128 a[120:123], v10 offset:30720
    s_waitcnt lgkmcnt(10)
    v_mfma_f32_16x16x32_bf16 v[48:51], a[180:183], a[80:83], v[48:51]
    ds_read_b128 a[76:79], v10 offset:19456
    ds_read_b128 a[92:95], v10 offset:23552
    s_waitcnt lgkmcnt(11)
    v_mfma_f32_16x16x32_bf16 v[48:51], a[184:187], a[96:99], v[48:51]
    ds_read_b128 a[108:111], v10 offset:27648
    ds_read_b128 a[124:127], v10 offset:31744
    s_waitcnt lgkmcnt(12)
    v_mfma_f32_16x16x32_bf16 v[48:51], a[188:191], a[112:115], v[48:51]
    s_waitcnt lgkmcnt(11)
    v_mfma_f32_16x16x32_bf16 v[52:55], a[176:179], a[68:71], v[52:55]
    s_waitcnt lgkmcnt(10)
    v_mfma_f32_16x16x32_bf16 v[52:55], a[180:183], a[84:87], v[52:55]
    s_waitcnt lgkmcnt(9)
    v_mfma_f32_16x16x32_bf16 v[52:55], a[184:187], a[100:103], v[52:55]
    s_waitcnt lgkmcnt(8)
    v_mfma_f32_16x16x32_bf16 v[52:55], a[188:191], a[116:119], v[52:55]
    v_exp_f32 v48, v48
    s_waitcnt lgkmcnt(7)
    v_mfma_f32_16x16x32_bf16 v[56:59], a[176:179], a[72:75], v[56:59]
    s_waitcnt vmcnt(12)
    ds_read_b128 v[128:131], v6 offset:8192
    ds_read_b128 v[132:135], v7 offset:8192
    s_waitcnt lgkmcnt(8)
    v_mfma_f32_16x16x32_bf16 v[56:59], a[180:183], a[88:91], v[56:59]
    ds_read_b128 v[136:139], v6 offset:10240
    ds_read_b128 v[140:143], v7 offset:10240
    s_waitcnt lgkmcnt(9)
    v_mfma_f32_16x16x32_bf16 v[56:59], a[184:187], a[104:107], v[56:59]
    v_exp_f32 v49, v49
    s_waitcnt lgkmcnt(8)
    v_mfma_f32_16x16x32_bf16 v[56:59], a[188:191], a[120:123], v[56:59]
    v_exp_f32 v50, v50
    s_waitcnt lgkmcnt(7)
    v_mfma_f32_16x16x32_bf16 v[60:63], a[176:179], a[76:79], v[60:63]
    v_exp_f32 v51, v51
    v_cvt_pk_bf16_f32 v108, v48, v49
    s_waitcnt lgkmcnt(6)
    v_mfma_f32_16x16x32_bf16 v[60:63], a[180:183], a[92:95], v[60:63]
    v_cvt_pk_bf16_f32 v109, v50, v51
    s_waitcnt lgkmcnt(5)
    v_mfma_f32_16x16x32_bf16 v[60:63], a[184:187], a[108:111], v[60:63]
    v_exp_f32 v52, v52
    s_waitcnt lgkmcnt(4)
    v_mfma_f32_16x16x32_bf16 v[60:63], a[188:191], a[124:127], v[60:63]
    v_exp_f32 v53, v53
    s_waitcnt lgkmcnt(0)
    v_mfma_f32_16x16x32_bf16 v[68:71], v[128:131], a[0:3], 0
    s_xor_b32 s36, s1, 32768
    s_mov_b32 m0, s30
    v_mfma_f32_16x16x32_bf16 v[68:71], v[132:135], a[16:19], v[68:71]
    buffer_load_dwordx4 v22, s[8:11], s36 offen offset:0  lds
    v_mfma_f32_16x16x32_bf16 v[68:71], v[136:139], a[32:35], v[68:71]
    v_exp_f32 v54, v54
    v_mfma_f32_16x16x32_bf16 v[68:71], v[140:143], a[48:51], v[68:71]
    v_exp_f32 v55, v55
    v_mfma_f32_16x16x32_bf16 v[72:75], v[128:131], a[4:7], 0
    buffer_load_dwordx4 v23, s[8:11], s36 offen offset:1024  lds
    v_cvt_pk_bf16_f32 v112, v52, v53
    v_mfma_f32_16x16x32_bf16 v[72:75], v[132:135], a[20:23], v[72:75]
    v_cvt_pk_bf16_f32 v113, v54, v55
    v_mfma_f32_16x16x32_bf16 v[72:75], v[136:139], a[36:39], v[72:75]
    v_exp_f32 v56, v56
    v_mfma_f32_16x16x32_bf16 v[72:75], v[140:143], a[52:55], v[72:75]
    v_exp_f32 v57, v57
    v_mfma_f32_16x16x32_bf16 v[76:79], v[128:131], a[8:11], 0
    s_waitcnt vmcnt(10)
    buffer_load_dwordx4 v24, s[8:11], s36 offen offset:2048  lds
    ds_read_b128 v[144:147], v6 offset:12288
    v_mfma_f32_16x16x32_bf16 v[76:79], v[132:135], a[24:27], v[76:79]
    ds_read_b128 v[148:151], v7 offset:12288
    ds_read_b128 v[152:155], v6 offset:14336
    v_mfma_f32_16x16x32_bf16 v[76:79], v[136:139], a[40:43], v[76:79]
    ds_read_b128 v[156:159], v7 offset:14336
    v_mfma_f32_16x16x32_bf16 v[76:79], v[140:143], a[56:59], v[76:79]
    v_exp_f32 v58, v58
    v_mfma_f32_16x16x32_bf16 v[80:83], v[128:131], a[12:15], 0
    buffer_load_dwordx4 v25, s[8:11], s36 offen offset:3072  lds
    v_mfma_f32_16x16x32_bf16 v[80:83], v[132:135], a[28:31], v[80:83]
    v_exp_f32 v59, v59
    v_mfma_f32_16x16x32_bf16 v[80:83], v[136:139], a[44:47], v[80:83]
    v_cvt_pk_bf16_f32 v116, v56, v57
    v_cvt_pk_bf16_f32 v117, v58, v59
    v_mfma_f32_16x16x32_bf16 v[80:83], v[140:143], a[60:63], v[80:83]
    v_exp_f32 v60, v60
    s_waitcnt lgkmcnt(0)
    v_mfma_f32_16x16x32_bf16 v[68:71], v[144:147], a[64:67], v[68:71]
    s_xor_b32 s36, s1, 33024
    s_mov_b32 m0, s31
    v_mfma_f32_16x16x32_bf16 v[68:71], v[148:151], a[80:83], v[68:71]
    buffer_load_dwordx4 v22, s[8:11], s36 offen offset:0  lds
    v_mfma_f32_16x16x32_bf16 v[68:71], v[152:155], a[96:99], v[68:71]
    v_exp_f32 v61, v61
    v_mfma_f32_16x16x32_bf16 v[68:71], v[156:159], a[112:115], v[68:71]
    v_exp_f32 v62, v62
    v_mfma_f32_16x16x32_bf16 v[72:75], v[144:147], a[68:71], v[72:75]
    buffer_load_dwordx4 v23, s[8:11], s36 offen offset:1024  lds
    v_mfma_f32_16x16x32_bf16 v[72:75], v[148:151], a[84:87], v[72:75]
    v_exp_f32 v63, v63
    v_mfma_f32_16x16x32_bf16 v[72:75], v[152:155], a[100:103], v[72:75]
    v_cvt_pk_bf16_f32 v120, v60, v61
    v_cvt_pk_bf16_f32 v121, v62, v63
    v_mfma_f32_16x16x32_bf16 v[72:75], v[156:159], a[116:119], v[72:75]
    v_exp_f32 v68, v68
    v_mfma_f32_16x16x32_bf16 v[76:79], v[144:147], a[72:75], v[76:79]
    buffer_load_dwordx4 v24, s[8:11], s36 offen offset:2048  lds
    v_mfma_f32_16x16x32_bf16 v[76:79], v[148:151], a[88:91], v[76:79]
    v_exp_f32 v69, v69
    v_mfma_f32_16x16x32_bf16 v[76:79], v[152:155], a[104:107], v[76:79]
    v_exp_f32 v70, v70
    v_mfma_f32_16x16x32_bf16 v[76:79], v[156:159], a[120:123], v[76:79]
    v_exp_f32 v71, v71
    v_mfma_f32_16x16x32_bf16 v[80:83], v[144:147], a[76:79], v[80:83]
    buffer_load_dwordx4 v25, s[8:11], s36 offen offset:3072  lds
    v_cvt_pk_bf16_f32 v110, v68, v69
    v_mfma_f32_16x16x32_bf16 v[80:83], v[148:151], a[92:95], v[80:83]
    v_cvt_pk_bf16_f32 v111, v70, v71
    v_mfma_f32_16x16x32_bf16 v[80:83], v[152:155], a[108:111], v[80:83]
    v_exp_f32 v72, v72
    v_mfma_f32_16x16x32_bf16 v[80:83], v[156:159], a[124:127], v[80:83]
    v_exp_f32 v73, v73
    v_mfma_f32_16x16x32_bf16 v[48:51], a[192:195], a[0:3], 0
    v_mfma_f32_16x16x32_bf16 v[88:91], v[44:47], v[108:111], 0
    ds_write_b128 v16, v[108:111] offset:0
    v_mfma_f32_16x16x32_bf16 v[48:51], a[196:199], a[16:19], v[48:51]
    v_exp_f32 v74, v74
    v_mfma_f32_16x16x32_bf16 v[48:51], a[200:203], a[32:35], v[48:51]
    v_exp_f32 v75, v75
    v_mfma_f32_16x16x32_bf16 v[48:51], a[204:207], a[48:51], v[48:51]
    v_cvt_pk_bf16_f32 v114, v72, v73
    v_cvt_pk_bf16_f32 v115, v74, v75
    v_mfma_f32_16x16x32_bf16 v[52:55], a[192:195], a[4:7], 0
    v_exp_f32 v76, v76
    v_mfma_f32_16x16x32_bf16 v[52:55], a[196:199], a[20:23], v[52:55]
    v_exp_f32 v77, v77
    v_mfma_f32_16x16x32_bf16 v[52:55], a[200:203], a[36:39], v[52:55]
    v_mfma_f32_16x16x32_bf16 v[92:95], v[44:47], v[112:115], 0
    ds_write_b128 v16, v[112:115] offset:1024
    v_mfma_f32_16x16x32_bf16 v[52:55], a[204:207], a[52:55], v[52:55]
    v_exp_f32 v78, v78
    v_mfma_f32_16x16x32_bf16 v[56:59], a[192:195], a[8:11], 0
    v_exp_f32 v79, v79
    v_mfma_f32_16x16x32_bf16 v[56:59], a[196:199], a[24:27], v[56:59]
    v_cvt_pk_bf16_f32 v118, v76, v77
    v_cvt_pk_bf16_f32 v119, v78, v79
    v_mfma_f32_16x16x32_bf16 v[56:59], a[200:203], a[40:43], v[56:59]
    v_exp_f32 v80, v80
    v_mfma_f32_16x16x32_bf16 v[56:59], a[204:207], a[56:59], v[56:59]
    v_exp_f32 v81, v81
    v_mfma_f32_16x16x32_bf16 v[60:63], a[192:195], a[12:15], 0
    v_mfma_f32_16x16x32_bf16 v[96:99], v[44:47], v[116:119], 0
    ds_write_b128 v16, v[116:119] offset:2048
    v_mfma_f32_16x16x32_bf16 v[60:63], a[196:199], a[28:31], v[60:63]
    v_exp_f32 v82, v82
    v_mfma_f32_16x16x32_bf16 v[60:63], a[200:203], a[44:47], v[60:63]
    v_exp_f32 v83, v83
    v_mfma_f32_16x16x32_bf16 v[60:63], a[204:207], a[60:63], v[60:63]
    v_cvt_pk_bf16_f32 v122, v80, v81
    v_cvt_pk_bf16_f32 v123, v82, v83
    v_mfma_f32_16x16x32_bf16 v[48:51], a[208:211], a[64:67], v[48:51]
    s_nop 0
    v_mfma_f32_16x16x32_bf16 v[100:103], v[44:47], v[120:123], 0
    ds_write_b128 v16, v[120:123] offset:3072
    v_mfma_f32_16x16x32_bf16 v[48:51], a[212:215], a[80:83], v[48:51]
    v_mfma_f32_16x16x32_bf16 v[48:51], a[216:219], a[96:99], v[48:51]
    v_mfma_f32_16x16x32_bf16 v[48:51], a[220:223], a[112:115], v[48:51]
    v_mfma_f32_16x16x32_bf16 v[52:55], a[208:211], a[68:71], v[52:55]
    v_mfma_f32_16x16x32_bf16 v[52:55], a[212:215], a[84:87], v[52:55]
    v_mfma_f32_16x16x32_bf16 v[52:55], a[216:219], a[100:103], v[52:55]
    v_mfma_f32_16x16x32_bf16 v[52:55], a[220:223], a[116:119], v[52:55]
    s_nop 3
    v_exp_f32 v48, v48
    v_mfma_f32_16x16x32_bf16 v[56:59], a[208:211], a[72:75], v[56:59]
    s_waitcnt vmcnt(12)
    ds_read_b128 v[128:131], v6 offset:0
    ds_read_b128 v[132:135], v7 offset:0
    v_mfma_f32_16x16x32_bf16 v[56:59], a[212:215], a[88:91], v[56:59]
    ds_read_b128 v[136:139], v6 offset:2048
    ds_read_b128 v[140:143], v7 offset:2048
    v_mfma_f32_16x16x32_bf16 v[56:59], a[216:219], a[104:107], v[56:59]
    v_exp_f32 v49, v49
    v_mfma_f32_16x16x32_bf16 v[56:59], a[220:223], a[120:123], v[56:59]
    v_exp_f32 v50, v50
    v_mfma_f32_16x16x32_bf16 v[60:63], a[208:211], a[76:79], v[60:63]
    v_exp_f32 v51, v51
    v_mfma_f32_16x16x32_bf16 v[60:63], a[212:215], a[92:95], v[60:63]
    v_cvt_pk_bf16_f32 v108, v48, v49
    v_cvt_pk_bf16_f32 v109, v50, v51
    v_mfma_f32_16x16x32_bf16 v[60:63], a[216:219], a[108:111], v[60:63]
    v_exp_f32 v52, v52
    v_mfma_f32_16x16x32_bf16 v[60:63], a[220:223], a[124:127], v[60:63]
    v_exp_f32 v53, v53
    s_waitcnt lgkmcnt(0)
    v_mfma_f32_16x16x32_bf16 v[68:71], v[128:131], a[0:3], 0
    s_xor_b32 s36, s1, 40960
    s_mov_b32 m0, s28
    v_mfma_f32_16x16x32_bf16 v[68:71], v[132:135], a[16:19], v[68:71]
    buffer_load_dwordx4 v22, s[8:11], s36 offen offset:0  lds
    v_mfma_f32_16x16x32_bf16 v[68:71], v[136:139], a[32:35], v[68:71]
    v_exp_f32 v54, v54
    v_mfma_f32_16x16x32_bf16 v[68:71], v[140:143], a[48:51], v[68:71]
    v_exp_f32 v55, v55
    v_mfma_f32_16x16x32_bf16 v[72:75], v[128:131], a[4:7], 0
    buffer_load_dwordx4 v23, s[8:11], s36 offen offset:1024  lds
    v_cvt_pk_bf16_f32 v112, v52, v53
    v_mfma_f32_16x16x32_bf16 v[72:75], v[132:135], a[20:23], v[72:75]
    v_cvt_pk_bf16_f32 v113, v54, v55
    v_mfma_f32_16x16x32_bf16 v[72:75], v[136:139], a[36:39], v[72:75]
    v_exp_f32 v56, v56
    v_mfma_f32_16x16x32_bf16 v[72:75], v[140:143], a[52:55], v[72:75]
    v_exp_f32 v57, v57
    v_mfma_f32_16x16x32_bf16 v[76:79], v[128:131], a[8:11], 0
    s_waitcnt vmcnt(10)
    buffer_load_dwordx4 v24, s[8:11], s36 offen offset:2048  lds
    ds_read_b128 v[144:147], v6 offset:4096
    v_mfma_f32_16x16x32_bf16 v[76:79], v[132:135], a[24:27], v[76:79]
    ds_read_b128 v[148:151], v7 offset:4096
    ds_read_b128 v[152:155], v6 offset:6144
    v_mfma_f32_16x16x32_bf16 v[76:79], v[136:139], a[40:43], v[76:79]
    ds_read_b128 v[156:159], v7 offset:6144
    v_mfma_f32_16x16x32_bf16 v[76:79], v[140:143], a[56:59], v[76:79]
    v_exp_f32 v58, v58
    v_mfma_f32_16x16x32_bf16 v[80:83], v[128:131], a[12:15], 0
    buffer_load_dwordx4 v25, s[8:11], s36 offen offset:3072  lds
    v_mfma_f32_16x16x32_bf16 v[80:83], v[132:135], a[28:31], v[80:83]
    v_exp_f32 v59, v59
    v_mfma_f32_16x16x32_bf16 v[80:83], v[136:139], a[44:47], v[80:83]
    v_cvt_pk_bf16_f32 v116, v56, v57
    v_cvt_pk_bf16_f32 v117, v58, v59
    v_mfma_f32_16x16x32_bf16 v[80:83], v[140:143], a[60:63], v[80:83]
    v_exp_f32 v60, v60
    s_waitcnt lgkmcnt(0)
    v_mfma_f32_16x16x32_bf16 v[68:71], v[144:147], a[64:67], v[68:71]
    s_barrier
    s_xor_b32 s36, s1, 41216
    s_mov_b32 m0, s29
    v_mfma_f32_16x16x32_bf16 v[68:71], v[148:151], a[80:83], v[68:71]
    buffer_load_dwordx4 v22, s[8:11], s36 offen offset:0  lds
    v_mfma_f32_16x16x32_bf16 v[68:71], v[152:155], a[96:99], v[68:71]
    v_exp_f32 v61, v61
    v_mfma_f32_16x16x32_bf16 v[68:71], v[156:159], a[112:115], v[68:71]
    v_exp_f32 v62, v62
    v_mfma_f32_16x16x32_bf16 v[72:75], v[144:147], a[68:71], v[72:75]
    buffer_load_dwordx4 v23, s[8:11], s36 offen offset:1024  lds
    v_mfma_f32_16x16x32_bf16 v[72:75], v[148:151], a[84:87], v[72:75]
    v_exp_f32 v63, v63
    v_mfma_f32_16x16x32_bf16 v[72:75], v[152:155], a[100:103], v[72:75]
    v_cvt_pk_bf16_f32 v120, v60, v61
    v_cvt_pk_bf16_f32 v121, v62, v63
    v_mfma_f32_16x16x32_bf16 v[72:75], v[156:159], a[116:119], v[72:75]
    v_exp_f32 v68, v68
    v_mfma_f32_16x16x32_bf16 v[76:79], v[144:147], a[72:75], v[76:79]
    s_waitcnt vmcnt(10)
    buffer_load_dwordx4 v24, s[8:11], s36 offen offset:2048  lds
    ds_read_b128 v[128:131], v6 offset:8192
    v_mfma_f32_16x16x32_bf16 v[76:79], v[148:151], a[88:91], v[76:79]
    ds_read_b128 v[132:135], v7 offset:8192
    ds_read_b128 v[136:139], v6 offset:10240
    v_mfma_f32_16x16x32_bf16 v[76:79], v[152:155], a[104:107], v[76:79]
    ds_read_b128 v[140:143], v7 offset:10240
    v_mfma_f32_16x16x32_bf16 v[76:79], v[156:159], a[120:123], v[76:79]
    v_exp_f32 v69, v69
    v_mfma_f32_16x16x32_bf16 v[80:83], v[144:147], a[76:79], v[80:83]
    buffer_load_dwordx4 v25, s[8:11], s36 offen offset:3072  lds
    v_mfma_f32_16x16x32_bf16 v[80:83], v[148:151], a[92:95], v[80:83]
    v_exp_f32 v70, v70
    v_mfma_f32_16x16x32_bf16 v[80:83], v[152:155], a[108:111], v[80:83]
    v_exp_f32 v71, v71
    v_mfma_f32_16x16x32_bf16 v[80:83], v[156:159], a[124:127], v[80:83]
    v_cvt_pk_bf16_f32 v110, v68, v69
    v_cvt_pk_bf16_f32 v111, v70, v71
    s_waitcnt lgkmcnt(0)
    v_mfma_f32_16x16x32_bf16 v[48:51], v[128:131], a[0:3], 0
    v_exp_f32 v72, v72
    v_mfma_f32_16x16x32_bf16 v[48:51], v[132:135], a[16:19], v[48:51]
    v_mov_b32 v253, 0
    global_load_dword v250, v253, s[48:49] sc1
    v_mfma_f32_16x16x32_bf16 v[48:51], v[136:139], a[32:35], v[48:51]
    v_exp_f32 v73, v73
    v_mfma_f32_16x16x32_bf16 v[48:51], v[140:143], a[48:51], v[48:51]
    s_xor_b32 s36, s1, 49152
    s_mov_b32 m0, s30
    v_mfma_f32_16x16x32_bf16 v[52:55], v[128:131], a[4:7], 0
    buffer_load_dwordx4 v22, s[8:11], s36 offen offset:0  lds
    v_mfma_f32_16x16x32_bf16 v[52:55], v[132:135], a[20:23], v[52:55]
    v_mfma_f32_16x16x32_bf16 v[88:91], v[44:47], v[108:111], v[88:91]
    ds_write_b128 v16, v[108:111] offset:16384
    v_mfma_f32_16x16x32_bf16 v[52:55], v[136:139], a[36:39], v[52:55]
    v_exp_f32 v74, v74
    v_mfma_f32_16x16x32_bf16 v[52:55], v[140:143], a[52:55], v[52:55]
    buffer_load_dwordx4 v23, s[8:11], s36 offen offset:1024  lds
    v_mfma_f32_16x16x32_bf16 v[56:59], v[128:131], a[8:11], 0
    s_waitcnt vmcnt(11)
    ds_read_b128 v[144:147], v6 offset:12288
    ds_read_b128 v[148:151], v7 offset:12288
    v_mfma_f32_16x16x32_bf16 v[56:59], v[132:135], a[24:27], v[56:59]
    ds_read_b128 v[152:155], v6 offset:14336
    ds_read_b128 v[156:159], v7 offset:14336
    v_mfma_f32_16x16x32_bf16 v[56:59], v[136:139], a[40:43], v[56:59]
    buffer_load_dwordx4 v24, s[8:11], s36 offen offset:2048  lds
    v_mfma_f32_16x16x32_bf16 v[56:59], v[140:143], a[56:59], v[56:59]
    v_exp_f32 v75, v75
    v_mfma_f32_16x16x32_bf16 v[60:63], v[128:131], a[12:15], 0
    v_cvt_pk_bf16_f32 v114, v72, v73
    v_cvt_pk_bf16_f32 v115, v74, v75
    v_mfma_f32_16x16x32_bf16 v[60:63], v[132:135], a[28:31], v[60:63]
    buffer_load_dwordx4 v25, s[8:11], s36 offen offset:3072  lds
    v_mfma_f32_16x16x32_bf16 v[60:63], v[136:139], a[44:47], v[60:63]
    v_exp_f32 v76, v76
    v_mfma_f32_16x16x32_bf16 v[60:63], v[140:143], a[60:63], v[60:63]
    v_exp_f32 v77, v77
    s_waitcnt lgkmcnt(0)
    v_mfma_f32_16x16x32_bf16 v[48:51], v[144:147], a[64:67], v[48:51]
    s_xor_b32 s36, s1, 49408
    s_mov_b32 m0, s31
    v_mfma_f32_16x16x32_bf16 v[48:51], v[148:151], a[80:83], v[48:51]
    buffer_load_dwordx4 v22, s[8:11], s36 offen offset:0  lds
    v_mfma_f32_16x16x32_bf16 v[48:51], v[152:155], a[96:99], v[48:51]
    v_mfma_f32_16x16x32_bf16 v[92:95], v[44:47], v[112:115], v[92:95]
    ds_write_b128 v16, v[112:115] offset:17408
    v_mfma_f32_16x16x32_bf16 v[48:51], v[156:159], a[112:115], v[48:51]
    v_exp_f32 v78, v78
    v_mfma_f32_16x16x32_bf16 v[52:55], v[144:147], a[68:71], v[52:55]
    buffer_load_dwordx4 v23, s[8:11], s36 offen offset:1024  lds
    v_mfma_f32_16x16x32_bf16 v[52:55], v[148:151], a[84:87], v[52:55]
    v_exp_f32 v79, v79
    v_mfma_f32_16x16x32_bf16 v[52:55], v[152:155], a[100:103], v[52:55]
    v_cvt_pk_bf16_f32 v118, v76, v77
    v_cvt_pk_bf16_f32 v119, v78, v79
    v_mfma_f32_16x16x32_bf16 v[52:55], v[156:159], a[116:119], v[52:55]
    v_exp_f32 v80, v80
    v_mfma_f32_16x16x32_bf16 v[56:59], v[144:147], a[72:75], v[56:59]
    s_waitcnt vmcnt(11)
    buffer_load_dwordx4 v24, s[8:11], s36 offen offset:2048  lds
    ds_read_b128 v[128:131], v6 offset:0
    v_mfma_f32_16x16x32_bf16 v[56:59], v[148:151], a[88:91], v[56:59]
    ds_read_b128 v[132:135], v7 offset:0
    ds_read_b128 v[136:139], v6 offset:2048
    v_mfma_f32_16x16x32_bf16 v[56:59], v[152:155], a[104:107], v[56:59]
    ds_read_b128 v[140:143], v7 offset:2048
    v_mfma_f32_16x16x32_bf16 v[56:59], v[156:159], a[120:123], v[56:59]
    v_exp_f32 v81, v81
    v_mfma_f32_16x16x32_bf16 v[60:63], v[144:147], a[76:79], v[60:63]
    buffer_load_dwordx4 v25, s[8:11], s36 offen offset:3072  lds
    v_mfma_f32_16x16x32_bf16 v[60:63], v[148:151], a[92:95], v[60:63]
    v_mfma_f32_16x16x32_bf16 v[96:99], v[44:47], v[116:119], v[96:99]
    ds_write_b128 v16, v[116:119] offset:18432
    v_mfma_f32_16x16x32_bf16 v[60:63], v[152:155], a[108:111], v[60:63]
    v_exp_f32 v82, v82
    v_mfma_f32_16x16x32_bf16 v[60:63], v[156:159], a[124:127], v[60:63]
    v_exp_f32 v83, v83
    v_cvt_pk_bf16_f32 v122, v80, v81
    v_cvt_pk_bf16_f32 v123, v82, v83
    s_nop 1
    v_mfma_f32_16x16x32_bf16 v[100:103], v[44:47], v[120:123], v[100:103]
    ds_write_b128 v16, v[120:123] offset:19456
    s_waitcnt lgkmcnt(2)
    v_mfma_f32_16x16x32_bf16 v[68:71], v[128:131], a[0:3], 0
    s_xor_b32 s36, s1, 57344
    s_mov_b32 m0, s28
    v_mfma_f32_16x16x32_bf16 v[68:71], v[132:135], a[16:19], v[68:71]
    buffer_load_dwordx4 v22, s[8:11], s36 offen offset:0  lds
    v_mfma_f32_16x16x32_bf16 v[68:71], v[136:139], a[32:35], v[68:71]
    v_exp_f32 v48, v48
    v_mfma_f32_16x16x32_bf16 v[68:71], v[140:143], a[48:51], v[68:71]
    v_exp_f32 v49, v49
    v_mfma_f32_16x16x32_bf16 v[72:75], v[128:131], a[4:7], 0
    buffer_load_dwordx4 v23, s[8:11], s36 offen offset:1024  lds
    v_mfma_f32_16x16x32_bf16 v[72:75], v[132:135], a[20:23], v[72:75]
    v_exp_f32 v50, v50
    v_mfma_f32_16x16x32_bf16 v[72:75], v[136:139], a[36:39], v[72:75]
    v_exp_f32 v51, v51
    v_mfma_f32_16x16x32_bf16 v[72:75], v[140:143], a[52:55], v[72:75]
    v_cvt_pk_bf16_f32 v108, v48, v49
    v_cvt_pk_bf16_f32 v109, v50, v51
    v_mfma_f32_16x16x32_bf16 v[76:79], v[128:131], a[8:11], 0
    s_waitcnt vmcnt(11)
    buffer_load_dwordx4 v24, s[8:11], s36 offen offset:2048  lds
    ds_read_b128 v[144:147], v6 offset:4096
    v_mfma_f32_16x16x32_bf16 v[76:79], v[132:135], a[24:27], v[76:79]
    ds_read_b128 v[148:151], v7 offset:4096
    ds_read_b128 v[152:155], v6 offset:6144
    v_mfma_f32_16x16x32_bf16 v[76:79], v[136:139], a[40:43], v[76:79]
    ds_read_b128 v[156:159], v7 offset:6144
    v_mfma_f32_16x16x32_bf16 v[76:79], v[140:143], a[56:59], v[76:79]
    v_exp_f32 v52, v52
    v_mfma_f32_16x16x32_bf16 v[80:83], v[128:131], a[12:15], 0
    buffer_load_dwordx4 v25, s[8:11], s36 offen offset:3072  lds
    v_mfma_f32_16x16x32_bf16 v[80:83], v[132:135], a[28:31], v[80:83]
    v_exp_f32 v53, v53
    v_mfma_f32_16x16x32_bf16 v[80:83], v[136:139], a[44:47], v[80:83]
    v_exp_f32 v54, v54
    v_mfma_f32_16x16x32_bf16 v[80:83], v[140:143], a[60:63], v[80:83]
    v_exp_f32 v55, v55
    s_waitcnt lgkmcnt(0)
    v_mfma_f32_16x16x32_bf16 v[68:71], v[144:147], a[64:67], v[68:71]
    s_xor_b32 s36, s1, 57600
    s_mov_b32 m0, s29
    v_cvt_pk_bf16_f32 v112, v52, v53
    v_mfma_f32_16x16x32_bf16 v[68:71], v[148:151], a[80:83], v[68:71]
    buffer_load_dwordx4 v22, s[8:11], s36 offen offset:0  lds
    v_cvt_pk_bf16_f32 v113, v54, v55
    v_mfma_f32_16x16x32_bf16 v[68:71], v[152:155], a[96:99], v[68:71]
    v_exp_f32 v56, v56
    v_mfma_f32_16x16x32_bf16 v[68:71], v[156:159], a[112:115], v[68:71]
    v_exp_f32 v57, v57
    v_mfma_f32_16x16x32_bf16 v[72:75], v[144:147], a[68:71], v[72:75]
    buffer_load_dwordx4 v23, s[8:11], s36 offen offset:1024  lds
    v_mfma_f32_16x16x32_bf16 v[72:75], v[148:151], a[84:87], v[72:75]
    v_exp_f32 v58, v58
    v_mfma_f32_16x16x32_bf16 v[72:75], v[152:155], a[100:103], v[72:75]
    v_exp_f32 v59, v59
    v_mfma_f32_16x16x32_bf16 v[72:75], v[156:159], a[116:119], v[72:75]
    v_cvt_pk_bf16_f32 v116, v56, v57
    v_cvt_pk_bf16_f32 v117, v58, v59
    v_mfma_f32_16x16x32_bf16 v[76:79], v[144:147], a[72:75], v[76:79]
    s_waitcnt vmcnt(10)
    buffer_load_dwordx4 v24, s[8:11], s36 offen offset:2048  lds
    ds_read_b128 v[128:131], v6 offset:8192
    v_mfma_f32_16x16x32_bf16 v[76:79], v[148:151], a[88:91], v[76:79]
    ds_read_b128 v[132:135], v7 offset:8192
    ds_read_b128 v[136:139], v6 offset:10240
    v_mfma_f32_16x16x32_bf16 v[76:79], v[152:155], a[104:107], v[76:79]
    ds_read_b128 v[140:143], v7 offset:10240
    v_mfma_f32_16x16x32_bf16 v[76:79], v[156:159], a[120:123], v[76:79]
    v_exp_f32 v60, v60
    v_mfma_f32_16x16x32_bf16 v[80:83], v[144:147], a[76:79], v[80:83]
    buffer_load_dwordx4 v25, s[8:11], s36 offen offset:3072  lds
    v_mfma_f32_16x16x32_bf16 v[80:83], v[148:151], a[92:95], v[80:83]
    v_exp_f32 v61, v61
    v_mfma_f32_16x16x32_bf16 v[80:83], v[152:155], a[108:111], v[80:83]
    v_exp_f32 v62, v62
    v_mfma_f32_16x16x32_bf16 v[80:83], v[156:159], a[124:127], v[80:83]
    v_exp_f32 v63, v63
    v_cvt_pk_bf16_f32 v120, v60, v61
    v_cvt_pk_bf16_f32 v121, v62, v63
    s_waitcnt lgkmcnt(0)
    v_mfma_f32_16x16x32_bf16 v[48:51], v[128:131], a[0:3], 0
    s_xor_b32 s36, s0, 32768
    s_mov_b32 m0, s30
    v_mfma_f32_16x16x32_bf16 v[48:51], v[132:135], a[16:19], v[48:51]
    buffer_load_dwordx4 v26, s[12:15], s36 offen offset:0  lds
    v_mfma_f32_16x16x32_bf16 v[48:51], v[136:139], a[32:35], v[48:51]
    v_exp_f32 v68, v68
    v_mfma_f32_16x16x32_bf16 v[48:51], v[140:143], a[48:51], v[48:51]
    v_exp_f32 v69, v69
    v_mfma_f32_16x16x32_bf16 v[52:55], v[128:131], a[4:7], 0
    buffer_load_dwordx4 v27, s[12:15], s36 offen offset:1024  lds
    v_mfma_f32_16x16x32_bf16 v[52:55], v[132:135], a[20:23], v[52:55]
    v_exp_f32 v70, v70
    v_mfma_f32_16x16x32_bf16 v[52:55], v[136:139], a[36:39], v[52:55]
    v_exp_f32 v71, v71
    v_mfma_f32_16x16x32_bf16 v[52:55], v[140:143], a[52:55], v[52:55]
    v_cvt_pk_bf16_f32 v110, v68, v69
    v_cvt_pk_bf16_f32 v111, v70, v71
    v_mfma_f32_16x16x32_bf16 v[56:59], v[128:131], a[8:11], 0
    s_waitcnt vmcnt(10)
    buffer_load_dwordx4 v28, s[12:15], s36 offen offset:2048  lds
    ds_read_b128 v[144:147], v6 offset:12288
    v_mfma_f32_16x16x32_bf16 v[56:59], v[132:135], a[24:27], v[56:59]
    ds_read_b128 v[148:151], v7 offset:12288
    ds_read_b128 v[152:155], v6 offset:14336
    v_mfma_f32_16x16x32_bf16 v[56:59], v[136:139], a[40:43], v[56:59]
    ds_read_b128 v[156:159], v7 offset:14336
    v_mfma_f32_16x16x32_bf16 v[56:59], v[140:143], a[56:59], v[56:59]
    v_exp_f32 v72, v72
    v_mfma_f32_16x16x32_bf16 v[60:63], v[128:131], a[12:15], 0
    buffer_load_dwordx4 v29, s[12:15], s36 offen offset:3072  lds
    v_mfma_f32_16x16x32_bf16 v[60:63], v[132:135], a[28:31], v[60:63]
    v_exp_f32 v73, v73
    v_mfma_f32_16x16x32_bf16 v[60:63], v[136:139], a[44:47], v[60:63]
    v_mfma_f32_16x16x32_bf16 v[88:91], v[44:47], v[108:111], v[88:91]
    ds_write_b128 v15, v[108:111] offset:0
    v_mfma_f32_16x16x32_bf16 v[60:63], v[140:143], a[60:63], v[60:63]
    v_exp_f32 v74, v74
    s_waitcnt lgkmcnt(1)
    v_mfma_f32_16x16x32_bf16 v[48:51], v[144:147], a[64:67], v[48:51]
    s_xor_b32 s36, s0, 98304
    s_mov_b32 m0, s31
    v_mfma_f32_16x16x32_bf16 v[48:51], v[148:151], a[80:83], v[48:51]
    buffer_load_dwordx4 v26, s[12:15], s36 offen offset:0  lds
    v_mfma_f32_16x16x32_bf16 v[48:51], v[152:155], a[96:99], v[48:51]
    v_exp_f32 v75, v75
    v_mfma_f32_16x16x32_bf16 v[48:51], v[156:159], a[112:115], v[48:51]
    v_cvt_pk_bf16_f32 v114, v72, v73
    v_cvt_pk_bf16_f32 v115, v74, v75
    v_mfma_f32_16x16x32_bf16 v[52:55], v[144:147], a[68:71], v[52:55]
    buffer_load_dwordx4 v27, s[12:15], s36 offen offset:1024  lds
    v_mfma_f32_16x16x32_bf16 v[52:55], v[148:151], a[84:87], v[52:55]
    v_exp_f32 v76, v76
    v_mfma_f32_16x16x32_bf16 v[52:55], v[152:155], a[100:103], v[52:55]
    v_exp_f32 v77, v77
    v_mfma_f32_16x16x32_bf16 v[52:55], v[156:159], a[116:119], v[52:55]
    v_mfma_f32_16x16x32_bf16 v[92:95], v[44:47], v[112:115], v[92:95]
    ds_write_b128 v15, v[112:115] offset:1024
    v_mfma_f32_16x16x32_bf16 v[56:59], v[144:147], a[72:75], v[56:59]
    s_waitcnt vmcnt(10)
    buffer_load_dwordx4 v28, s[12:15], s36 offen offset:2048  lds
    ds_read_b128 v[128:131], v6 offset:0
    v_mfma_f32_16x16x32_bf16 v[56:59], v[148:151], a[88:91], v[56:59]
    ds_read_b128 v[132:135], v7 offset:0
    ds_read_b128 v[136:139], v6 offset:2048
    v_mfma_f32_16x16x32_bf16 v[56:59], v[152:155], a[104:107], v[56:59]
    ds_read_b128 v[140:143], v7 offset:2048
    v_mfma_f32_16x16x32_bf16 v[56:59], v[156:159], a[120:123], v[56:59]
    v_exp_f32 v78, v78
    v_mfma_f32_16x16x32_bf16 v[60:63], v[144:147], a[76:79], v[60:63]
    buffer_load_dwordx4 v29, s[12:15], s36 offen offset:3072  lds
    v_mfma_f32_16x16x32_bf16 v[60:63], v[148:151], a[92:95], v[60:63]
    v_exp_f32 v79, v79
    v_mfma_f32_16x16x32_bf16 v[60:63], v[152:155], a[108:111], v[60:63]
    v_cvt_pk_bf16_f32 v118, v76, v77
    v_cvt_pk_bf16_f32 v119, v78, v79
    v_mfma_f32_16x16x32_bf16 v[60:63], v[156:159], a[124:127], v[60:63]
    v_exp_f32 v80, v80
    v_exp_f32 v81, v81
    v_mfma_f32_16x16x32_bf16 v[96:99], v[44:47], v[116:119], v[96:99]
    ds_write_b128 v15, v[116:119] offset:2048
    v_exp_f32 v82, v82
    v_exp_f32 v83, v83
    v_cvt_pk_bf16_f32 v122, v80, v81
    v_cvt_pk_bf16_f32 v123, v82, v83
    s_nop 1
    v_mfma_f32_16x16x32_bf16 v[100:103], v[44:47], v[120:123], v[100:103]
    ds_write_b128 v15, v[120:123] offset:3072
    s_waitcnt lgkmcnt(2)
    v_mfma_f32_16x16x32_bf16 v[68:71], v[128:131], a[0:3], 0
    s_xor_b32 s36, s0, 163840
    s_mov_b32 m0, s28
    v_mfma_f32_16x16x32_bf16 v[68:71], v[132:135], a[16:19], v[68:71]
    buffer_load_dwordx4 v26, s[12:15], s36 offen offset:0  lds
    v_mfma_f32_16x16x32_bf16 v[68:71], v[136:139], a[32:35], v[68:71]
    v_exp_f32 v48, v48
    v_mfma_f32_16x16x32_bf16 v[68:71], v[140:143], a[48:51], v[68:71]
    v_exp_f32 v49, v49
    v_mfma_f32_16x16x32_bf16 v[72:75], v[128:131], a[4:7], 0
    buffer_load_dwordx4 v27, s[12:15], s36 offen offset:1024  lds
    v_mfma_f32_16x16x32_bf16 v[72:75], v[132:135], a[20:23], v[72:75]
    v_exp_f32 v50, v50
    v_mfma_f32_16x16x32_bf16 v[72:75], v[136:139], a[36:39], v[72:75]
    v_exp_f32 v51, v51
    v_mfma_f32_16x16x32_bf16 v[72:75], v[140:143], a[52:55], v[72:75]
    v_cvt_pk_bf16_f32 v108, v48, v49
    v_cvt_pk_bf16_f32 v109, v50, v51
    v_mfma_f32_16x16x32_bf16 v[76:79], v[128:131], a[8:11], 0
    s_waitcnt vmcnt(10)
    buffer_load_dwordx4 v28, s[12:15], s36 offen offset:2048  lds
    ds_read_b128 v[144:147], v6 offset:4096
    v_mfma_f32_16x16x32_bf16 v[76:79], v[132:135], a[24:27], v[76:79]
    ds_read_b128 v[148:151], v7 offset:4096
    ds_read_b128 v[152:155], v6 offset:6144
    v_mfma_f32_16x16x32_bf16 v[76:79], v[136:139], a[40:43], v[76:79]
    ds_read_b128 v[156:159], v7 offset:6144
    v_mfma_f32_16x16x32_bf16 v[76:79], v[140:143], a[56:59], v[76:79]
    v_exp_f32 v52, v52
    v_mfma_f32_16x16x32_bf16 v[80:83], v[128:131], a[12:15], 0
    buffer_load_dwordx4 v29, s[12:15], s36 offen offset:3072  lds
    v_mfma_f32_16x16x32_bf16 v[80:83], v[132:135], a[28:31], v[80:83]
    v_exp_f32 v53, v53
    v_mfma_f32_16x16x32_bf16 v[80:83], v[136:139], a[44:47], v[80:83]
    v_exp_f32 v54, v54
    v_mfma_f32_16x16x32_bf16 v[80:83], v[140:143], a[60:63], v[80:83]
    v_exp_f32 v55, v55
    s_waitcnt lgkmcnt(0)
    v_mfma_f32_16x16x32_bf16 v[68:71], v[144:147], a[64:67], v[68:71]
    s_xor_b32 s36, s0, 229376
    s_mov_b32 m0, s29
    v_cvt_pk_bf16_f32 v112, v52, v53
    v_mfma_f32_16x16x32_bf16 v[68:71], v[148:151], a[80:83], v[68:71]
    buffer_load_dwordx4 v26, s[12:15], s36 offen offset:0  lds
    v_cvt_pk_bf16_f32 v113, v54, v55
    v_mfma_f32_16x16x32_bf16 v[68:71], v[152:155], a[96:99], v[68:71]
    v_exp_f32 v56, v56
    v_mfma_f32_16x16x32_bf16 v[68:71], v[156:159], a[112:115], v[68:71]
    v_exp_f32 v57, v57
    v_mfma_f32_16x16x32_bf16 v[72:75], v[144:147], a[68:71], v[72:75]
    buffer_load_dwordx4 v27, s[12:15], s36 offen offset:1024  lds
    v_mfma_f32_16x16x32_bf16 v[72:75], v[148:151], a[84:87], v[72:75]
    s_waitcnt vmcnt(10)
    ds_read_b64_tr_b16 v[128:129], v1 offset:8192
    ds_read_b64_tr_b16 v[130:131], v1 offset:10240
    v_mfma_f32_16x16x32_bf16 v[72:75], v[152:155], a[100:103], v[72:75]
    ds_read_b64_tr_b16 v[132:133], v2 offset:8192
    ds_read_b64_tr_b16 v[134:135], v2 offset:10240
    v_mfma_f32_16x16x32_bf16 v[72:75], v[156:159], a[116:119], v[72:75]
    ds_read_b64_tr_b16 v[136:137], v3 offset:8192
    ds_read_b64_tr_b16 v[138:139], v3 offset:10240
    v_mfma_f32_16x16x32_bf16 v[76:79], v[144:147], a[72:75], v[76:79]
    buffer_load_dwordx4 v28, s[12:15], s36 offen offset:2048  lds
    ds_read_b64_tr_b16 v[140:141], v4 offset:8192
    v_mfma_f32_16x16x32_bf16 v[76:79], v[148:151], a[88:91], v[76:79]
    ds_read_b64_tr_b16 v[142:143], v4 offset:10240
    v_mfma_f32_16x16x32_bf16 v[76:79], v[152:155], a[104:107], v[76:79]
    v_exp_f32 v58, v58
    v_mfma_f32_16x16x32_bf16 v[76:79], v[156:159], a[120:123], v[76:79]
    v_exp_f32 v59, v59
    v_mfma_f32_16x16x32_bf16 v[80:83], v[144:147], a[76:79], v[80:83]
    buffer_load_dwordx4 v29, s[12:15], s36 offen offset:3072  lds
    v_cvt_pk_bf16_f32 v116, v56, v57
    v_mfma_f32_16x16x32_bf16 v[80:83], v[148:151], a[92:95], v[80:83]
    v_cvt_pk_bf16_f32 v117, v58, v59
    v_mfma_f32_16x16x32_bf16 v[80:83], v[152:155], a[108:111], v[80:83]
    v_exp_f32 v60, v60
    v_mfma_f32_16x16x32_bf16 v[80:83], v[156:159], a[124:127], v[80:83]
    v_exp_f32 v61, v61
    v_exp_f32 v62, v62
    v_exp_f32 v63, v63
    v_cvt_pk_bf16_f32 v120, v60, v61
    v_cvt_pk_bf16_f32 v121, v62, v63
    s_xor_b32 s36, s0, 49152
    s_mov_b32 m0, s30
    v_exp_f32 v68, v68
    v_exp_f32 v69, v69
    v_exp_f32 v70, v70
    v_exp_f32 v71, v71
    s_waitcnt vmcnt(8)
    ds_read_b64_tr_b16 v[144:145], v1 offset:12288
    ds_read_b64_tr_b16 v[146:147], v1 offset:14336
    s_waitcnt lgkmcnt(2)
    buffer_load_dwordx4 v26, s[12:15], s36 offen offset:0  lds
    ds_read_b64_tr_b16 v[148:149], v2 offset:12288
    ds_read_b64_tr_b16 v[150:151], v2 offset:14336
    ds_read_b64_tr_b16 v[152:153], v3 offset:12288
    ds_read_b64_tr_b16 v[154:155], v3 offset:14336
    ds_read_b64_tr_b16 v[156:157], v4 offset:12288
    ds_read_b64_tr_b16 v[158:159], v4 offset:14336
    v_cvt_pk_bf16_f32 v110, v68, v69
    v_cvt_pk_bf16_f32 v111, v70, v71
    buffer_load_dwordx4 v27, s[12:15], s36 offen offset:1024  lds
    v_exp_f32 v72, v72
    v_exp_f32 v73, v73
    v_mfma_f32_16x16x32_bf16 v[88:91], v[44:47], v[108:111], v[88:91]
    ds_write_b128 v15, v[108:111] offset:16384
    v_exp_f32 v74, v74
    v_exp_f32 v75, v75
    v_cvt_pk_bf16_f32 v114, v72, v73
    v_cvt_pk_bf16_f32 v115, v74, v75
    buffer_load_dwordx4 v28, s[12:15], s36 offen offset:2048  lds
    v_exp_f32 v76, v76
    v_exp_f32 v77, v77
    v_mfma_f32_16x16x32_bf16 v[92:95], v[44:47], v[112:115], v[92:95]
    ds_write_b128 v15, v[112:115] offset:17408
    v_exp_f32 v78, v78
    v_exp_f32 v79, v79
    v_cvt_pk_bf16_f32 v118, v76, v77
    v_cvt_pk_bf16_f32 v119, v78, v79
    v_exp_f32 v80, v80
    buffer_load_dwordx4 v29, s[12:15], s36 offen offset:3072  lds
    v_exp_f32 v81, v81
    v_mfma_f32_16x16x32_bf16 v[96:99], v[44:47], v[116:119], v[96:99]
    ds_write_b128 v15, v[116:119] offset:18432
    v_exp_f32 v82, v82
    v_exp_f32 v83, v83
    v_cvt_pk_bf16_f32 v122, v80, v81
    v_cvt_pk_bf16_f32 v123, v82, v83
    s_nop 1
    v_mfma_f32_16x16x32_bf16 v[100:103], v[44:47], v[120:123], v[100:103]
    ds_write_b128 v15, v[120:123] offset:19456
    ds_write_b32 v13, v88 offset:0
    ds_write_b32 v13, v92 offset:256
    ds_write_b32 v13, v96 offset:512
    s_nop 3
    ds_write_b32 v13, v100 offset:768
    v_cmp_eq_u32 vcc, 0, v250
    s_waitcnt lgkmcnt(0)
    s_barrier
    s_cbranch_vccnz L_ep_l
L_epok_l:
    s_xor_b32 s36, s0, 114688
    s_mov_b32 m0, s31
    s_nop 0
    buffer_load_dwordx4 v26, s[12:15], s36 offen offset:0  lds
    buffer_load_dwordx4 v27, s[12:15], s36 offen offset:1024  lds
    buffer_load_dwordx4 v28, s[12:15], s36 offen offset:2048  lds
    buffer_load_dwordx4 v29, s[12:15], s36 offen offset:3072  lds
L_pv_l:
    ds_read_b128 v[200:203], v14 offset:0
    ds_read_b128 v[204:207], v14 offset:256
    ds_read_b128 v[208:211], v14 offset:512
    ds_read_b128 v[212:215], v14 offset:768
    ds_read_b128 v[160:163], v10 offset:0
    ds_read_b128 v[164:167], v10 offset:1024
    ds_read_b128 v[168:171], v10 offset:2048
    ds_read_b128 v[172:175], v10 offset:3072
    s_waitcnt lgkmcnt(7)
    v_add_f32 v200, v200, v201
    v_add_f32 v202, v202, v203
    v_add_f32 v245, v200, v202
    v_rcp_f32 v240, v245
    s_waitcnt lgkmcnt(6)
    v_add_f32 v204, v204, v205
    v_add_f32 v206, v206, v207
    v_add_f32 v246, v204, v206
    v_rcp_f32 v241, v246
    s_waitcnt lgkmcnt(5)
    v_add_f32 v208, v208, v209
    v_add_f32 v210, v210, v211
    v_add_f32 v247, v208, v210
    v_rcp_f32 v242, v247
    s_waitcnt lgkmcnt(4)
    v_add_f32 v212, v212, v213
    v_add_f32 v214, v214, v215
    v_add_f32 v248, v212, v214
    v_rcp_f32 v243, v248
    v_max_f32 v38, v245, v240
    v_max3_f32 v38, v38, v246, v241
    v_max3_f32 v38, v38, v247, v242
    v_max3_f32 v38, v38, v248, v243
    v_cmp_lt_f32 vcc, 0x5d800000, v38
    s_nop 1
    s_cbranch_vccz L_pvgo_l
    s_cmp_eq_u32 s39, 0
    s_cbranch_scc1 L_slow_l
L_pvgo_l:
    s_waitcnt lgkmcnt(0)
    v_mfma_f32_16x16x32_bf16 v[48:51], v[128:131], v[160:163], 0
    ds_read_b128 v[180:183], v10 offset:4096
    ds_read_b128 v[184:187], v10 offset:5120
    v_mfma_f32_16x16x32_bf16 v[64:67], v[132:135], v[160:163], 0
    v_add_u32 v40, 0, v0
    v_bfe_u32 v41, v40, 1, 1
    v_lshlrev_b32 v41, 7, v41
    v_and_or_b32 v41, v40, 1, v41
    v_mul_u32_u24 v41, 896, v41
    v_lshrrev_b32 v40, 2, v40
    v_lshl_add_u32 v40, v40, 7, v41
    s_mul_i32 s35, s73, 1792
    s_mov_b64 exec, 0xffff
    buffer_load_dword v39, v40, s[20:23], s35 offen
    s_mov_b64 exec, -1
    v_mfma_f32_16x16x32_bf16 v[80:83], v[136:139], v[160:163], 0
    ds_read_b128 v[188:191], v10 offset:6144
    ds_read_b128 v[192:195], v10 offset:7168
    v_mfma_f32_16x16x32_bf16 v[96:99], v[140:143], v[160:163], 0
    v_mfma_f32_16x16x32_bf16 v[100:103], v[140:143], v[164:167], 0
    v_mfma_f32_16x16x32_bf16 v[84:87], v[136:139], v[164:167], 0
    v_mfma_f32_16x16x32_bf16 v[68:71], v[132:135], v[164:167], 0
    v_mfma_f32_16x16x32_bf16 v[52:55], v[128:131], v[164:167], 0
    v_mfma_f32_16x16x32_bf16 v[56:59], v[128:131], v[168:171], 0
    v_mfma_f32_16x16x32_bf16 v[72:75], v[132:135], v[168:171], 0
    v_mfma_f32_16x16x32_bf16 v[88:91], v[136:139], v[168:171], 0
    v_mfma_f32_16x16x32_bf16 v[104:107], v[140:143], v[168:171], 0
    v_mfma_f32_16x16x32_bf16 v[108:111], v[140:143], v[172:175], 0
    v_mfma_f32_16x16x32_bf16 v[92:95], v[136:139], v[172:175], 0
    v_mfma_f32_16x16x32_bf16 v[76:79], v[132:135], v[172:175], 0
    v_mfma_f32_16x16x32_bf16 v[60:63], v[128:131], v[172:175], 0
    s_waitcnt lgkmcnt(0)
    v_mfma_f32_16x16x32_bf16 v[48:51], v[144:147], v[180:183], v[48:51]
    ds_read_b128 v[160:163], v10 offset:8192
    s_mov_b32 s4, s50
    v_mfma_f32_16x16x32_bf16 v[64:67], v[148:151], v[180:183], v[64:67]
    ds_read_b128 v[164:167], v10 offset:9216
    s_mov_b32 s5, s51
    v_mfma_f32_16x16x32_bf16 v[80:83], v[152:155], v[180:183], v[80:83]
    ds_read_b128 v[168:171], v10 offset:10240
    s_mov_b32 s6, 268435456
    v_mfma_f32_16x16x32_bf16 v[96:99], v[156:159], v[180:183], v[96:99]
    ds_read_b128 v[172:175], v10 offset:11264
    s_mov_b32 s7, 0x20000
    v_mfma_f32_16x16x32_bf16 v[100:103], v[156:159], v[184:187], v[100:103]
    s_waitcnt vmcnt(13)
    ds_read_b64_tr_b16 v[128:129], v1 offset:0
    s_mov_b32 s16, s46
    v_mfma_f32_16x16x32_bf16 v[84:87], v[152:155], v[184:187], v[84:87]
    ds_read_b64_tr_b16 v[130:131], v1 offset:2048
    s_mov_b32 s17, s47
    v_mfma_f32_16x16x32_bf16 v[68:71], v[148:151], v[184:187], v[68:71]
    ds_read_b64_tr_b16 v[132:133], v2 offset:0
    s_mov_b32 s18, 1032192
    v_mfma_f32_16x16x32_bf16 v[52:55], v[144:147], v[184:187], v[52:55]
    ds_read_b64_tr_b16 v[134:135], v2 offset:2048
    s_mov_b32 s19, 0x20000
    v_mfma_f32_16x16x32_bf16 v[56:59], v[144:147], v[188:191], v[56:59]
    ds_read_b64_tr_b16 v[136:137], v3 offset:0
    v_readfirstlane_b32 s54, v250
    v_mfma_f32_16x16x32_bf16 v[72:75], v[148:151], v[188:191], v[72:75]
    ds_read_b64_tr_b16 v[138:139], v3 offset:2048
    s_mov_b32 s58, s3
    v_mfma_f32_16x16x32_bf16 v[88:91], v[152:155], v[188:191], v[88:91]
    ds_read_b64_tr_b16 v[140:141], v4 offset:0
    s_and_b32 s61, s54, 16
    v_mfma_f32_16x16x32_bf16 v[104:107], v[156:159], v[188:191], v[104:107]
    ds_read_b64_tr_b16 v[142:143], v4 offset:2048
    s_lshl_b32 s61, s61, 9
    v_mfma_f32_16x16x32_bf16 v[108:111], v[156:159], v[192:195], v[108:111]
    s_and_b32 s54, s54, 14
    s_add_u32 s54, s54, s33
    v_mfma_f32_16x16x32_bf16 v[92:95], v[152:155], v[192:195], v[92:95]
    s_and_b32 s54, s54, 15
    s_lshr_b32 s42, s54, 3
    v_mfma_f32_16x16x32_bf16 v[76:79], v[148:151], v[192:195], v[76:79]
    s_lshl_b32 s54, s54, 2
    s_mov_b32 s56, 539230722
    v_mfma_f32_16x16x32_bf16 v[60:63], v[144:147], v[192:195], v[60:63]
    s_mov_b32 s57, 320017171
    s_lshr_b64 s[56:57], s[56:57], s54
    s_waitcnt lgkmcnt(0)
    v_mfma_f32_16x16x32_bf16 v[48:51], v[128:131], v[160:163], v[48:51]
    s_xor_b32 s36, s0, 180224
    s_mov_b32 m0, s28
    ds_read_b128 v[180:183], v10 offset:12288
    v_mfma_f32_16x16x32_bf16 v[64:67], v[132:135], v[160:163], v[64:67]
    buffer_load_dwordx4 v26, s[12:15], s36 offen offset:0  lds
    ds_read_b128 v[184:187], v10 offset:13312
    v_mfma_f32_16x16x32_bf16 v[80:83], v[136:139], v[160:163], v[80:83]
    ds_read_b128 v[188:191], v10 offset:14336
    s_and_b32 s52, s56, 15
    v_mfma_f32_16x16x32_bf16 v[96:99], v[140:143], v[160:163], v[96:99]
    ds_read_b128 v[192:195], v10 offset:15360
    s_mov_b32 s56, 841027840
    v_mfma_f32_16x16x32_bf16 v[100:103], v[140:143], v[164:167], v[100:103]
    s_waitcnt vmcnt(10)
    buffer_load_dwordx4 v27, s[12:15], s36 offen offset:1024  lds
    ds_read_b64_tr_b16 v[144:145], v1 offset:4096
    v_mfma_f32_16x16x32_bf16 v[84:87], v[136:139], v[164:167], v[84:87]
    ds_read_b64_tr_b16 v[146:147], v1 offset:6144
    s_mov_b32 s57, 857870592
    v_mfma_f32_16x16x32_bf16 v[68:71], v[132:135], v[164:167], v[68:71]
    ds_read_b64_tr_b16 v[148:149], v2 offset:4096
    s_lshr_b64 s[56:57], s[56:57], s54
    v_mfma_f32_16x16x32_bf16 v[52:55], v[128:131], v[164:167], v[52:55]
    ds_read_b64_tr_b16 v[150:151], v2 offset:6144
    s_and_b32 s53, s56, 15
    v_mfma_f32_16x16x32_bf16 v[56:59], v[128:131], v[168:171], v[56:59]
    buffer_load_dwordx4 v28, s[12:15], s36 offen offset:2048  lds
    ds_read_b64_tr_b16 v[152:153], v3 offset:4096
    v_mfma_f32_16x16x32_bf16 v[72:75], v[132:135], v[168:171], v[72:75]
    ds_read_b64_tr_b16 v[154:155], v3 offset:6144
    s_mov_b32 s56, 2997295368
    v_mfma_f32_16x16x32_bf16 v[88:91], v[136:139], v[168:171], v[88:91]
    ds_read_b64_tr_b16 v[156:157], v4 offset:4096
    s_mov_b32 s57, 992614664
    v_mfma_f32_16x16x32_bf16 v[104:107], v[140:143], v[168:171], v[104:107]
    ds_read_b64_tr_b16 v[158:159], v4 offset:6144
    s_lshr_b64 s[56:57], s[56:57], s54
    v_mfma_f32_16x16x32_bf16 v[108:111], v[140:143], v[172:175], v[108:111]
    buffer_load_dwordx4 v29, s[12:15], s36 offen offset:3072  lds
    s_and_b32 s59, s56, 15
    v_mfma_f32_16x16x32_bf16 v[92:95], v[136:139], v[172:175], v[92:95]
    s_lshl3_add_u32 s54, s52, s53
    v_mfma_f32_16x16x32_bf16 v[76:79], v[132:135], v[172:175], v[76:79]
    s_cmp_eq_u32 s54, 38
    s_cselect_b32 s43, 0xffff, -1
    v_mfma_f32_16x16x32_bf16 v[60:63], v[128:131], v[172:175], v[60:63]
    s_lshl_b32 s56, s32, 14
    s_mul_i32 s55, s3, 896
    s_waitcnt lgkmcnt(0)
    v_mfma_f32_16x16x32_bf16 v[48:51], v[144:147], v[180:183], v[48:51]
    ds_read_b128 v[160:163], v10 offset:16384
    s_add_u32 s55, s55, s56
    v_mfma_f32_16x16x32_bf16 v[64:67], v[148:151], v[180:183], v[64:67]
    s_getpc_b64 s[44:45]
L_pc33_l:
    s_lshr_b32 s35, s2, 4
    s_lshl2_add_u32 s35, s35, s3
    s_lshr_b32 s35, s35, 1
    v_lshl_add_u32 v40, v0, 5, s35
    v_lshlrev_b32 v40, 7, v40
    v_min_u32 v40, L_end_l-L_pc33_l, v40
    s_mov_b64 exec, 15
    global_load_dword v39, v40, s[44:45]
    s_mov_b64 exec, -1
    v_mfma_f32_16x16x32_bf16 v[80:83], v[152:155], v[180:183], v[80:83]
    ds_read_b128 v[164:167], v10 offset:17408
    s_lshl2_add_u32 s55, s33, s55
    v_mfma_f32_16x16x32_bf16 v[96:99], v[156:159], v[180:183], v[96:99]
    s_xor_b32 s36, s0, 245760
    s_mov_b32 m0, s29
    ds_read_b128 v[168:171], v10 offset:18432
    v_mfma_f32_16x16x32_bf16 v[100:103], v[156:159], v[184:187], v[100:103]
    buffer_load_dwordx4 v26, s[12:15], s36 offen offset:0  lds
    ds_read_b128 v[172:175], v10 offset:19456
    v_mfma_f32_16x16x32_bf16 v[84:87], v[152:155], v[184:187], v[84:87]
    s_waitcnt vmcnt(11)
    ds_read_b64_tr_b16 v[128:129], v1 offset:8192
    s_add_u32 s40, s55, 16780800
    v_mfma_f32_16x16x32_bf16 v[68:71], v[148:151], v[184:187], v[68:71]
    ds_read_b64_tr_b16 v[130:131], v1 offset:10240
    s_mul_i32 s55, s58, 896
    v_mfma_f32_16x16x32_bf16 v[52:55], v[144:147], v[184:187], v[52:55]
    buffer_load_dwordx4 v27, s[12:15], s36 offen offset:1024  lds
    ds_read_b64_tr_b16 v[132:133], v2 offset:8192
    v_mfma_f32_16x16x32_bf16 v[56:59], v[144:147], v[188:191], v[56:59]
    ds_read_b64_tr_b16 v[134:135], v2 offset:10240
    s_add_u32 s55, s55, s56
    v_mfma_f32_16x16x32_bf16 v[72:75], v[148:151], v[188:191], v[72:75]
    ds_read_b64_tr_b16 v[136:137], v3 offset:8192
    s_lshl_b32 s56, s42, 13
    v_mfma_f32_16x16x32_bf16 v[88:91], v[152:155], v[188:191], v[88:91]
    buffer_load_dwordx4 v28, s[12:15], s36 offen offset:2048  lds
    ds_read_b64_tr_b16 v[138:139], v3 offset:10240
    v_mfma_f32_16x16x32_bf16 v[104:107], v[156:159], v[188:191], v[104:107]
    ds_read_b64_tr_b16 v[140:141], v4 offset:8192
    s_add_u32 s55, s55, 0
    v_mfma_f32_16x16x32_bf16 v[108:111], v[156:159], v[192:195], v[108:111]
    ds_read_b64_tr_b16 v[142:143], v4 offset:10240
    s_lshl_b32 s54, s53, 2
    v_mfma_f32_16x16x32_bf16 v[92:95], v[152:155], v[192:195], v[92:95]
    buffer_load_dwordx4 v29, s[12:15], s36 offen offset:3072  lds
    s_lshr_b32 s56, 107361075, s54
    v_mfma_f32_16x16x32_bf16 v[76:79], v[148:151], v[192:195], v[76:79]
    s_and_b32 s56, s56, 15
    s_bfe_u32 s54, s52, 0x10001
    v_mfma_f32_16x16x32_bf16 v[60:63], v[144:147], v[192:195], v[60:63]
    s_mul_i32 s54, s54, 28
    s_add_u32 s54, s54, s56
    s_waitcnt lgkmcnt(0)
    v_mfma_f32_16x16x32_bf16 v[48:51], v[128:131], v[160:163], v[48:51]
    s_xor_b32 s36, s0, 0
    s_mov_b32 m0, s30
    ds_read_b128 v[180:183], v10 offset:20480
    v_mfma_f32_16x16x32_bf16 v[64:67], v[132:135], v[160:163], v[64:67]
    buffer_load_dwordx4 v26, s[12:15], s36 offen offset:0  lds
    ds_read_b128 v[184:187], v10 offset:21504
    v_mfma_f32_16x16x32_bf16 v[80:83], v[136:139], v[160:163], v[80:83]
    ds_read_b128 v[188:191], v10 offset:22528
    s_lshl_b32 s54, s54, 7
    v_mfma_f32_16x16x32_bf16 v[96:99], v[140:143], v[160:163], v[96:99]
    ds_read_b128 v[192:195], v10 offset:23552
    s_add_u32 s54, s54, s55
    v_mfma_f32_16x16x32_bf16 v[100:103], v[140:143], v[164:167], v[100:103]
    s_waitcnt vmcnt(11)
    buffer_load_dwordx4 v27, s[12:15], s36 offen offset:1024  lds
    ds_read_b64_tr_b16 v[144:145], v1 offset:12288
    v_mfma_f32_16x16x32_bf16 v[84:87], v[136:139], v[164:167], v[84:87]
    ds_read_b64_tr_b16 v[146:147], v1 offset:14336
    s_add_u32 s41, s54, 16777216
    v_mfma_f32_16x16x32_bf16 v[68:71], v[132:135], v[164:167], v[68:71]
    ds_read_b64_tr_b16 v[148:149], v2 offset:12288
    s_and_b32 s54, s32, 1
    v_mfma_f32_16x16x32_bf16 v[52:55], v[128:131], v[164:167], v[52:55]
    ds_read_b64_tr_b16 v[150:151], v2 offset:14336
    s_lshl_b32 s54, s54, 13
    v_mfma_f32_16x16x32_bf16 v[56:59], v[128:131], v[168:171], v[56:59]
    buffer_load_dwordx4 v28, s[12:15], s36 offen offset:2048  lds
    ds_read_b64_tr_b16 v[152:153], v3 offset:12288
    v_mfma_f32_16x16x32_bf16 v[72:75], v[132:135], v[168:171], v[72:75]
    ds_read_b64_tr_b16 v[154:155], v3 offset:14336
    s_lshr_b32 s55, s33, 1
    v_mfma_f32_16x16x32_bf16 v[88:91], v[136:139], v[168:171], v[88:91]
    ds_read_b64_tr_b16 v[156:157], v4 offset:12288
    s_lshl_b32 s55, s55, 2
    v_mfma_f32_16x16x32_bf16 v[104:107], v[140:143], v[168:171], v[104:107]
    ds_read_b64_tr_b16 v[158:159], v4 offset:14336
    s_and_b32 s60, s33, 1
    v_mfma_f32_16x16x32_bf16 v[108:111], v[140:143], v[172:175], v[108:111]
    buffer_load_dwordx4 v29, s[12:15], s36 offen offset:3072  lds
    s_or_b32 s60, s60, s55
    v_mfma_f32_16x16x32_bf16 v[92:95], v[136:139], v[172:175], v[92:95]
    s_lshl2_add_u32 s60, s60, s3
    s_lshl_b32 s60, s60, 10
    v_mfma_f32_16x16x32_bf16 v[76:79], v[132:135], v[172:175], v[76:79]
    s_or_b32 s60, s60, s54
    s_lshl_b32 s55, s33, 12
    v_mfma_f32_16x16x32_bf16 v[60:63], v[128:131], v[172:175], v[60:63]
    s_and_b32 s55, s55, s61
    s_xor_b32 s60, s60, s55
    s_waitcnt lgkmcnt(0)
    v_mfma_f32_16x16x32_bf16 v[48:51], v[144:147], v[180:183], v[48:51]
    s_xor_b32 s36, s0, 65536
    s_mov_b32 m0, s31
    ds_read_b128 v[160:163], v10 offset:24576
    v_mfma_f32_16x16x32_bf16 v[64:67], v[148:151], v[180:183], v[64:67]
    buffer_load_dwordx4 v26, s[12:15], s36 offen offset:0  lds
    ds_read_b128 v[164:167], v10 offset:25600
    v_mfma_f32_16x16x32_bf16 v[80:83], v[152:155], v[180:183], v[80:83]
    ds_read_b128 v[168:171], v10 offset:26624
    s_lshl_b32 s42, s42, 13
    v_mfma_f32_16x16x32_bf16 v[96:99], v[156:159], v[180:183], v[96:99]
    ds_read_b128 v[172:175], v10 offset:27648
    s_xor_b32 s54, s54, s42
    v_mfma_f32_16x16x32_bf16 v[100:103], v[156:159], v[184:187], v[100:103]
    s_waitcnt vmcnt(10)
    buffer_load_dwordx4 v27, s[12:15], s36 offen offset:1024  lds
    ds_read_b64_tr_b16 v[128:129], v1 offset:0
    v_mfma_f32_16x16x32_bf16 v[84:87], v[152:155], v[184:187], v[84:87]
    ds_read_b64_tr_b16 v[130:131], v1 offset:2048
    s_xor_b32 s60, s60, 0
    v_mfma_f32_16x16x32_bf16 v[68:71], v[148:151], v[184:187], v[68:71]
    ds_read_b64_tr_b16 v[132:133], v2 offset:0
    s_lshr_b32 s55, s59, 1
    v_mfma_f32_16x16x32_bf16 v[52:55], v[144:147], v[184:187], v[52:55]
    ds_read_b64_tr_b16 v[134:135], v2 offset:2048
    s_lshl_b32 s55, s55, 2
    v_mfma_f32_16x16x32_bf16 v[56:59], v[144:147], v[188:191], v[56:59]
    buffer_load_dwordx4 v28, s[12:15], s36 offen offset:2048  lds
    ds_read_b64_tr_b16 v[136:137], v3 offset:0
    v_mfma_f32_16x16x32_bf16 v[72:75], v[148:151], v[188:191], v[72:75]
    ds_read_b64_tr_b16 v[138:139], v3 offset:2048
    s_and_b32 s42, s59, 1
    v_mfma_f32_16x16x32_bf16 v[88:91], v[152:155], v[188:191], v[88:91]
    ds_read_b64_tr_b16 v[140:141], v4 offset:0
    s_or_b32 s42, s42, s55
    v_mfma_f32_16x16x32_bf16 v[104:107], v[156:159], v[188:191], v[104:107]
    ds_read_b64_tr_b16 v[142:143], v4 offset:2048
    s_lshl2_add_u32 s42, s42, s3
    v_mfma_f32_16x16x32_bf16 v[108:111], v[156:159], v[192:195], v[108:111]
    buffer_load_dwordx4 v29, s[12:15], s36 offen offset:3072  lds
    s_lshl_b32 s42, s42, 10
    v_mfma_f32_16x16x32_bf16 v[92:95], v[152:155], v[192:195], v[92:95]
    s_or_b32 s42, s42, s54
    s_lshl_b32 s54, s32, 21
    v_mfma_f32_16x16x32_bf16 v[76:79], v[148:151], v[192:195], v[76:79]
    s_or_b32 s42, s42, s54
    s_xor_b32 s61, s61, s42
    v_mfma_f32_16x16x32_bf16 v[60:63], v[144:147], v[192:195], v[60:63]
    s_lshl_b32 s54, s52, 3
    s_mov_b32 s56, 1884299264
    s_waitcnt lgkmcnt(0)
    v_mfma_f32_16x16x32_bf16 v[48:51], v[128:131], v[160:163], v[48:51]
    s_xor_b32 s36, s0, 131072
    s_mov_b32 m0, s28
    ds_read_b128 v[180:183], v10 offset:28672
    v_mfma_f32_16x16x32_bf16 v[64:67], v[132:135], v[160:163], v[64:67]
    buffer_load_dwordx4 v26, s[12:15], s36 offen offset:0  lds
    ds_read_b128 v[184:187], v10 offset:29696
    v_mfma_f32_16x16x32_bf16 v[80:83], v[136:139], v[160:163], v[80:83]
    ds_read_b128 v[188:191], v10 offset:30720
    s_mov_b32 s57, 64
    v_mfma_f32_16x16x32_bf16 v[96:99], v[140:143], v[160:163], v[96:99]
    ds_read_b128 v[192:195], v10 offset:31744
    s_lshr_b64 s[56:57], s[56:57], s54
    v_mfma_f32_16x16x32_bf16 v[100:103], v[140:143], v[164:167], v[100:103]
    s_waitcnt vmcnt(9)
    buffer_load_dwordx4 v27, s[12:15], s36 offen offset:1024  lds
    ds_read_b64_tr_b16 v[144:145], v1 offset:4096
    v_mfma_f32_16x16x32_bf16 v[84:87], v[136:139], v[164:167], v[84:87]
    ds_read_b64_tr_b16 v[146:147], v1 offset:6144
    s_and_b32 s54, s56, 255
    v_mfma_f32_16x16x32_bf16 v[68:71], v[132:135], v[164:167], v[68:71]
    ds_read_b64_tr_b16 v[148:149], v2 offset:4096
    s_mul_i32 s55, s32, 144
    v_mfma_f32_16x16x32_bf16 v[52:55], v[128:131], v[164:167], v[52:55]
    ds_read_b64_tr_b16 v[150:151], v2 offset:6144
    s_add_u32 s54, s54, s55
    v_mfma_f32_16x16x32_bf16 v[56:59], v[128:131], v[168:171], v[56:59]
    buffer_load_dwordx4 v28, s[12:15], s36 offen offset:2048  lds
    ds_read_b64_tr_b16 v[152:153], v3 offset:4096
    v_mfma_f32_16x16x32_bf16 v[72:75], v[132:135], v[168:171], v[72:75]
    ds_read_b64_tr_b16 v[154:155], v3 offset:6144
    s_mul_i32 s54, s54, 896
    v_mfma_f32_16x16x32_bf16 v[88:91], v[136:139], v[168:171], v[88:91]
    ds_read_b64_tr_b16 v[156:157], v4 offset:4096
    s_lshr_b32 s55, s52, 2
    v_mfma_f32_16x16x32_bf16 v[104:107], v[140:143], v[168:171], v[104:107]
    ds_read_b64_tr_b16 v[158:159], v4 offset:6144
    s_andn2_b32 s55, s53, s55
    v_mfma_f32_16x16x32_bf16 v[108:111], v[140:143], v[172:175], v[108:111]
    buffer_load_dwordx4 v29, s[12:15], s36 offen offset:3072  lds
    s_lshl_b32 s55, s55, 2
    v_mfma_f32_16x16x32_bf16 v[92:95], v[136:139], v[172:175], v[92:95]
    s_add_u32 s55, s55, 0
    s_lshl_b32 s55, s55, 5
    v_mfma_f32_16x16x32_bf16 v[76:79], v[132:135], v[172:175], v[76:79]
    s_add_u32 s54, s54, s55
    s_mov_b32 s56, 14336
    v_mfma_f32_16x16x32_bf16 v[60:63], v[128:131], v[172:175], v[60:63]
    s_cmp_eq_u32 s52, 4
    s_cselect_b32 s55, 128, s56
    s_waitcnt lgkmcnt(0)
    v_mfma_f32_16x16x32_bf16 v[48:51], v[144:147], v[180:183], v[48:51]
    s_xor_b32 s36, s0, 196608
    s_mov_b32 m0, s29
    ds_read_b128 v[160:163], v11 offset:0
    v_mfma_f32_16x16x32_bf16 v[64:67], v[148:151], v[180:183], v[64:67]
    buffer_load_dwordx4 v26, s[12:15], s36 offen offset:0  lds
    ds_read_b128 v[164:167], v11 offset:1024
    v_mfma_f32_16x16x32_bf16 v[80:83], v[152:155], v[180:183], v[80:83]
    ds_read_b128 v[168:171], v11 offset:2048
    s_lshr_b32 s56, s3, 1
    v_mfma_f32_16x16x32_bf16 v[96:99], v[156:159], v[180:183], v[96:99]
    ds_read_b128 v[172:175], v11 offset:3072
    s_mul_i32 s55, s55, s56
    v_mfma_f32_16x16x32_bf16 v[100:103], v[156:159], v[184:187], v[100:103]
    s_waitcnt vmcnt(9)
    buffer_load_dwordx4 v27, s[12:15], s36 offen offset:1024  lds
    ds_read_b64_tr_b16 v[128:129], v1 offset:8192
    v_mfma_f32_16x16x32_bf16 v[84:87], v[152:155], v[184:187], v[84:87]
    ds_read_b64_tr_b16 v[130:131], v1 offset:10240
    s_add_u32 s54, s54, s55
    v_mfma_f32_16x16x32_bf16 v[68:71], v[148:151], v[184:187], v[68:71]
    ds_read_b64_tr_b16 v[132:133], v2 offset:8192
    s_and_b32 s55, s3, 1
    v_mfma_f32_16x16x32_bf16 v[52:55], v[144:147], v[184:187], v[52:55]
    ds_read_b64_tr_b16 v[134:135], v2 offset:10240
    s_mul_i32 s55, s55, 7168
    v_mfma_f32_16x16x32_bf16 v[56:59], v[144:147], v[188:191], v[56:59]
    buffer_load_dwordx4 v28, s[12:15], s36 offen offset:2048  lds
    ds_read_b64_tr_b16 v[136:137], v3 offset:8192
    v_mfma_f32_16x16x32_bf16 v[72:75], v[148:151], v[188:191], v[72:75]
    ds_read_b64_tr_b16 v[138:139], v3 offset:10240
    s_add_u32 s54, s54, s55
    v_mfma_f32_16x16x32_bf16 v[88:91], v[152:155], v[188:191], v[88:91]
    ds_read_b64_tr_b16 v[140:141], v4 offset:8192
    s_not_b32 s43, s43
    v_mfma_f32_16x16x32_bf16 v[104:107], v[156:159], v[188:191], v[104:107]
    ds_read_b64_tr_b16 v[142:143], v4 offset:10240
    s_mul_i32 s43, s43, s56
    v_mfma_f32_16x16x32_bf16 v[108:111], v[156:159], v[192:195], v[108:111]
    buffer_load_dwordx4 v29, s[12:15], s36 offen offset:3072  lds
    v_lshrrev_b32 v42, 3, v0
    v_mfma_f32_16x16x32_bf16 v[92:95], v[152:155], v[192:195], v[92:95]
    v_and_b32 v43, 7, v0
    v_lshlrev_b32 v43, 4, v43
    v_mfma_f32_16x16x32_bf16 v[76:79], v[148:151], v[192:195], v[76:79]
    v_mul_u32_u24 v251, 896, v42
    v_add3_u32 v251, v251, v43, s54
    v_mfma_f32_16x16x32_bf16 v[60:63], v[144:147], v[192:195], v[60:63]
    s_mul_i32 s54, s3, 1152
    s_add_u32 s54, s54, 32768
    s_waitcnt lgkmcnt(0)
    v_mfma_f32_16x16x32_bf16 v[48:51], v[128:131], v[160:163], v[48:51]
    ds_read_b128 v[180:183], v11 offset:4096
    v_mul_u32_u24 v42, 144, v42
    v_mfma_f32_16x16x32_bf16 v[64:67], v[132:135], v[160:163], v[64:67]
    v_add_u32 v40, 16, v0
    v_bfe_u32 v41, v40, 1, 1
    v_lshlrev_b32 v41, 7, v41
    v_and_or_b32 v41, v40, 1, v41
    v_mul_u32_u24 v41, 896, v41
    v_lshrrev_b32 v40, 2, v40
    v_lshl_add_u32 v40, v40, 7, v41
    s_mul_i32 s35, s73, 1792
    s_mov_b64 exec, 0xfff
    buffer_load_dword v39, v40, s[20:23], s35 offen
    s_mov_b64 exec, -1
    v_mfma_f32_16x16x32_bf16 v[80:83], v[136:139], v[160:163], v[80:83]
    ds_read_b128 v[184:187], v11 offset:5120
    v_add3_u32 v252, v42, v43, s54
    v_mfma_f32_16x16x32_bf16 v[96:99], v[140:143], v[160:163], v[96:99]
    s_xor_b32 s36, s0, 16384
    s_mov_b32 m0, s30
    ds_read_b128 v[188:191], v11 offset:6144
    v_mfma_f32_16x16x32_bf16 v[100:103], v[140:143], v[164:167], v[100:103]
    buffer_load_dwordx4 v26, s[12:15], s36 offen offset:0  lds
    ds_read_b128 v[192:195], v11 offset:7168
    v_mfma_f32_16x16x32_bf16 v[84:87], v[136:139], v[164:167], v[84:87]
    s_waitcnt vmcnt(10)
    ds_read_b64_tr_b16 v[144:145], v1 offset:12288
    v_and_b32 v42, 31, v0
    v_mfma_f32_16x16x32_bf16 v[68:71], v[132:135], v[164:167], v[68:71]
    ds_read_b64_tr_b16 v[146:147], v1 offset:14336
    v_mul_u32_u24 v42, 144, v42
    v_mfma_f32_16x16x32_bf16 v[52:55], v[128:131], v[164:167], v[52:55]
    buffer_load_dwordx4 v27, s[12:15], s36 offen offset:1024  lds
    ds_read_b64_tr_b16 v[148:149], v2 offset:12288
    v_mfma_f32_16x16x32_bf16 v[56:59], v[128:131], v[168:171], v[56:59]
    ds_read_b64_tr_b16 v[150:151], v2 offset:14336
    v_lshrrev_b32 v43, 5, v0
    v_mfma_f32_16x16x32_bf16 v[72:75], v[132:135], v[168:171], v[72:75]
    ds_read_b64_tr_b16 v[152:153], v3 offset:12288
    v_lshl_add_u32 v42, v43, 4, v42
    v_mfma_f32_16x16x32_bf16 v[88:91], v[136:139], v[168:171], v[88:91]
    buffer_load_dwordx4 v28, s[12:15], s36 offen offset:2048  lds
    ds_read_b64_tr_b16 v[154:155], v3 offset:14336
    v_mfma_f32_16x16x32_bf16 v[104:107], v[140:143], v[168:171], v[104:107]
    ds_read_b64_tr_b16 v[156:157], v4 offset:12288
    s_lshl_b32 s54, s3, 5
    v_mfma_f32_16x16x32_bf16 v[108:111], v[140:143], v[172:175], v[108:111]
    ds_read_b64_tr_b16 v[158:159], v4 offset:14336
    s_add_u32 s54, s54, 32768
    v_mfma_f32_16x16x32_bf16 v[92:95], v[136:139], v[172:175], v[92:95]
    buffer_load_dwordx4 v29, s[12:15], s36 offen offset:3072  lds
    v_add_u32 v12, s54, v42
    v_mfma_f32_16x16x32_bf16 v[76:79], v[132:135], v[172:175], v[76:79]
    v_lshlrev_b32 v254, 2, v0
    v_lshlrev_b32 v37, 13, v0
    v_mfma_f32_16x16x32_bf16 v[60:63], v[128:131], v[172:175], v[60:63]
    s_cmp_lg_u32 s33, 0
    s_cbranch_scc1 L_nowarm_4
    s_mov_b64 exec, 1
    buffer_atomic_or v253, v37, s[4:7], s40 offen offset:384 sc1
    buffer_atomic_or v253, v37, s[4:7], s40 offen offset:768 sc1
    s_mov_b64 exec, -1
L_nowarm_4:
    s_waitcnt lgkmcnt(0)
    v_mfma_f32_16x16x32_bf16 v[48:51], v[144:147], v[180:183], v[48:51]
    s_xor_b32 s36, s0, 81920
    s_mov_b32 m0, s31
    ds_read_b128 v[160:163], v11 offset:8192
    v_mfma_f32_16x16x32_bf16 v[64:67], v[148:151], v[180:183], v[64:67]
    buffer_load_dwordx4 v26, s[12:15], s36 offen offset:0  lds
    ds_read_b128 v[164:167], v11 offset:9216
    v_mfma_f32_16x16x32_bf16 v[80:83], v[152:155], v[180:183], v[80:83]
    ds_read_b128 v[168:171], v11 offset:10240
    ds_read_b128 v[172:175], v11 offset:11264
    v_mfma_f32_16x16x32_bf16 v[96:99], v[156:159], v[180:183], v[96:99]
    v_mfma_f32_16x16x32_bf16 v[100:103], v[156:159], v[184:187], v[100:103]
    s_waitcnt vmcnt(10)
    buffer_load_dwordx4 v27, s[12:15], s36 offen offset:1024  lds
    ds_read_b64_tr_b16 v[128:129], v1 offset:0
    v_mfma_f32_16x16x32_bf16 v[84:87], v[152:155], v[184:187], v[84:87]
    ds_read_b64_tr_b16 v[130:131], v1 offset:2048
    ds_read_b64_tr_b16 v[132:133], v2 offset:0
    v_mfma_f32_16x16x32_bf16 v[68:71], v[148:151], v[184:187], v[68:71]
    ds_read_b64_tr_b16 v[134:135], v2 offset:2048
    ds_read_b64_tr_b16 v[136:137], v3 offset:0
    v_mfma_f32_16x16x32_bf16 v[52:55], v[144:147], v[184:187], v[52:55]
    ds_read_b64_tr_b16 v[138:139], v3 offset:2048
    ds_read_b64_tr_b16 v[140:141], v4 offset:0
    v_mfma_f32_16x16x32_bf16 v[56:59], v[144:147], v[188:191], v[56:59]
    buffer_load_dwordx4 v28, s[12:15], s36 offen offset:2048  lds
    ds_read_b64_tr_b16 v[142:143], v4 offset:2048
    v_mfma_f32_16x16x32_bf16 v[72:75], v[148:151], v[188:191], v[72:75]
    v_mfma_f32_16x16x32_bf16 v[88:91], v[152:155], v[188:191], v[88:91]
    v_mfma_f32_16x16x32_bf16 v[104:107], v[156:159], v[188:191], v[104:107]
    v_mfma_f32_16x16x32_bf16 v[108:111], v[156:159], v[192:195], v[108:111]
    buffer_load_dwordx4 v29, s[12:15], s36 offen offset:3072  lds
    v_mfma_f32_16x16x32_bf16 v[92:95], v[152:155], v[192:195], v[92:95]
    v_mfma_f32_16x16x32_bf16 v[76:79], v[148:151], v[192:195], v[76:79]
    v_mfma_f32_16x16x32_bf16 v[60:63], v[144:147], v[192:195], v[60:63]
    s_waitcnt lgkmcnt(0)
    v_mfma_f32_16x16x32_bf16 v[48:51], v[128:131], v[160:163], v[48:51]
    s_mov_b32 s36, 0
    s_mov_b32 m0, s28
    ds_read_b128 v[180:183], v11 offset:12288
    v_mfma_f32_16x16x32_bf16 v[64:67], v[132:135], v[160:163], v[64:67]
    buffer_load_dwordx4 v30, s[20:23], s36 offen offset:0  lds
    ds_read_b128 v[184:187], v11 offset:13312
    v_mfma_f32_16x16x32_bf16 v[80:83], v[136:139], v[160:163], v[80:83]
    ds_read_b128 v[188:191], v11 offset:14336
    ds_read_b128 v[192:195], v11 offset:15360
    v_mfma_f32_16x16x32_bf16 v[96:99], v[140:143], v[160:163], v[96:99]
    v_mfma_f32_16x16x32_bf16 v[100:103], v[140:143], v[164:167], v[100:103]
    s_waitcnt vmcnt(10)
    buffer_load_dwordx4 v31, s[20:23], s36 offen offset:1024  lds
    ds_read_b64_tr_b16 v[144:145], v1 offset:4096
    v_mfma_f32_16x16x32_bf16 v[84:87], v[136:139], v[164:167], v[84:87]
    ds_read_b64_tr_b16 v[146:147], v1 offset:6144
    ds_read_b64_tr_b16 v[148:149], v2 offset:4096
    v_mfma_f32_16x16x32_bf16 v[68:71], v[132:135], v[164:167], v[68:71]
    ds_read_b64_tr_b16 v[150:151], v2 offset:6144
    ds_read_b64_tr_b16 v[152:153], v3 offset:4096
    v_mfma_f32_16x16x32_bf16 v[52:55], v[128:131], v[164:167], v[52:55]
    ds_read_b64_tr_b16 v[154:155], v3 offset:6144
    ds_read_b64_tr_b16 v[156:157], v4 offset:4096
    v_mfma_f32_16x16x32_bf16 v[56:59], v[128:131], v[168:171], v[56:59]
    buffer_load_dwordx4 v32, s[20:23], s36 offen offset:2048  lds
    ds_read_b64_tr_b16 v[158:159], v4 offset:6144
    v_mfma_f32_16x16x32_bf16 v[72:75], v[132:135], v[168:171], v[72:75]
    v_mfma_f32_16x16x32_bf16 v[88:91], v[136:139], v[168:171], v[88:91]
    v_mfma_f32_16x16x32_bf16 v[104:107], v[140:143], v[168:171], v[104:107]
    v_mfma_f32_16x16x32_bf16 v[108:111], v[140:143], v[172:175], v[108:111]
    buffer_load_dwordx4 v33, s[20:23], s36 offen offset:3072  lds
    v_mfma_f32_16x16x32_bf16 v[92:95], v[136:139], v[172:175], v[92:95]
    v_mfma_f32_16x16x32_bf16 v[76:79], v[132:135], v[172:175], v[76:79]
    v_mfma_f32_16x16x32_bf16 v[60:63], v[128:131], v[172:175], v[60:63]
    s_waitcnt lgkmcnt(0)
    v_mfma_f32_16x16x32_bf16 v[48:51], v[144:147], v[180:183], v[48:51]
    s_mov_b32 s36, 114688
    s_mov_b32 m0, s29
    ds_read_b128 v[160:163], v11 offset:16384
    v_mfma_f32_16x16x32_bf16 v[64:67], v[148:151], v[180:183], v[64:67]
    buffer_load_dwordx4 v30, s[20:23], s36 offen offset:0  lds
    ds_read_b128 v[164:167], v11 offset:17408
    v_mfma_f32_16x16x32_bf16 v[80:83], v[152:155], v[180:183], v[80:83]
    ds_read_b128 v[168:171], v11 offset:18432
    ds_read_b128 v[172:175], v11 offset:19456
    v_mfma_f32_16x16x32_bf16 v[96:99], v[156:159], v[180:183], v[96:99]
    v_mfma_f32_16x16x32_bf16 v[100:103], v[156:159], v[184:187], v[100:103]
    s_waitcnt vmcnt(9)
    buffer_load_dwordx4 v31, s[20:23], s36 offen offset:1024  lds
    ds_read_b64_tr_b16 v[128:129], v1 offset:8192
    v_mfma_f32_16x16x32_bf16 v[84:87], v[152:155], v[184:187], v[84:87]
    ds_read_b64_tr_b16 v[130:131], v1 offset:10240
    ds_read_b64_tr_b16 v[132:133], v2 offset:8192
    v_mfma_f32_16x16x32_bf16 v[68:71], v[148:151], v[184:187], v[68:71]
    ds_read_b64_tr_b16 v[134:135], v2 offset:10240
    ds_read_b64_tr_b16 v[136:137], v3 offset:8192
    v_mfma_f32_16x16x32_bf16 v[52:55], v[144:147], v[184:187], v[52:55]
    ds_read_b64_tr_b16 v[138:139], v3 offset:10240
    ds_read_b64_tr_b16 v[140:141], v4 offset:8192
    v_mfma_f32_16x16x32_bf16 v[56:59], v[144:147], v[188:191], v[56:59]
    buffer_load_dwordx4 v32, s[20:23], s36 offen offset:2048  lds
    ds_read_b64_tr_b16 v[142:143], v4 offset:10240
    v_mfma_f32_16x16x32_bf16 v[72:75], v[148:151], v[188:191], v[72:75]
    v_mfma_f32_16x16x32_bf16 v[88:91], v[152:155], v[188:191], v[88:91]
    v_mfma_f32_16x16x32_bf16 v[104:107], v[156:159], v[188:191], v[104:107]
    v_mfma_f32_16x16x32_bf16 v[108:111], v[156:159], v[192:195], v[108:111]
    buffer_load_dwordx4 v33, s[20:23], s36 offen offset:3072  lds
    v_mfma_f32_16x16x32_bf16 v[92:95], v[152:155], v[192:195], v[92:95]
    v_mfma_f32_16x16x32_bf16 v[76:79], v[148:151], v[192:195], v[76:79]
    v_mfma_f32_16x16x32_bf16 v[60:63], v[144:147], v[192:195], v[60:63]
    s_waitcnt lgkmcnt(0)
    v_mfma_f32_16x16x32_bf16 v[48:51], v[128:131], v[160:163], v[48:51]
    s_barrier
    s_mov_b32 s36, 128
    s_mov_b32 m0, s30
    v_mfma_f32_16x16x32_bf16 v[64:67], v[132:135], v[160:163], v[64:67]
    buffer_load_dwordx4 v30, s[20:23], s36 offen offset:0  lds
    ds_read_b128 v[180:183], v11 offset:20480
    v_mfma_f32_16x16x32_bf16 v[80:83], v[136:139], v[160:163], v[80:83]
    ds_read_b128 v[184:187], v11 offset:21504
    ds_read_b128 v[188:191], v11 offset:22528
    v_mfma_f32_16x16x32_bf16 v[96:99], v[140:143], v[160:163], v[96:99]
    ds_read_b128 v[192:195], v11 offset:23552
    v_mfma_f32_16x16x32_bf16 v[100:103], v[140:143], v[164:167], v[100:103]
    s_waitcnt vmcnt(9)
    buffer_load_dwordx4 v31, s[20:23], s36 offen offset:1024  lds
    ds_read_b64_tr_b16 v[144:145], v1 offset:12288
    v_mfma_f32_16x16x32_bf16 v[84:87], v[136:139], v[164:167], v[84:87]
    ds_read_b64_tr_b16 v[146:147], v1 offset:14336
    ds_read_b64_tr_b16 v[148:149], v2 offset:12288
    v_mfma_f32_16x16x32_bf16 v[68:71], v[132:135], v[164:167], v[68:71]
    ds_read_b64_tr_b16 v[150:151], v2 offset:14336
    ds_read_b64_tr_b16 v[152:153], v3 offset:12288
    v_mfma_f32_16x16x32_bf16 v[52:55], v[128:131], v[164:167], v[52:55]
    ds_read_b64_tr_b16 v[154:155], v3 offset:14336
    ds_read_b64_tr_b16 v[156:157], v4 offset:12288
    v_mfma_f32_16x16x32_bf16 v[56:59], v[128:131], v[168:171], v[56:59]
    buffer_load_dwordx4 v32, s[20:23], s36 offen offset:2048  lds
    ds_read_b64_tr_b16 v[158:159], v4 offset:14336
    v_mfma_f32_16x16x32_bf16 v[72:75], v[132:135], v[168:171], v[72:75]
    v_mfma_f32_16x16x32_bf16 v[88:91], v[136:139], v[168:171], v[88:91]
    v_mfma_f32_16x16x32_bf16 v[104:107], v[140:143], v[168:171], v[104:107]
    v_mfma_f32_16x16x32_bf16 v[108:111], v[140:143], v[172:175], v[108:111]
    buffer_load_dwordx4 v33, s[20:23], s36 offen offset:3072  lds
    v_mfma_f32_16x16x32_bf16 v[92:95], v[136:139], v[172:175], v[92:95]
    v_mfma_f32_16x16x32_bf16 v[76:79], v[132:135], v[172:175], v[76:79]
    v_mfma_f32_16x16x32_bf16 v[60:63], v[128:131], v[172:175], v[60:63]
    s_waitcnt lgkmcnt(0)
    v_mfma_f32_16x16x32_bf16 v[48:51], v[144:147], v[180:183], v[48:51]
    s_mov_b32 s36, 114816
    s_mov_b32 m0, s31
    ds_read_b128 v[160:163], v11 offset:24576
    v_mfma_f32_16x16x32_bf16 v[64:67], v[148:151], v[180:183], v[64:67]
    buffer_load_dwordx4 v30, s[20:23], s36 offen offset:0  lds
    ds_read_b128 v[164:167], v11 offset:25600
    v_mfma_f32_16x16x32_bf16 v[80:83], v[152:155], v[180:183], v[80:83]
    buffer_load_dwordx4 v31, s[20:23], s36 offen offset:1024  lds
    ds_read_b128 v[168:171], v11 offset:26624
    v_mfma_f32_16x16x32_bf16 v[96:99], v[156:159], v[180:183], v[96:99]
    buffer_load_dwordx4 v32, s[20:23], s36 offen offset:2048  lds
    ds_read_b128 v[172:175], v11 offset:27648
    v_mfma_f32_16x16x32_bf16 v[100:103], v[156:159], v[184:187], v[100:103]
    s_waitcnt vmcnt(11)
    s_barrier
    buffer_load_dwordx4 v33, s[20:23], s36 offen offset:3072  lds
    v_mfma_f32_16x16x32_bf16 v[84:87], v[152:155], v[184:187], v[84:87]
    ds_read_b64_tr_b16 a[160:161], v5 offset:0
    ds_read_b64_tr_b16 a[162:163], v5 offset:2048
    v_mfma_f32_16x16x32_bf16 v[68:71], v[148:151], v[184:187], v[68:71]
    ds_read_b64_tr_b16 a[164:165], v5 offset:16384
    ds_read_b64_tr_b16 a[166:167], v5 offset:18432
    v_mfma_f32_16x16x32_bf16 v[52:55], v[144:147], v[184:187], v[52:55]
    ds_read_b64_tr_b16 a[168:169], v5 offset:32768
    ds_read_b64_tr_b16 a[170:171], v5 offset:34816
    v_mfma_f32_16x16x32_bf16 v[56:59], v[144:147], v[188:191], v[56:59]
    ds_read_b64_tr_b16 a[172:173], v5 offset:49152
    ds_read_b64_tr_b16 a[174:175], v5 offset:51200
    v_mfma_f32_16x16x32_bf16 v[72:75], v[148:151], v[188:191], v[72:75]
    s_waitcnt vmcnt(8) lgkmcnt(0)
    s_barrier
    ds_read_b64_tr_b16 a[176:177], v5 offset:4096
    v_mfma_f32_16x16x32_bf16 v[88:91], v[152:155], v[188:191], v[88:91]
    ds_read_b64_tr_b16 a[178:179], v5 offset:6144
    ds_read_b64_tr_b16 a[180:181], v5 offset:20480
    v_mfma_f32_16x16x32_bf16 v[104:107], v[156:159], v[188:191], v[104:107]
    ds_read_b64_tr_b16 a[182:183], v5 offset:22528
    ds_read_b64_tr_b16 a[184:185], v5 offset:36864
    v_mfma_f32_16x16x32_bf16 v[108:111], v[156:159], v[192:195], v[108:111]
    ds_read_b64_tr_b16 a[186:187], v5 offset:38912
    ds_read_b64_tr_b16 a[188:189], v5 offset:53248
    v_mfma_f32_16x16x32_bf16 v[92:95], v[152:155], v[192:195], v[92:95]
    ds_read_b64_tr_b16 a[190:191], v5 offset:55296
    s_mov_b32 s36, 256
    v_mfma_f32_16x16x32_bf16 v[76:79], v[148:151], v[192:195], v[76:79]
    s_mov_b32 m0, s28
    s_nop 0
    buffer_load_dwordx4 v30, s[20:23], s36 offen offset:0  lds
    buffer_load_dwordx4 v31, s[20:23], s36 offen offset:1024  lds
    v_mfma_f32_16x16x32_bf16 v[60:63], v[144:147], v[192:195], v[60:63]
    buffer_load_dwordx4 v32, s[20:23], s36 offen offset:2048  lds
    buffer_load_dwordx4 v33, s[20:23], s36 offen offset:3072  lds
    s_waitcnt vmcnt(8) lgkmcnt(0)
    s_barrier
    ds_read_b64_tr_b16 a[192:193], v5 offset:8192
    ds_read_b64_tr_b16 a[194:195], v5 offset:10240
    ds_read_b64_tr_b16 a[196:197], v5 offset:24576
    ds_read_b64_tr_b16 a[198:199], v5 offset:26624
    ds_read_b64_tr_b16 a[200:201], v5 offset:40960
    ds_read_b64_tr_b16 a[202:203], v5 offset:43008
    ds_read_b64_tr_b16 a[204:205], v5 offset:57344
    ds_read_b64_tr_b16 a[206:207], v5 offset:59392
    s_xor_b32 s36, s0, 147456
    s_mov_b32 m0, s29
    s_nop 0
    buffer_load_dwordx4 v26, s[12:15], s36 offen offset:0  lds
    buffer_load_dwordx4 v27, s[12:15], s36 offen offset:1024  lds
    buffer_load_dwordx4 v28, s[12:15], s36 offen offset:2048  lds
    buffer_load_dwordx4 v29, s[12:15], s36 offen offset:3072  lds
    s_waitcnt vmcnt(8) lgkmcnt(0)
    s_barrier
    ds_read_b64_tr_b16 a[208:209], v5 offset:12288
    ds_read_b64_tr_b16 a[210:211], v5 offset:14336
    ds_read_b64_tr_b16 a[212:213], v5 offset:28672
    ds_read_b64_tr_b16 a[214:215], v5 offset:30720
    ds_read_b64_tr_b16 a[216:217], v5 offset:45056
    ds_read_b64_tr_b16 a[218:219], v5 offset:47104
    ds_read_b64_tr_b16 a[220:221], v5 offset:61440
    ds_read_b64_tr_b16 a[222:223], v5 offset:63488
    s_xor_b32 s36, s0, 212992
    s_mov_b32 m0, s30
    s_nop 0
    buffer_load_dwordx4 v26, s[12:15], s36 offen offset:0  lds
    buffer_load_dwordx4 v27, s[12:15], s36 offen offset:1024  lds
    buffer_load_dwordx4 v28, s[12:15], s36 offen offset:2048  lds
    buffer_load_dwordx4 v29, s[12:15], s36 offen offset:3072  lds
    s_waitcnt vmcnt(8) lgkmcnt(0)
    s_barrier
    ds_read_b64_tr_b16 a[224:225], v5 offset:0
    ds_read_b64_tr_b16 a[226:227], v5 offset:2048
    ds_read_b64_tr_b16 a[228:229], v5 offset:16384
    ds_read_b64_tr_b16 a[230:231], v5 offset:18432
    ds_read_b64_tr_b16 a[232:233], v5 offset:32768
    ds_read_b64_tr_b16 a[234:235], v5 offset:34816
    ds_read_b64_tr_b16 a[236:237], v5 offset:49152
    ds_read_b64_tr_b16 a[238:239], v5 offset:51200
    s_waitcnt vmcnt(4) lgkmcnt(0)
    s_barrier
    ds_read_b64_tr_b16 v[128:129], v1 offset:4096
    ds_read_b64_tr_b16 v[130:131], v1 offset:6144
    ds_read_b64_tr_b16 v[132:133], v2 offset:4096
    ds_read_b64_tr_b16 v[134:135], v2 offset:6144
    ds_read_b64_tr_b16 v[136:137], v3 offset:4096
    ds_read_b64_tr_b16 v[138:139], v3 offset:6144
    ds_read_b64_tr_b16 v[140:141], v4 offset:4096
    ds_read_b64_tr_b16 v[142:143], v4 offset:6144
    s_waitcnt lgkmcnt(0)
    v_mfma_f32_16x16x32_bf16 v[48:51], v[128:131], v[160:163], v[48:51]
    s_mov_b32 s36, 114944
    s_mov_b32 m0, s31
    ds_read_b128 v[180:183], v11 offset:28672
    v_mfma_f32_16x16x32_bf16 v[64:67], v[132:135], v[160:163], v[64:67]
    buffer_load_dwordx4 v30, s[20:23], s36 offen offset:0  lds
    ds_read_b128 v[184:187], v11 offset:29696
    v_mfma_f32_16x16x32_bf16 v[80:83], v[136:139], v[160:163], v[80:83]
    ds_read_b128 v[188:191], v11 offset:30720
    ds_read_b128 v[192:195], v11 offset:31744
    v_mfma_f32_16x16x32_bf16 v[96:99], v[140:143], v[160:163], v[96:99]
    v_mfma_f32_16x16x32_bf16 v[100:103], v[140:143], v[164:167], v[100:103]
    buffer_load_dwordx4 v31, s[20:23], s36 offen offset:1024  lds
    v_mfma_f32_16x16x32_bf16 v[84:87], v[136:139], v[164:167], v[84:87]
    v_mfma_f32_16x16x32_bf16 v[68:71], v[132:135], v[164:167], v[68:71]
    v_mfma_f32_16x16x32_bf16 v[52:55], v[128:131], v[164:167], v[52:55]
    v_mfma_f32_16x16x32_bf16 v[56:59], v[128:131], v[168:171], v[56:59]
    buffer_load_dwordx4 v32, s[20:23], s36 offen offset:2048  lds
    v_mfma_f32_16x16x32_bf16 v[72:75], v[132:135], v[168:171], v[72:75]
    v_mfma_f32_16x16x32_bf16 v[88:91], v[136:139], v[168:171], v[88:91]
    v_mfma_f32_16x16x32_bf16 v[104:107], v[140:143], v[168:171], v[104:107]
    v_mfma_f32_16x16x32_bf16 v[108:111], v[140:143], v[172:175], v[108:111]
    buffer_load_dwordx4 v33, s[20:23], s36 offen offset:3072  lds
    v_mfma_f32_16x16x32_bf16 v[92:95], v[136:139], v[172:175], v[92:95]
    v_mfma_f32_16x16x32_bf16 v[76:79], v[132:135], v[172:175], v[76:79]
    v_mfma_f32_16x16x32_bf16 v[60:63], v[128:131], v[172:175], v[60:63]
    s_waitcnt vmcnt(4)
    ds_read_b64_tr_b16 v[144:145], v1 offset:8192
    ds_read_b64_tr_b16 v[146:147], v1 offset:10240
    ds_read_b64_tr_b16 v[148:149], v2 offset:8192
    ds_read_b64_tr_b16 v[150:151], v2 offset:10240
    ds_read_b64_tr_b16 v[152:153], v3 offset:8192
    ds_read_b64_tr_b16 v[154:155], v3 offset:10240
    ds_read_b64_tr_b16 v[156:157], v4 offset:8192
    ds_read_b64_tr_b16 v[158:159], v4 offset:10240
    s_waitcnt lgkmcnt(0)
    v_mfma_f32_16x16x32_bf16 v[48:51], v[144:147], v[180:183], v[48:51]
    s_mov_b32 s36, 384
    s_mov_b32 m0, s28
    v_mfma_f32_16x16x32_bf16 v[64:67], v[148:151], v[180:183], v[64:67]
    buffer_load_dwordx4 v30, s[20:23], s36 offen offset:0  lds
    v_mfma_f32_16x16x32_bf16 v[80:83], v[152:155], v[180:183], v[80:83]
    v_mfma_f32_16x16x32_bf16 v[96:99], v[156:159], v[180:183], v[96:99]
    v_mfma_f32_16x16x32_bf16 v[52:55], v[144:147], v[184:187], v[52:55]
    buffer_load_dwordx4 v31, s[20:23], s36 offen offset:1024  lds
    v_cvt_pk_bf16_f32 v48, v48, v49
    v_mfma_f32_16x16x32_bf16 v[68:71], v[148:151], v[184:187], v[68:71]
    v_cvt_pk_bf16_f32 v49, v50, v51
    v_cvt_pk_bf16_f32 v50, v64, v65
    v_mfma_f32_16x16x32_bf16 v[84:87], v[152:155], v[184:187], v[84:87]
    v_cvt_pk_bf16_f32 v51, v66, v67
    ds_write_b128 v17, v[48:51] offset:0
    v_mfma_f32_16x16x32_bf16 v[100:103], v[156:159], v[184:187], v[100:103]
    v_cvt_pk_bf16_f32 v80, v80, v81
    v_cvt_pk_bf16_f32 v81, v82, v83
    v_mfma_f32_16x16x32_bf16 v[56:59], v[144:147], v[188:191], v[56:59]
    buffer_load_dwordx4 v32, s[20:23], s36 offen offset:2048  lds
    v_cvt_pk_bf16_f32 v82, v96, v97
    v_mfma_f32_16x16x32_bf16 v[72:75], v[148:151], v[188:191], v[72:75]
    v_cvt_pk_bf16_f32 v83, v98, v99
    ds_write_b128 v17, v[80:83] offset:4096
    v_mfma_f32_16x16x32_bf16 v[88:91], v[152:155], v[188:191], v[88:91]
    v_cvt_pk_bf16_f32 v52, v52, v53
    v_cvt_pk_bf16_f32 v53, v54, v55
    v_mfma_f32_16x16x32_bf16 v[104:107], v[156:159], v[188:191], v[104:107]
    v_cvt_pk_bf16_f32 v54, v68, v69
    v_cvt_pk_bf16_f32 v55, v70, v71
    v_mfma_f32_16x16x32_bf16 v[60:63], v[144:147], v[192:195], v[60:63]
    buffer_load_dwordx4 v33, s[20:23], s36 offen offset:3072  lds
    ds_write_b128 v17, v[52:55] offset:1024
    v_mfma_f32_16x16x32_bf16 v[76:79], v[148:151], v[192:195], v[76:79]
    v_cvt_pk_bf16_f32 v84, v84, v85
    v_cvt_pk_bf16_f32 v85, v86, v87
    v_mfma_f32_16x16x32_bf16 v[92:95], v[152:155], v[192:195], v[92:95]
    v_cvt_pk_bf16_f32 v86, v100, v101
    v_cvt_pk_bf16_f32 v87, v102, v103
    v_mfma_f32_16x16x32_bf16 v[108:111], v[156:159], v[192:195], v[108:111]
    ds_write_b128 v17, v[84:87] offset:5120
    v_cvt_pk_bf16_f32 v56, v56, v57
    v_cvt_pk_bf16_f32 v57, v58, v59
    v_cvt_pk_bf16_f32 v58, v72, v73
    v_cvt_pk_bf16_f32 v59, v74, v75
    ds_write_b128 v17, v[56:59] offset:2048
    v_cvt_pk_bf16_f32 v88, v88, v89
    v_cvt_pk_bf16_f32 v89, v90, v91
    v_cvt_pk_bf16_f32 v90, v104, v105
    v_cvt_pk_bf16_f32 v91, v106, v107
    ds_write_b128 v17, v[88:91] offset:6144
    v_cvt_pk_bf16_f32 v60, v60, v61
    v_cvt_pk_bf16_f32 v61, v62, v63
    v_cvt_pk_bf16_f32 v62, v76, v77
    v_cvt_pk_bf16_f32 v63, v78, v79
    ds_write_b128 v17, v[60:63] offset:3072
    v_cvt_pk_bf16_f32 v92, v92, v93
    v_cvt_pk_bf16_f32 v93, v94, v95
    v_cvt_pk_bf16_f32 v94, v108, v109
    v_cvt_pk_bf16_f32 v95, v110, v111
    ds_write_b128 v17, v[92:95] offset:7168
    s_mov_b32 s36, 115072
    s_mov_b32 m0, s29
    s_nop 0
    buffer_load_dwordx4 v30, s[20:23], s36 offen offset:0  lds
    buffer_load_dwordx4 v31, s[20:23], s36 offen offset:1024  lds
    buffer_load_dwordx4 v32, s[20:23], s36 offen offset:2048  lds
    buffer_load_dwordx4 v33, s[20:23], s36 offen offset:3072  lds
    s_lshl_b32 s37, s3, 12
    v_subrev_u32 v1, 40960, v255
    s_waitcnt lgkmcnt(0)
    s_barrier
    ds_read_b128 a[0:3], v10 offset:0
    ds_read_b128 a[16:19], v10 offset:4096
    ds_read_b128 a[32:35], v10 offset:8192
    ds_read_b128 a[48:51], v10 offset:12288
    ds_read_b128 a[4:7], v10 offset:1024
    ds_read_b128 a[20:23], v10 offset:5120
    ds_read_b128 a[36:39], v10 offset:9216
    ds_read_b128 a[52:55], v10 offset:13312
    ds_read_b128 a[8:11], v10 offset:2048
    ds_read_b128 a[24:27], v10 offset:6144
    s_waitcnt lgkmcnt(9)
    v_mfma_f32_16x16x32_bf16 v[48:51], a[160:163], a[0:3], 0
    ds_read_b128 a[40:43], v10 offset:10240
    ds_read_b128 a[56:59], v10 offset:14336
    s_waitcnt lgkmcnt(10)
    v_mfma_f32_16x16x32_bf16 v[48:51], a[164:167], a[16:19], v[48:51]
    s_mov_b32 s36, 512
    s_mov_b32 m0, s30
    ds_read_b128 a[12:15], v10 offset:3072
    s_waitcnt lgkmcnt(10)
    v_mfma_f32_16x16x32_bf16 v[48:51], a[168:171], a[32:35], v[48:51]
    ds_read_b128 a[28:31], v10 offset:7168
    buffer_load_dwordx4 v30, s[20:23], s36 offen offset:0  lds
    s_waitcnt lgkmcnt(10)
    v_mfma_f32_16x16x32_bf16 v[48:51], a[172:175], a[48:51], v[48:51]
    ds_read_b128 a[44:47], v10 offset:11264
    ds_read_b128 a[60:63], v10 offset:15360
    s_waitcnt lgkmcnt(11)
    v_mfma_f32_16x16x32_bf16 v[52:55], a[160:163], a[4:7], 0
    ds_read_b128 a[64:67], v10 offset:16384
    ds_read_b128 a[80:83], v10 offset:20480
    s_waitcnt lgkmcnt(12)
    v_mfma_f32_16x16x32_bf16 v[52:55], a[164:167], a[20:23], v[52:55]
    ds_read_b128 a[96:99], v10 offset:24576
    buffer_load_dwordx4 v31, s[20:23], s36 offen offset:1024  lds
    s_waitcnt lgkmcnt(12)
    v_mfma_f32_16x16x32_bf16 v[52:55], a[168:171], a[36:39], v[52:55]
    ds_read_b128 a[112:115], v10 offset:28672
    ds_read_b128 a[68:71], v10 offset:17408
    s_waitcnt lgkmcnt(13)
    v_mfma_f32_16x16x32_bf16 v[52:55], a[172:175], a[52:55], v[52:55]
    ds_read_b128 a[84:87], v10 offset:21504
    ds_read_b128 a[100:103], v10 offset:25600
    s_waitcnt lgkmcnt(14)
    v_mfma_f32_16x16x32_bf16 v[56:59], a[160:163], a[8:11], 0
    ds_read_b128 a[116:119], v10 offset:29696
    ds_read_b128 a[72:75], v10 offset:18432
    s_waitcnt lgkmcnt(14)
    v_mfma_f32_16x16x32_bf16 v[56:59], a[164:167], a[24:27], v[56:59]
    ds_read_b128 a[88:91], v10 offset:22528
    buffer_load_dwordx4 v32, s[20:23], s36 offen offset:2048  lds
    v_mfma_f32_16x16x32_bf16 v[56:59], a[168:171], a[40:43], v[56:59]
    s_waitcnt lgkmcnt(14)
    v_mfma_f32_16x16x32_bf16 v[56:59], a[172:175], a[56:59], v[56:59]
    s_waitcnt lgkmcnt(13)
    v_mfma_f32_16x16x32_bf16 v[60:63], a[160:163], a[12:15], 0
    buffer_load_dwordx4 v33, s[20:23], s36 offen offset:3072  lds
    s_waitcnt lgkmcnt(12)
    v_mfma_f32_16x16x32_bf16 v[60:63], a[164:167], a[28:31], v[60:63]
    s_waitcnt lgkmcnt(11)
    v_mfma_f32_16x16x32_bf16 v[60:63], a[168:171], a[44:47], v[60:63]
    s_waitcnt lgkmcnt(10)
    v_mfma_f32_16x16x32_bf16 v[60:63], a[172:175], a[60:63], v[60:63]
    s_waitcnt lgkmcnt(9)
    v_mfma_f32_16x16x32_bf16 v[48:51], a[176:179], a[64:67], v[48:51]
    ds_read_b128 a[104:107], v10 offset:26624
    ds_read_b128 a[120:123], v10 offset:30720
    s_waitcnt lgkmcnt(10)
    v_mfma_f32_16x16x32_bf16 v[48:51], a[180:183], a[80:83], v[48:51]
    s_mov_b32 s36, 115200
    s_add_u32 m0, s37, 40960
    ds_read_b128 a[76:79], v10 offset:19456
    s_waitcnt lgkmcnt(10)
    v_mfma_f32_16x16x32_bf16 v[48:51], a[184:187], a[96:99], v[48:51]
    ds_read_b128 a[92:95], v10 offset:23552
    buffer_load_dwordx4 v30, s[20:23], s36 offen offset:0  lds
    s_waitcnt lgkmcnt(10)
    v_mfma_f32_16x16x32_bf16 v[48:51], a[188:191], a[112:115], v[48:51]
    ds_read_b128 a[108:111], v10 offset:27648
    ds_read_b128 a[124:127], v10 offset:31744
    s_waitcnt lgkmcnt(11)
    v_mfma_f32_16x16x32_bf16 v[52:55], a[176:179], a[68:71], v[52:55]
    s_waitcnt lgkmcnt(10)
    v_mfma_f32_16x16x32_bf16 v[52:55], a[180:183], a[84:87], v[52:55]
    buffer_load_dwordx4 v31, s[20:23], s36 offen offset:1024  lds
    s_waitcnt lgkmcnt(9)
    v_mfma_f32_16x16x32_bf16 v[52:55], a[184:187], a[100:103], v[52:55]
    s_waitcnt lgkmcnt(8)
    v_mfma_f32_16x16x32_bf16 v[52:55], a[188:191], a[116:119], v[52:55]
    v_mul_f32 v48, v48, v240
    v_mul_f32 v49, v49, v240
    s_waitcnt lgkmcnt(7)
    v_mfma_f32_16x16x32_bf16 v[56:59], a[176:179], a[72:75], v[56:59]
    v_mul_f32 v50, v50, v240
    v_mul_f32 v51, v51, v240
    s_waitcnt lgkmcnt(6)
    v_mfma_f32_16x16x32_bf16 v[56:59], a[180:183], a[88:91], v[56:59]
    v_cvt_pk_bf16_f32 v160, v48, v49
    buffer_load_dwordx4 v32, s[20:23], s36 offen offset:2048  lds
    s_waitcnt lgkmcnt(5)
    v_mfma_f32_16x16x32_bf16 v[56:59], a[184:187], a[104:107], v[56:59]
    v_cvt_pk_bf16_f32 v161, v50, v51
    s_waitcnt lgkmcnt(4)
    v_mfma_f32_16x16x32_bf16 v[56:59], a[188:191], a[120:123], v[56:59]
    v_mul_f32 v52, v52, v241
    v_mul_f32 v53, v53, v241
    s_waitcnt lgkmcnt(3)
    v_mfma_f32_16x16x32_bf16 v[60:63], a[176:179], a[76:79], v[60:63]
    v_mul_f32 v54, v54, v241
    buffer_load_dwordx4 v33, s[20:23], s36 offen offset:3072  lds
    s_waitcnt lgkmcnt(2)
    v_mfma_f32_16x16x32_bf16 v[60:63], a[180:183], a[92:95], v[60:63]
    v_mul_f32 v55, v55, v241
    v_cvt_pk_bf16_f32 v162, v52, v53
    s_waitcnt lgkmcnt(1)
    v_mfma_f32_16x16x32_bf16 v[60:63], a[184:187], a[108:111], v[60:63]
    v_cvt_pk_bf16_f32 v163, v54, v55
    s_xor_b32 s78, s60, 65536
    buffer_store_dwordx4 v[160:163], v10, s[24:27], s78 offen sc1
    s_waitcnt lgkmcnt(0)
    v_mfma_f32_16x16x32_bf16 v[60:63], a[188:191], a[124:127], v[60:63]
    v_mul_f32 v56, v56, v242
    v_mul_f32 v57, v57, v242
    v_mfma_f32_16x16x32_bf16 v[68:71], a[192:195], a[0:3], 0
    v_mul_f32 v58, v58, v242
    v_mul_f32 v59, v59, v242
    v_mfma_f32_16x16x32_bf16 v[68:71], a[196:199], a[16:19], v[68:71]
    s_mov_b32 s36, 640
    s_add_u32 m0, s37, 57344
    v_cvt_pk_bf16_f32 v164, v56, v57
    v_mfma_f32_16x16x32_bf16 v[68:71], a[200:203], a[32:35], v[68:71]
    buffer_load_dwordx4 v30, s[20:23], s36 offen offset:0  lds
    v_cvt_pk_bf16_f32 v165, v58, v59
    v_mfma_f32_16x16x32_bf16 v[68:71], a[204:207], a[48:51], v[68:71]
    v_mul_f32 v60, v60, v243
    v_mul_f32 v61, v61, v243
    v_mfma_f32_16x16x32_bf16 v[72:75], a[192:195], a[4:7], 0
    v_mul_f32 v62, v62, v243
    v_mul_f32 v63, v63, v243
    v_mfma_f32_16x16x32_bf16 v[72:75], a[196:199], a[20:23], v[72:75]
    buffer_load_dwordx4 v31, s[20:23], s36 offen offset:1024  lds
    v_cvt_pk_bf16_f32 v166, v60, v61
    v_mfma_f32_16x16x32_bf16 v[72:75], a[200:203], a[36:39], v[72:75]
    v_cvt_pk_bf16_f32 v167, v62, v63
    s_xor_b32 s78, s60, 73728
    buffer_store_dwordx4 v[164:167], v10, s[24:27], s78 offen sc1
    v_mfma_f32_16x16x32_bf16 v[72:75], a[204:207], a[52:55], v[72:75]
    v_mfma_f32_16x16x32_bf16 v[76:79], a[192:195], a[8:11], 0
    v_mfma_f32_16x16x32_bf16 v[76:79], a[196:199], a[24:27], v[76:79]
    buffer_load_dwordx4 v32, s[20:23], s36 offen offset:2048  lds
    v_mfma_f32_16x16x32_bf16 v[76:79], a[200:203], a[40:43], v[76:79]
    v_mfma_f32_16x16x32_bf16 v[76:79], a[204:207], a[56:59], v[76:79]
    v_mfma_f32_16x16x32_bf16 v[80:83], a[192:195], a[12:15], 0
    buffer_load_dwordx4 v33, s[20:23], s36 offen offset:3072  lds
    v_mfma_f32_16x16x32_bf16 v[80:83], a[196:199], a[28:31], v[80:83]
    v_mfma_f32_16x16x32_bf16 v[80:83], a[200:203], a[44:47], v[80:83]
    v_mfma_f32_16x16x32_bf16 v[80:83], a[204:207], a[60:63], v[80:83]
    v_mfma_f32_16x16x32_bf16 v[68:71], a[208:211], a[64:67], v[68:71]
    v_mfma_f32_16x16x32_bf16 v[68:71], a[212:215], a[80:83], v[68:71]
    s_mov_b32 s36, 115328
    s_add_u32 m0, s37, 73728
    v_mfma_f32_16x16x32_bf16 v[68:71], a[216:219], a[96:99], v[68:71]
    buffer_load_dwordx4 v30, s[20:23], s36 offen offset:0  lds
    v_mfma_f32_16x16x32_bf16 v[68:71], a[220:223], a[112:115], v[68:71]
    v_mfma_f32_16x16x32_bf16 v[72:75], a[208:211], a[68:71], v[72:75]
    v_mfma_f32_16x16x32_bf16 v[72:75], a[212:215], a[84:87], v[72:75]
    buffer_load_dwordx4 v31, s[20:23], s36 offen offset:1024  lds
    v_mfma_f32_16x16x32_bf16 v[72:75], a[216:219], a[100:103], v[72:75]
    v_mfma_f32_16x16x32_bf16 v[72:75], a[220:223], a[116:119], v[72:75]
    s_nop 2
    v_mul_f32 v68, v68, v240
    v_mul_f32 v69, v69, v240
    v_mfma_f32_16x16x32_bf16 v[76:79], a[208:211], a[72:75], v[76:79]
    v_mul_f32 v70, v70, v240
    v_mul_f32 v71, v71, v240
    v_mfma_f32_16x16x32_bf16 v[76:79], a[212:215], a[88:91], v[76:79]
    buffer_load_dwordx4 v32, s[20:23], s36 offen offset:2048  lds
    v_cvt_pk_bf16_f32 v168, v68, v69
    v_mfma_f32_16x16x32_bf16 v[76:79], a[216:219], a[104:107], v[76:79]
    v_cvt_pk_bf16_f32 v169, v70, v71
    v_mfma_f32_16x16x32_bf16 v[76:79], a[220:223], a[120:123], v[76:79]
    v_mul_f32 v72, v72, v241
    v_mul_f32 v73, v73, v241
    v_mfma_f32_16x16x32_bf16 v[80:83], a[208:211], a[76:79], v[80:83]
    buffer_load_dwordx4 v33, s[20:23], s36 offen offset:3072  lds
    v_mul_f32 v74, v74, v241
    v_mfma_f32_16x16x32_bf16 v[80:83], a[212:215], a[92:95], v[80:83]
    v_mul_f32 v75, v75, v241
    v_cvt_pk_bf16_f32 v170, v72, v73
    v_mfma_f32_16x16x32_bf16 v[80:83], a[216:219], a[108:111], v[80:83]
    v_cvt_pk_bf16_f32 v171, v74, v75
    s_xor_b32 s78, s60, 69632
    buffer_store_dwordx4 v[168:171], v10, s[24:27], s78 offen sc1
    v_mfma_f32_16x16x32_bf16 v[80:83], a[220:223], a[124:127], v[80:83]
    v_mul_f32 v76, v76, v242
    v_mul_f32 v77, v77, v242
    v_mfma_f32_16x16x32_bf16 v[48:51], a[224:227], a[0:3], 0
    v_mul_f32 v78, v78, v242
    v_mul_f32 v79, v79, v242
    v_mfma_f32_16x16x32_bf16 v[48:51], a[228:231], a[16:19], v[48:51]
    s_waitcnt vmcnt(11)
    s_barrier
    v_mfma_f32_16x16x32_bf16 v[48:51], a[232:235], a[32:35], v[48:51]
    s_mov_b32 s36, 768
    s_add_u32 m0, s37, 0
    s_nop 0
    buffer_load_dwordx4 v30, s[20:23], s36 offen offset:0  lds
    v_mfma_f32_16x16x32_bf16 v[48:51], a[236:239], a[48:51], v[48:51]
    ds_read_b64_tr_b16 v[128:129], v5 offset:12288
    v_cvt_pk_bf16_f32 v172, v76, v77
    v_mfma_f32_16x16x32_bf16 v[52:55], a[224:227], a[4:7], 0
    ds_read_b64_tr_b16 v[130:131], v5 offset:14336
    v_cvt_pk_bf16_f32 v173, v78, v79
    v_mfma_f32_16x16x32_bf16 v[52:55], a[228:231], a[20:23], v[52:55]
    buffer_load_dwordx4 v31, s[20:23], s36 offen offset:1024  lds
    ds_read_b64_tr_b16 v[132:133], v5 offset:28672
    v_mfma_f32_16x16x32_bf16 v[52:55], a[232:235], a[36:39], v[52:55]
    ds_read_b64_tr_b16 v[134:135], v5 offset:30720
    v_mul_f32 v80, v80, v243
    v_mfma_f32_16x16x32_bf16 v[52:55], a[236:239], a[52:55], v[52:55]
    ds_read_b64_tr_b16 v[136:137], v5 offset:45056
    v_mul_f32 v81, v81, v243
    v_mfma_f32_16x16x32_bf16 v[56:59], a[224:227], a[8:11], 0
    ds_read_b64_tr_b16 v[138:139], v5 offset:47104
    v_mul_f32 v82, v82, v243
    v_mfma_f32_16x16x32_bf16 v[56:59], a[228:231], a[24:27], v[56:59]
    buffer_load_dwordx4 v32, s[20:23], s36 offen offset:2048  lds
    ds_read_b64_tr_b16 v[140:141], v5 offset:61440
    v_mfma_f32_16x16x32_bf16 v[56:59], a[232:235], a[40:43], v[56:59]
    ds_read_b64_tr_b16 v[142:143], v5 offset:63488
    v_mul_f32 v83, v83, v243
    v_mfma_f32_16x16x32_bf16 v[56:59], a[236:239], a[56:59], v[56:59]
    v_cvt_pk_bf16_f32 v174, v80, v81
    v_cvt_pk_bf16_f32 v175, v82, v83
    v_mfma_f32_16x16x32_bf16 v[60:63], a[224:227], a[12:15], 0
    buffer_load_dwordx4 v33, s[20:23], s36 offen offset:3072  lds
    s_xor_b32 s78, s60, 77824
    buffer_store_dwordx4 v[172:175], v10, s[24:27], s78 offen sc1
    v_mfma_f32_16x16x32_bf16 v[60:63], a[228:231], a[28:31], v[60:63]
    v_mfma_f32_16x16x32_bf16 v[60:63], a[232:235], a[44:47], v[60:63]
    v_mfma_f32_16x16x32_bf16 v[60:63], a[236:239], a[60:63], v[60:63]
    s_waitcnt lgkmcnt(0)
    v_mfma_f32_16x16x32_bf16 v[48:51], v[128:131], a[64:67], v[48:51]
    v_mfma_f32_16x16x32_bf16 v[48:51], v[132:135], a[80:83], v[48:51]
    s_mov_b32 s36, 115456
    s_add_u32 m0, s37, 16384
    v_mfma_f32_16x16x32_bf16 v[48:51], v[136:139], a[96:99], v[48:51]
    buffer_load_dwordx4 v30, s[20:23], s36 offen offset:0  lds
    ds_read_b64_tr_b16 v[144:145], v5 offset:0
    v_mfma_f32_16x16x32_bf16 v[48:51], v[140:143], a[112:115], v[48:51]
    ds_read_b64_tr_b16 v[146:147], v5 offset:2048
    ds_read_b64_tr_b16 v[148:149], v5 offset:16384
    v_mfma_f32_16x16x32_bf16 v[52:55], v[128:131], a[68:71], v[52:55]
    ds_read_b64_tr_b16 v[150:151], v5 offset:18432
    ds_read_b64_tr_b16 v[152:153], v5 offset:32768
    v_mfma_f32_16x16x32_bf16 v[52:55], v[132:135], a[84:87], v[52:55]
    buffer_load_dwordx4 v31, s[20:23], s36 offen offset:1024  lds
    ds_read_b64_tr_b16 v[154:155], v5 offset:34816
    v_mfma_f32_16x16x32_bf16 v[52:55], v[136:139], a[100:103], v[52:55]
    ds_read_b64_tr_b16 v[156:157], v5 offset:49152
    ds_read_b64_tr_b16 v[158:159], v5 offset:51200
    v_mfma_f32_16x16x32_bf16 v[52:55], v[140:143], a[116:119], v[52:55]
    v_mul_f32 v48, v48, v240
    v_mul_f32 v49, v49, v240
    v_mfma_f32_16x16x32_bf16 v[56:59], v[128:131], a[72:75], v[56:59]
    v_mul_f32 v50, v50, v240
    v_mul_f32 v51, v51, v240
    v_mfma_f32_16x16x32_bf16 v[56:59], v[132:135], a[88:91], v[56:59]
    buffer_load_dwordx4 v32, s[20:23], s36 offen offset:2048  lds
    v_cvt_pk_bf16_f32 v176, v48, v49
    v_mfma_f32_16x16x32_bf16 v[56:59], v[136:139], a[104:107], v[56:59]
    v_cvt_pk_bf16_f32 v177, v50, v51
    v_mfma_f32_16x16x32_bf16 v[56:59], v[140:143], a[120:123], v[56:59]
    v_mul_f32 v52, v52, v241
    v_mul_f32 v53, v53, v241
    v_mfma_f32_16x16x32_bf16 v[60:63], v[128:131], a[76:79], v[60:63]
    buffer_load_dwordx4 v33, s[20:23], s36 offen offset:3072  lds
    v_mul_f32 v54, v54, v241
    v_mfma_f32_16x16x32_bf16 v[60:63], v[132:135], a[92:95], v[60:63]
    v_mul_f32 v55, v55, v241
    v_cvt_pk_bf16_f32 v178, v52, v53
    v_mfma_f32_16x16x32_bf16 v[60:63], v[136:139], a[108:111], v[60:63]
    v_cvt_pk_bf16_f32 v179, v54, v55
    s_xor_b32 s78, s60, 81920
    buffer_store_dwordx4 v[176:179], v10, s[24:27], s78 offen sc1
    v_mfma_f32_16x16x32_bf16 v[60:63], v[140:143], a[124:127], v[60:63]
    v_mul_f32 v56, v56, v242
    v_mul_f32 v57, v57, v242
    s_waitcnt lgkmcnt(0)
    v_mfma_f32_16x16x32_bf16 v[68:71], v[144:147], a[0:3], 0
    v_mul_f32 v58, v58, v242
    v_mul_f32 v59, v59, v242
    v_mfma_f32_16x16x32_bf16 v[68:71], v[148:151], a[16:19], v[68:71]
    ds_read_b64_tr_b16 v[128:129], v5 offset:4096
    v_cvt_pk_bf16_f32 v180, v56, v57
    v_mfma_f32_16x16x32_bf16 v[68:71], v[152:155], a[32:35], v[68:71]
    ds_read_b64_tr_b16 v[130:131], v5 offset:6144
    v_cvt_pk_bf16_f32 v181, v58, v59
    v_mfma_f32_16x16x32_bf16 v[68:71], v[156:159], a[48:51], v[68:71]
    ds_read_b64_tr_b16 v[132:133], v5 offset:20480
    v_mul_f32 v60, v60, v243
    v_mfma_f32_16x16x32_bf16 v[72:75], v[144:147], a[4:7], 0
    ds_read_b64_tr_b16 v[134:135], v5 offset:22528
    v_mul_f32 v61, v61, v243
    v_mfma_f32_16x16x32_bf16 v[72:75], v[148:151], a[20:23], v[72:75]
    ds_read_b64_tr_b16 v[136:137], v5 offset:36864
    v_mul_f32 v62, v62, v243
    v_mfma_f32_16x16x32_bf16 v[72:75], v[152:155], a[36:39], v[72:75]
    ds_read_b64_tr_b16 v[138:139], v5 offset:38912
    v_mul_f32 v63, v63, v243
    v_mfma_f32_16x16x32_bf16 v[72:75], v[156:159], a[52:55], v[72:75]
    ds_read_b64_tr_b16 v[140:141], v5 offset:53248
    v_cvt_pk_bf16_f32 v182, v60, v61
    v_mfma_f32_16x16x32_bf16 v[76:79], v[144:147], a[8:11], 0
    ds_read_b64_tr_b16 v[142:143], v5 offset:55296
    v_cvt_pk_bf16_f32 v183, v62, v63
    v_mfma_f32_16x16x32_bf16 v[76:79], v[148:151], a[24:27], v[76:79]
    s_xor_b32 s78, s60, 90112
    buffer_store_dwordx4 v[180:183], v10, s[24:27], s78 offen sc1
    v_mfma_f32_16x16x32_bf16 v[76:79], v[152:155], a[40:43], v[76:79]
    v_mfma_f32_16x16x32_bf16 v[76:79], v[156:159], a[56:59], v[76:79]
    v_mfma_f32_16x16x32_bf16 v[80:83], v[144:147], a[12:15], 0
    v_mfma_f32_16x16x32_bf16 v[80:83], v[148:151], a[28:31], v[80:83]
    v_mfma_f32_16x16x32_bf16 v[80:83], v[152:155], a[44:47], v[80:83]
    v_mfma_f32_16x16x32_bf16 v[80:83], v[156:159], a[60:63], v[80:83]
    s_waitcnt lgkmcnt(0)
    v_mfma_f32_16x16x32_bf16 v[68:71], v[128:131], a[64:67], v[68:71]
    v_mfma_f32_16x16x32_bf16 v[68:71], v[132:135], a[80:83], v[68:71]
    ds_read_b64_tr_b16 v[144:145], v5 offset:8192
    ds_read_b64_tr_b16 v[146:147], v5 offset:10240
    v_mfma_f32_16x16x32_bf16 v[68:71], v[136:139], a[96:99], v[68:71]
    ds_read_b64_tr_b16 v[148:149], v5 offset:24576
    ds_read_b64_tr_b16 v[150:151], v5 offset:26624
    v_mfma_f32_16x16x32_bf16 v[68:71], v[140:143], a[112:115], v[68:71]
    ds_read_b64_tr_b16 v[152:153], v5 offset:40960
    ds_read_b64_tr_b16 v[154:155], v5 offset:43008
    v_mfma_f32_16x16x32_bf16 v[72:75], v[128:131], a[68:71], v[72:75]
    ds_read_b64_tr_b16 v[156:157], v5 offset:57344
    ds_read_b64_tr_b16 v[158:159], v5 offset:59392
    v_mfma_f32_16x16x32_bf16 v[72:75], v[132:135], a[84:87], v[72:75]
    v_mfma_f32_16x16x32_bf16 v[72:75], v[136:139], a[100:103], v[72:75]
    v_mfma_f32_16x16x32_bf16 v[72:75], v[140:143], a[116:119], v[72:75]
    v_mul_f32 v68, v68, v240
    v_mul_f32 v69, v69, v240
    v_mfma_f32_16x16x32_bf16 v[76:79], v[128:131], a[72:75], v[76:79]
    v_mul_f32 v70, v70, v240
    v_mul_f32 v71, v71, v240
    v_mfma_f32_16x16x32_bf16 v[76:79], v[132:135], a[88:91], v[76:79]
    v_cvt_pk_bf16_f32 v160, v68, v69
    v_cvt_pk_bf16_f32 v161, v70, v71
    v_mfma_f32_16x16x32_bf16 v[76:79], v[136:139], a[104:107], v[76:79]
    v_mfma_f32_16x16x32_bf16 v[76:79], v[140:143], a[120:123], v[76:79]
    v_mul_f32 v72, v72, v241
    v_mul_f32 v73, v73, v241
    v_mfma_f32_16x16x32_bf16 v[80:83], v[128:131], a[76:79], v[80:83]
    v_mul_f32 v74, v74, v241
    v_mul_f32 v75, v75, v241
    v_mfma_f32_16x16x32_bf16 v[80:83], v[132:135], a[92:95], v[80:83]
    v_cvt_pk_bf16_f32 v162, v72, v73
    v_cvt_pk_bf16_f32 v163, v74, v75
    v_mfma_f32_16x16x32_bf16 v[80:83], v[136:139], a[108:111], v[80:83]
    s_xor_b32 s78, s60, 86016
    buffer_store_dwordx4 v[160:163], v10, s[24:27], s78 offen sc1
    v_mfma_f32_16x16x32_bf16 v[80:83], v[140:143], a[124:127], v[80:83]
    v_mul_f32 v76, v76, v242
    v_mul_f32 v77, v77, v242
    s_waitcnt lgkmcnt(0)
    v_mfma_f32_16x16x32_bf16 v[48:51], v[144:147], a[0:3], 0
    v_mul_f32 v78, v78, v242
    v_mul_f32 v79, v79, v242
    v_mfma_f32_16x16x32_bf16 v[48:51], v[148:151], a[16:19], v[48:51]
    ds_read_b64_tr_b16 v[128:129], v255 offset:0
    v_cvt_pk_bf16_f32 v164, v76, v77
    v_mfma_f32_16x16x32_bf16 v[48:51], v[152:155], a[32:35], v[48:51]
    ds_read_b64_tr_b16 v[130:131], v255 offset:2048
    v_cvt_pk_bf16_f32 v165, v78, v79
    v_mfma_f32_16x16x32_bf16 v[48:51], v[156:159], a[48:51], v[48:51]
    ds_read_b64_tr_b16 v[132:133], v255 offset:4096
    v_mul_f32 v80, v80, v243
    v_mfma_f32_16x16x32_bf16 v[52:55], v[144:147], a[4:7], 0
    ds_read_b64_tr_b16 v[134:135], v255 offset:6144
    v_mul_f32 v81, v81, v243
    v_mfma_f32_16x16x32_bf16 v[52:55], v[148:151], a[20:23], v[52:55]
    ds_read_b64_tr_b16 v[136:137], v255 offset:8192
    v_mul_f32 v82, v82, v243
    v_mfma_f32_16x16x32_bf16 v[52:55], v[152:155], a[36:39], v[52:55]
    ds_read_b64_tr_b16 v[138:139], v255 offset:10240
    v_mul_f32 v83, v83, v243
    v_mfma_f32_16x16x32_bf16 v[52:55], v[156:159], a[52:55], v[52:55]
    ds_read_b64_tr_b16 v[140:141], v255 offset:12288
    v_cvt_pk_bf16_f32 v166, v80, v81
    v_mfma_f32_16x16x32_bf16 v[56:59], v[144:147], a[8:11], 0
    ds_read_b64_tr_b16 v[142:143], v255 offset:14336
    v_cvt_pk_bf16_f32 v167, v82, v83
    v_mfma_f32_16x16x32_bf16 v[56:59], v[148:151], a[24:27], v[56:59]
    s_xor_b32 s78, s60, 94208
    buffer_store_dwordx4 v[164:167], v10, s[24:27], s78 offen sc1
    v_mfma_f32_16x16x32_bf16 v[56:59], v[152:155], a[40:43], v[56:59]
    v_mfma_f32_16x16x32_bf16 v[56:59], v[156:159], a[56:59], v[56:59]
    v_mfma_f32_16x16x32_bf16 v[60:63], v[144:147], a[12:15], 0
    v_mfma_f32_16x16x32_bf16 v[60:63], v[148:151], a[28:31], v[60:63]
    v_mfma_f32_16x16x32_bf16 v[60:63], v[152:155], a[44:47], v[60:63]
    v_mfma_f32_16x16x32_bf16 v[60:63], v[156:159], a[60:63], v[60:63]
    s_waitcnt lgkmcnt(0)
    v_mfma_f32_16x16x32_bf16 v[48:51], v[128:131], a[64:67], v[48:51]
    v_mfma_f32_16x16x32_bf16 v[48:51], v[132:135], a[80:83], v[48:51]
    s_waitcnt vmcnt(4)
    s_barrier
    v_mfma_f32_16x16x32_bf16 v[48:51], v[136:139], a[96:99], v[48:51]
    ds_read_b64_tr_b16 v[144:145], v255 offset:16384
    ds_read_b64_tr_b16 v[146:147], v255 offset:18432
    v_mfma_f32_16x16x32_bf16 v[48:51], v[140:143], a[112:115], v[48:51]
    ds_read_b64_tr_b16 v[148:149], v255 offset:20480
    ds_read_b64_tr_b16 v[150:151], v255 offset:22528
    v_mfma_f32_16x16x32_bf16 v[52:55], v[128:131], a[68:71], v[52:55]
    ds_read_b64_tr_b16 v[152:153], v255 offset:24576
    ds_read_b64_tr_b16 v[154:155], v255 offset:26624
    v_mfma_f32_16x16x32_bf16 v[52:55], v[132:135], a[84:87], v[52:55]
    ds_read_b64_tr_b16 v[156:157], v255 offset:28672
    ds_read_b64_tr_b16 v[158:159], v255 offset:30720
    v_mfma_f32_16x16x32_bf16 v[52:55], v[136:139], a[100:103], v[52:55]
    v_mfma_f32_16x16x32_bf16 v[52:55], v[140:143], a[116:119], v[52:55]
    v_mul_f32 v48, v48, v240
    v_mul_f32 v49, v49, v240
    v_mfma_f32_16x16x32_bf16 v[56:59], v[128:131], a[72:75], v[56:59]
    v_mul_f32 v50, v50, v240
    v_mul_f32 v51, v51, v240
    v_mfma_f32_16x16x32_bf16 v[56:59], v[132:135], a[88:91], v[56:59]
    v_cvt_pk_bf16_f32 v168, v48, v49
    v_cvt_pk_bf16_f32 v169, v50, v51
    v_mfma_f32_16x16x32_bf16 v[56:59], v[136:139], a[104:107], v[56:59]
    v_mfma_f32_16x16x32_bf16 v[56:59], v[140:143], a[120:123], v[56:59]
    v_mul_f32 v52, v52, v241
    v_mul_f32 v53, v53, v241
    v_mfma_f32_16x16x32_bf16 v[60:63], v[128:131], a[76:79], v[60:63]
    v_mul_f32 v54, v54, v241
    v_mul_f32 v55, v55, v241
    v_mfma_f32_16x16x32_bf16 v[60:63], v[132:135], a[92:95], v[60:63]
    v_cvt_pk_bf16_f32 v170, v52, v53
    v_cvt_pk_bf16_f32 v171, v54, v55
    v_mfma_f32_16x16x32_bf16 v[60:63], v[136:139], a[108:111], v[60:63]
    s_xor_b32 s78, s60, 98304
    buffer_store_dwordx4 v[168:171], v10, s[24:27], s78 offen sc1
    v_mfma_f32_16x16x32_bf16 v[60:63], v[140:143], a[124:127], v[60:63]
    v_mul_f32 v56, v56, v242
    v_mul_f32 v57, v57, v242
    s_waitcnt lgkmcnt(0)
    v_mfma_f32_16x16x32_bf16 v[68:71], v[144:147], a[0:3], 0
    v_mul_f32 v58, v58, v242
    v_mul_f32 v59, v59, v242
    v_mfma_f32_16x16x32_bf16 v[68:71], v[148:151], a[16:19], v[68:71]
    ds_read_b64_tr_b16 v[128:129], v255 offset:32768
    v_cvt_pk_bf16_f32 v172, v56, v57
    v_mfma_f32_16x16x32_bf16 v[68:71], v[152:155], a[32:35], v[68:71]
    ds_read_b64_tr_b16 v[130:131], v255 offset:34816
    v_cvt_pk_bf16_f32 v173, v58, v59
    v_mfma_f32_16x16x32_bf16 v[68:71], v[156:159], a[48:51], v[68:71]
    ds_read_b64_tr_b16 v[132:133], v255 offset:36864
    v_mul_f32 v60, v60, v243
    v_mfma_f32_16x16x32_bf16 v[72:75], v[144:147], a[4:7], 0
    ds_read_b64_tr_b16 v[134:135], v255 offset:38912
    v_mul_f32 v61, v61, v243
    v_mfma_f32_16x16x32_bf16 v[72:75], v[148:151], a[20:23], v[72:75]
    ds_read_b64_tr_b16 v[136:137], v255 offset:40960
    v_mul_f32 v62, v62, v243
    v_mfma_f32_16x16x32_bf16 v[72:75], v[152:155], a[36:39], v[72:75]
    ds_read_b64_tr_b16 v[138:139], v255 offset:43008
    v_mul_f32 v63, v63, v243
    v_mfma_f32_16x16x32_bf16 v[72:75], v[156:159], a[52:55], v[72:75]
    ds_read_b64_tr_b16 v[140:141], v255 offset:45056
    v_cvt_pk_bf16_f32 v174, v60, v61
    v_mfma_f32_16x16x32_bf16 v[76:79], v[144:147], a[8:11], 0
    ds_read_b64_tr_b16 v[142:143], v255 offset:47104
    v_cvt_pk_bf16_f32 v175, v62, v63
    v_mfma_f32_16x16x32_bf16 v[76:79], v[148:151], a[24:27], v[76:79]
    s_xor_b32 s78, s60, 106496
    buffer_store_dwordx4 v[172:175], v10, s[24:27], s78 offen sc1
    v_mfma_f32_16x16x32_bf16 v[76:79], v[152:155], a[40:43], v[76:79]
    s_waitcnt vmcnt(2)
    s_mov_b64 exec, 1
    buffer_atomic_swap v250, v37, s[4:7], s40 offen offset:384 sc1
    s_mov_b64 exec, -1
    v_mfma_f32_16x16x32_bf16 v[76:79], v[156:159], a[56:59], v[76:79]
    v_mfma_f32_16x16x32_bf16 v[80:83], v[144:147], a[12:15], 0
    v_mfma_f32_16x16x32_bf16 v[80:83], v[148:151], a[28:31], v[80:83]
    v_mfma_f32_16x16x32_bf16 v[80:83], v[152:155], a[44:47], v[80:83]
    v_mfma_f32_16x16x32_bf16 v[80:83], v[156:159], a[60:63], v[80:83]
    s_waitcnt lgkmcnt(0)
    v_mfma_f32_16x16x32_bf16 v[68:71], v[128:131], a[64:67], v[68:71]
    v_mfma_f32_16x16x32_bf16 v[68:71], v[132:135], a[80:83], v[68:71]
    ds_read_b64_tr_b16 v[144:145], v1 offset:0
    ds_read_b64_tr_b16 v[146:147], v1 offset:2048
    v_mfma_f32_16x16x32_bf16 v[68:71], v[136:139], a[96:99], v[68:71]
    ds_read_b64_tr_b16 v[148:149], v1 offset:4096
    ds_read_b64_tr_b16 v[150:151], v1 offset:6144
    v_mfma_f32_16x16x32_bf16 v[68:71], v[140:143], a[112:115], v[68:71]
    ds_read_b64_tr_b16 v[152:153], v1 offset:8192
    ds_read_b64_tr_b16 v[154:155], v1 offset:10240
    v_mfma_f32_16x16x32_bf16 v[72:75], v[128:131], a[68:71], v[72:75]
    ds_read_b64_tr_b16 v[156:157], v1 offset:12288
    ds_read_b64_tr_b16 v[158:159], v1 offset:14336
    v_mfma_f32_16x16x32_bf16 v[72:75], v[132:135], a[84:87], v[72:75]
    v_mfma_f32_16x16x32_bf16 v[72:75], v[136:139], a[100:103], v[72:75]
    v_mfma_f32_16x16x32_bf16 v[72:75], v[140:143], a[116:119], v[72:75]
    v_mul_f32 v68, v68, v240
    v_mul_f32 v69, v69, v240
    v_mfma_f32_16x16x32_bf16 v[76:79], v[128:131], a[72:75], v[76:79]
    v_mul_f32 v70, v70, v240
    v_mul_f32 v71, v71, v240
    v_mfma_f32_16x16x32_bf16 v[76:79], v[132:135], a[88:91], v[76:79]
    v_cvt_pk_bf16_f32 v176, v68, v69
    v_cvt_pk_bf16_f32 v177, v70, v71
    v_mfma_f32_16x16x32_bf16 v[76:79], v[136:139], a[104:107], v[76:79]
    v_mfma_f32_16x16x32_bf16 v[76:79], v[140:143], a[120:123], v[76:79]
    v_mul_f32 v72, v72, v241
    v_mul_f32 v73, v73, v241
    v_mfma_f32_16x16x32_bf16 v[80:83], v[128:131], a[76:79], v[80:83]
    v_mul_f32 v74, v74, v241
    v_mul_f32 v75, v75, v241
    v_mfma_f32_16x16x32_bf16 v[80:83], v[132:135], a[92:95], v[80:83]
    v_cvt_pk_bf16_f32 v178, v72, v73
    v_cvt_pk_bf16_f32 v179, v74, v75
    v_mfma_f32_16x16x32_bf16 v[80:83], v[136:139], a[108:111], v[80:83]
    s_xor_b32 s78, s60, 102400
    buffer_store_dwordx4 v[176:179], v10, s[24:27], s78 offen sc1
    v_mfma_f32_16x16x32_bf16 v[80:83], v[140:143], a[124:127], v[80:83]
    v_mul_f32 v76, v76, v242
    v_mul_f32 v77, v77, v242
    s_waitcnt lgkmcnt(0)
    v_mfma_f32_16x16x32_bf16 v[48:51], v[144:147], a[0:3], 0
    v_mul_f32 v78, v78, v242
    v_mul_f32 v79, v79, v242
    v_mfma_f32_16x16x32_bf16 v[48:51], v[148:151], a[16:19], v[48:51]
    ds_read_b64_tr_b16 v[128:129], v1 offset:16384
    v_cvt_pk_bf16_f32 v180, v76, v77
    v_mfma_f32_16x16x32_bf16 v[48:51], v[152:155], a[32:35], v[48:51]
    ds_read_b64_tr_b16 v[130:131], v1 offset:18432
    v_cvt_pk_bf16_f32 v181, v78, v79
    v_mfma_f32_16x16x32_bf16 v[48:51], v[156:159], a[48:51], v[48:51]
    ds_read_b64_tr_b16 v[132:133], v1 offset:20480
    v_mul_f32 v80, v80, v243
    v_mfma_f32_16x16x32_bf16 v[52:55], v[144:147], a[4:7], 0
    ds_read_b64_tr_b16 v[134:135], v1 offset:22528
    v_mul_f32 v81, v81, v243
    v_mfma_f32_16x16x32_bf16 v[52:55], v[148:151], a[20:23], v[52:55]
    ds_read_b64_tr_b16 v[136:137], v1 offset:24576
    v_mul_f32 v82, v82, v243
    v_mfma_f32_16x16x32_bf16 v[52:55], v[152:155], a[36:39], v[52:55]
    ds_read_b64_tr_b16 v[138:139], v1 offset:26624
    v_mul_f32 v83, v83, v243
    v_mfma_f32_16x16x32_bf16 v[52:55], v[156:159], a[52:55], v[52:55]
    ds_read_b64_tr_b16 v[140:141], v1 offset:28672
    v_cvt_pk_bf16_f32 v182, v80, v81
    v_mfma_f32_16x16x32_bf16 v[56:59], v[144:147], a[8:11], 0
    ds_read_b64_tr_b16 v[142:143], v1 offset:30720
    v_cvt_pk_bf16_f32 v183, v82, v83
    v_mfma_f32_16x16x32_bf16 v[56:59], v[148:151], a[24:27], v[56:59]
    s_xor_b32 s78, s60, 110592
    buffer_store_dwordx4 v[180:183], v10, s[24:27], s78 offen sc1
    v_mfma_f32_16x16x32_bf16 v[56:59], v[152:155], a[40:43], v[56:59]
    v_mfma_f32_16x16x32_bf16 v[56:59], v[156:159], a[56:59], v[56:59]
    v_mfma_f32_16x16x32_bf16 v[60:63], v[144:147], a[12:15], 0
    v_mfma_f32_16x16x32_bf16 v[60:63], v[148:151], a[28:31], v[60:63]
    v_mfma_f32_16x16x32_bf16 v[60:63], v[152:155], a[44:47], v[60:63]
    v_mfma_f32_16x16x32_bf16 v[60:63], v[156:159], a[60:63], v[60:63]
    s_waitcnt lgkmcnt(0)
    v_mfma_f32_16x16x32_bf16 v[48:51], v[128:131], a[64:67], v[48:51]
    v_mfma_f32_16x16x32_bf16 v[48:51], v[132:135], a[80:83], v[48:51]
    v_mfma_f32_16x16x32_bf16 v[48:51], v[136:139], a[96:99], v[48:51]
    v_mfma_f32_16x16x32_bf16 v[48:51], v[140:143], a[112:115], v[48:51]
    v_mfma_f32_16x16x32_bf16 v[52:55], v[128:131], a[68:71], v[52:55]
    v_mfma_f32_16x16x32_bf16 v[52:55], v[132:135], a[84:87], v[52:55]
    v_mfma_f32_16x16x32_bf16 v[52:55], v[136:139], a[100:103], v[52:55]
    v_mfma_f32_16x16x32_bf16 v[52:55], v[140:143], a[116:119], v[52:55]
    s_nop 3
    v_mul_f32 v48, v48, v240
    v_mul_f32 v49, v49, v240
    v_mfma_f32_16x16x32_bf16 v[56:59], v[128:131], a[72:75], v[56:59]
    v_mul_f32 v50, v50, v240
    v_mul_f32 v51, v51, v240
    v_mfma_f32_16x16x32_bf16 v[56:59], v[132:135], a[88:91], v[56:59]
    v_cvt_pk_bf16_f32 v160, v48, v49
    v_cvt_pk_bf16_f32 v161, v50, v51
    v_mfma_f32_16x16x32_bf16 v[56:59], v[136:139], a[104:107], v[56:59]
    v_mfma_f32_16x16x32_bf16 v[56:59], v[140:143], a[120:123], v[56:59]
    v_mul_f32 v52, v52, v241
    v_mul_f32 v53, v53, v241
    v_mfma_f32_16x16x32_bf16 v[60:63], v[128:131], a[76:79], v[60:63]
    v_mul_f32 v54, v54, v241
    v_mul_f32 v55, v55, v241
    v_mfma_f32_16x16x32_bf16 v[60:63], v[132:135], a[92:95], v[60:63]
    v_cvt_pk_bf16_f32 v162, v52, v53
    v_cvt_pk_bf16_f32 v163, v54, v55
    v_mfma_f32_16x16x32_bf16 v[60:63], v[136:139], a[108:111], v[60:63]
    s_xor_b32 s78, s60, 114688
    buffer_store_dwordx4 v[160:163], v10, s[24:27], s78 offen sc1
    v_mfma_f32_16x16x32_bf16 v[60:63], v[140:143], a[124:127], v[60:63]
    v_mul_f32 v56, v56, v242
    v_mul_f32 v57, v57, v242
    v_mul_f32 v58, v58, v242
    v_mul_f32 v59, v59, v242
    v_cvt_pk_bf16_f32 v164, v56, v57
    v_cvt_pk_bf16_f32 v165, v58, v59
    s_nop 1
    v_mul_f32 v60, v60, v243
    v_mul_f32 v61, v61, v243
    v_mul_f32 v62, v62, v243
    v_mul_f32 v63, v63, v243
    v_cvt_pk_bf16_f32 v166, v60, v61
    v_cvt_pk_bf16_f32 v167, v62, v63
    s_xor_b32 s78, s60, 122880
    buffer_store_dwordx4 v[164:167], v10, s[24:27], s78 offen sc1
    s_waitcnt vmcnt(0)
    s_mov_b64 exec, 1
    buffer_atomic_swap v250, v37, s[4:7], s40 offen offset:768 sc1
    s_mov_b64 exec, -1
    s_mov_b32 s79, 0x100000
    s_mov_b32 s77, 0xffff
L_poll_l:
    s_mov_b32 exec_lo, s77
    s_mov_b32 exec_hi, 0
    v_mov_b32 v38, 0
    buffer_atomic_or v38, v254, s[4:7], s41 offen sc0 sc1
    s_sub_u32 s79, s79, 1
    s_cbranch_scc1 L_k1_end
    s_waitcnt vmcnt(0)
    v_cmp_eq_u32 vcc, v38, v250
    s_mov_b32 exec_lo, -1
    s_nop 0
    s_andn2_b32 s77, s77, vcc_lo
    s_cbranch_scc1 L_poll_l
    s_mov_b32 exec_hi, -1
    s_xor_b32 s78, s42, 0
    buffer_load_dwordx4 v[64:67], v10, s[4:7], s78 offen sc1
    s_xor_b32 s78, s42, 135168
    buffer_load_dwordx4 v[68:71], v10, s[4:7], s78 offen sc1
    s_xor_b32 s78, s61, 278528
    buffer_load_dwordx4 v[72:75], v10, s[4:7], s78 offen sc1
    s_xor_b32 s78, s61, 413696
    buffer_load_dwordx4 v[76:79], v10, s[4:7], s78 offen sc1
    s_xor_b32 s78, s42, 557056
    buffer_load_dwordx4 v[80:83], v10, s[4:7], s78 offen sc1
    s_xor_b32 s78, s42, 692224
    buffer_load_dwordx4 v[84:87], v10, s[4:7], s78 offen sc1
    s_xor_b32 s78, s61, 835584
    buffer_load_dwordx4 v[88:91], v10, s[4:7], s78 offen sc1
    s_xor_b32 s78, s61, 970752
    buffer_load_dwordx4 v[92:95], v10, s[4:7], s78 offen sc1
    s_xor_b32 s78, s42, 1114112
    buffer_load_dwordx4 v[96:99], v10, s[4:7], s78 offen sc1
    s_xor_b32 s78, s42, 1249280
    buffer_load_dwordx4 v[100:103], v10, s[4:7], s78 offen sc1
    s_xor_b32 s78, s61, 1392640
    buffer_load_dwordx4 v[104:107], v10, s[4:7], s78 offen sc1
    s_xor_b32 s78, s61, 1527808
    buffer_load_dwordx4 v[108:111], v10, s[4:7], s78 offen sc1
    s_xor_b32 s78, s42, 1671168
    buffer_load_dwordx4 v[112:115], v10, s[4:7], s78 offen sc1
    s_xor_b32 s78, s42, 1806336
    buffer_load_dwordx4 v[116:119], v10, s[4:7], s78 offen sc1
    s_xor_b32 s78, s61, 1949696
    buffer_load_dwordx4 v[120:123], v10, s[4:7], s78 offen sc1
    s_xor_b32 s78, s61, 2084864
    buffer_load_dwordx4 v[124:127], v10, s[4:7], s78 offen sc1
L_sum_l:
    s_mov_b32 s35, 0x00003f80
    s_mov_b32 s76, 0x3f800000
    s_waitcnt vmcnt(15)
    v_lshlrev_b32 v128, 16, v64
    v_and_b32 v129, 0xffff0000, v64
    v_lshlrev_b32 v130, 16, v65
    v_and_b32 v131, 0xffff0000, v65
    v_lshlrev_b32 v132, 16, v66
    v_and_b32 v133, 0xffff0000, v66
    v_lshlrev_b32 v134, 16, v67
    v_and_b32 v135, 0xffff0000, v67
    s_waitcnt vmcnt(14)
    v_dot2c_f32_bf16 v128, s35, v68
    v_dot2c_f32_bf16 v129, s76, v68
    v_dot2c_f32_bf16 v130, s35, v69
    v_dot2c_f32_bf16 v131, s76, v69
    v_dot2c_f32_bf16 v132, s35, v70
    v_dot2c_f32_bf16 v133, s76, v70
    v_dot2c_f32_bf16 v134, s35, v71
    v_dot2c_f32_bf16 v135, s76, v71
    s_waitcnt vmcnt(13)
    v_dot2c_f32_bf16 v128, s35, v72
    v_dot2c_f32_bf16 v129, s76, v72
    v_dot2c_f32_bf16 v130, s35, v73
    v_dot2c_f32_bf16 v131, s76, v73
    v_dot2c_f32_bf16 v132, s35, v74
    v_dot2c_f32_bf16 v133, s76, v74
    v_dot2c_f32_bf16 v134, s35, v75
    v_dot2c_f32_bf16 v135, s76, v75
    s_waitcnt vmcnt(12)
    v_dot2c_f32_bf16 v128, s35, v76
    v_dot2c_f32_bf16 v129, s76, v76
    v_dot2c_f32_bf16 v130, s35, v77
    v_dot2c_f32_bf16 v131, s76, v77
    v_dot2c_f32_bf16 v132, s35, v78
    v_dot2c_f32_bf16 v133, s76, v78
    v_dot2c_f32_bf16 v134, s35, v79
    v_dot2c_f32_bf16 v135, s76, v79
    s_waitcnt vmcnt(11)
    v_dot2c_f32_bf16 v128, s35, v80
    v_dot2c_f32_bf16 v129, s76, v80
    v_dot2c_f32_bf16 v130, s35, v81
    v_dot2c_f32_bf16 v131, s76, v81
    v_dot2c_f32_bf16 v132, s35, v82
    v_dot2c_f32_bf16 v133, s76, v82
    v_dot2c_f32_bf16 v134, s35, v83
    v_dot2c_f32_bf16 v135, s76, v83
    s_waitcnt vmcnt(10)
    v_dot2c_f32_bf16 v128, s35, v84
    v_dot2c_f32_bf16 v129, s76, v84
    v_dot2c_f32_bf16 v130, s35, v85
    v_dot2c_f32_bf16 v131, s76, v85
    v_dot2c_f32_bf16 v132, s35, v86
    v_dot2c_f32_bf16 v133, s76, v86
    v_dot2c_f32_bf16 v134, s35, v87
    v_dot2c_f32_bf16 v135, s76, v87
    s_waitcnt vmcnt(9)
    v_dot2c_f32_bf16 v128, s35, v88
    v_dot2c_f32_bf16 v129, s76, v88
    v_dot2c_f32_bf16 v130, s35, v89
    v_dot2c_f32_bf16 v131, s76, v89
    v_dot2c_f32_bf16 v132, s35, v90
    v_dot2c_f32_bf16 v133, s76, v90
    v_dot2c_f32_bf16 v134, s35, v91
    v_dot2c_f32_bf16 v135, s76, v91
    s_waitcnt vmcnt(8)
    v_dot2c_f32_bf16 v128, s35, v92
    v_dot2c_f32_bf16 v129, s76, v92
    v_dot2c_f32_bf16 v130, s35, v93
    v_dot2c_f32_bf16 v131, s76, v93
    v_dot2c_f32_bf16 v132, s35, v94
    v_dot2c_f32_bf16 v133, s76, v94
    v_dot2c_f32_bf16 v134, s35, v95
    v_dot2c_f32_bf16 v135, s76, v95
    s_waitcnt vmcnt(7)
    v_dot2c_f32_bf16 v128, s35, v96
    v_dot2c_f32_bf16 v129, s76, v96
    v_dot2c_f32_bf16 v130, s35, v97
    v_dot2c_f32_bf16 v131, s76, v97
    v_dot2c_f32_bf16 v132, s35, v98
    v_dot2c_f32_bf16 v133, s76, v98
    v_dot2c_f32_bf16 v134, s35, v99
    v_dot2c_f32_bf16 v135, s76, v99
    s_waitcnt vmcnt(6)
    v_dot2c_f32_bf16 v128, s35, v100
    v_dot2c_f32_bf16 v129, s76, v100
    v_dot2c_f32_bf16 v130, s35, v101
    v_dot2c_f32_bf16 v131, s76, v101
    v_dot2c_f32_bf16 v132, s35, v102
    v_dot2c_f32_bf16 v133, s76, v102
    v_dot2c_f32_bf16 v134, s35, v103
    v_dot2c_f32_bf16 v135, s76, v103
    s_waitcnt vmcnt(5)
    v_dot2c_f32_bf16 v128, s35, v104
    v_dot2c_f32_bf16 v129, s76, v104
    v_dot2c_f32_bf16 v130, s35, v105
    v_dot2c_f32_bf16 v131, s76, v105
    v_dot2c_f32_bf16 v132, s35, v106
    v_dot2c_f32_bf16 v133, s76, v106
    v_dot2c_f32_bf16 v134, s35, v107
    v_dot2c_f32_bf16 v135, s76, v107
    s_waitcnt vmcnt(4)
    v_dot2c_f32_bf16 v128, s35, v108
    v_dot2c_f32_bf16 v129, s76, v108
    v_dot2c_f32_bf16 v130, s35, v109
    v_dot2c_f32_bf16 v131, s76, v109
    v_dot2c_f32_bf16 v132, s35, v110
    v_dot2c_f32_bf16 v133, s76, v110
    v_dot2c_f32_bf16 v134, s35, v111
    v_dot2c_f32_bf16 v135, s76, v111
    s_waitcnt vmcnt(3)
    v_dot2c_f32_bf16 v128, s35, v112
    v_dot2c_f32_bf16 v129, s76, v112
    v_dot2c_f32_bf16 v130, s35, v113
    v_dot2c_f32_bf16 v131, s76, v113
    v_dot2c_f32_bf16 v132, s35, v114
    v_dot2c_f32_bf16 v133, s76, v114
    v_dot2c_f32_bf16 v134, s35, v115
    v_dot2c_f32_bf16 v135, s76, v115
    s_waitcnt vmcnt(2)
    v_dot2c_f32_bf16 v128, s35, v116
    v_dot2c_f32_bf16 v129, s76, v116
    v_dot2c_f32_bf16 v130, s35, v117
    v_dot2c_f32_bf16 v131, s76, v117
    v_dot2c_f32_bf16 v132, s35, v118
    v_dot2c_f32_bf16 v133, s76, v118
    v_dot2c_f32_bf16 v134, s35, v119
    v_dot2c_f32_bf16 v135, s76, v119
    s_waitcnt vmcnt(1)
    v_dot2c_f32_bf16 v128, s35, v120
    v_dot2c_f32_bf16 v129, s76, v120
    v_dot2c_f32_bf16 v130, s35, v121
    v_dot2c_f32_bf16 v131, s76, v121
    v_dot2c_f32_bf16 v132, s35, v122
    v_dot2c_f32_bf16 v133, s76, v122
    v_dot2c_f32_bf16 v134, s35, v123
    v_dot2c_f32_bf16 v135, s76, v123
    s_waitcnt vmcnt(0)
    v_dot2c_f32_bf16 v128, s35, v124
    v_dot2c_f32_bf16 v129, s76, v124
    v_dot2c_f32_bf16 v130, s35, v125
    v_dot2c_f32_bf16 v131, s76, v125
    v_dot2c_f32_bf16 v132, s35, v126
    v_dot2c_f32_bf16 v133, s76, v126
    v_dot2c_f32_bf16 v134, s35, v127
    v_dot2c_f32_bf16 v135, s76, v127
    s_nop 2
    v_cvt_pk_bf16_f32 v140, v128, v129
    v_cvt_pk_bf16_f32 v141, v130, v131
    v_cvt_pk_bf16_f32 v142, v132, v133
    v_cvt_pk_bf16_f32 v143, v134, v135
    s_nop 0
    v_permlane16_swap_b32 v140, v142
    v_permlane16_swap_b32 v141, v143
    ds_write_b128 v12, v[140:143]
    s_cmp_lg_u32 s43, 0
    s_waitcnt lgkmcnt(0)
    s_barrier
    s_cbranch_scc1 L_exp1_l
    ds_read_b128 v[140:143], v252
    s_waitcnt lgkmcnt(0)
    buffer_store_dwordx4 v[140:143], v251, s[16:19], 0 offen sc1
L_exp1_l:
L_end_l:
    s_endpgm
L_tag0:
    s_add_u32 s44, s50, 17039360
    s_addc_u32 s45, s51, 0
    s_load_dword s40, s[44:45], 0
    v_bfe_u32 v242, v0, 4, 1
    v_lshlrev_b32 v242, 13, v242
    v_lshrrev_b32 v241, 5, v0
    v_mul_u32_u24 v241, 20480, v241
    v_add_u32 v241, v241, v242
    v_and_b32 v242, 15, v0
    v_lshl_add_u32 v241, v242, 3, v241
    v_add_u32 v241, 65536, v241
    v_mov_b32 v242, 0
    v_mov_b32 v243, 0
    global_store_dwordx2 v241, v[242:243], s[44:45] sc1
    s_waitcnt lgkmcnt(0)
    s_branch L_tag0done
.p2align 6
L_tag:
    s_getreg_b32 s76, hwreg(HW_REG_XCC_ID, 0, 3)
    s_mov_b32 s79, 0x1000
    s_mov_b32 s41, 1
    s_mov_b32 s42, 1
    s_mov_b32 s43, 0x800
    s_load_dword s41, s[44:45], 65536
    s_load_dword s42, s[44:45], 73728
L_raceA0:
    s_sub_u32 s43, s43, 1
    s_min_u32 s77, s43, s41
    s_cmp_lg_u32 s77, 0
    s_cbranch_scc1 L_raceA0
    s_mov_b32 s43, 0x800
L_raceB0:
    s_sub_u32 s43, s43, 1
    s_min_u32 s77, s43, s42
    s_cmp_lg_u32 s77, 0
    s_cbranch_scc1 L_raceB0
    s_waitcnt lgkmcnt(0)
    s_sub_u32 s79, s79, s43
    s_mov_b32 s41, 1
    s_mov_b32 s42, 1
    s_mov_b32 s43, 0x800
    s_load_dword s41, s[44:45], 94208
    s_load_dword s42, s[44:45], 86016
L_raceA1:
    s_sub_u32 s43, s43, 1
    s_min_u32 s77, s43, s41
    s_cmp_lg_u32 s77, 0
    s_cbranch_scc1 L_raceA1
    s_mov_b32 s43, 0x800
L_raceB1:
    s_sub_u32 s43, s43, 1
    s_min_u32 s77, s43, s42
    s_cmp_lg_u32 s77, 0
    s_cbranch_scc1 L_raceB1
    s_waitcnt lgkmcnt(0)
    s_add_u32 s79, s79, s43
    s_and_b32 s76, s76, 3
    s_cmp_le_u32 s79, 4094
    s_cselect_b32 s77, 4, 8
    s_cmp_ge_u32 s79, 4098
    s_cselect_b32 s77, 0, s77
    s_add_u32 s76, s76, s77
    s_or_b32 s35, s40, 31
    s_add_u32 s35, s35, 2
    s_lshl1_add_u32 s35, s76, s35
    v_mov_b32 v250, s35
    v_mov_b32 v253, 0
    s_mov_b64 exec, 1
    global_store_dword v253, v250, s[48:49] sc1
    global_store_dword v253, v250, s[44:45] sc1
    s_mov_b64 exec, -1
    s_branch L_tagdone
L_main_end:
L_ep_h:
    s_mov_b32 s79, 0x100000
    v_mov_b32 v38, 0
L_ep2_h:
    global_load_dword v250, v38, s[48:49] sc1
    s_waitcnt vmcnt(0)
    s_sub_u32 s79, s79, 1
    s_cbranch_scc1 L_epok_h
    v_cmp_eq_u32 vcc, 0, v250
    s_nop 1
    s_cbranch_vccnz L_ep2_h
    s_branch L_epok_h
L_slow_h:
    s_waitcnt vmcnt(0) lgkmcnt(0)
    s_nop 7
    s_barrier
    s_mov_b32 s39, 1
    v_and_b32 v39, 15, v0
    v_lshlrev_b32 v39, 9, v39
    v_lshrrev_b32 v38, 4, v0
    v_lshl_add_u32 v39, v38, 4, v39
    s_and_b32 s35, s33, 1
    s_lshl_b32 s35, s35, 12
    v_xor_b32 v39, s35, v39
    v_add_u32 v39, 3072, v39
    v_mov_b32 v245, 0xff800000
    v_mov_b32 v246, 0xff800000
    v_mov_b32 v247, 0xff800000
    v_mov_b32 v248, 0xff800000
    v_mov_b32 v249, 0xff800000
    s_mov_b32 s36, 0
L_slow1_h:
    buffer_load_dwordx4 v[208:211], v39, s[8:11], s36 offen offset:0
    buffer_load_dwordx4 v[212:215], v39, s[8:11], s36 offen offset:64
    buffer_load_dwordx4 v[216:219], v39, s[8:11], s36 offen offset:128
    buffer_load_dwordx4 v[220:223], v39, s[8:11], s36 offen offset:192
    buffer_load_dwordx4 v[224:227], v39, s[8:11], s36 offen offset:256
    buffer_load_dwordx4 v[228:231], v39, s[8:11], s36 offen offset:320
    buffer_load_dwordx4 v[232:235], v39, s[8:11], s36 offen offset:384
    buffer_load_dwordx4 v[236:239], v39, s[8:11], s36 offen offset:448
    s_waitcnt vmcnt(7)
    v_mfma_f32_16x16x32_bf16 v[48:51], v[208:211], a[0:3], 0
    v_mfma_f32_16x16x32_bf16 v[52:55], v[208:211], a[4:7], 0
    v_mfma_f32_16x16x32_bf16 v[56:59], v[208:211], a[8:11], 0
    v_mfma_f32_16x16x32_bf16 v[60:63], v[208:211], a[12:15], 0
    v_mfma_f32_16x16x32_bf16 v[64:67], v[208:211], a[16:19], 0
    s_waitcnt vmcnt(6)
    v_mfma_f32_16x16x32_bf16 v[48:51], v[212:215], a[20:23], v[48:51]
    v_mfma_f32_16x16x32_bf16 v[52:55], v[212:215], a[24:27], v[52:55]
    v_mfma_f32_16x16x32_bf16 v[56:59], v[212:215], a[28:31], v[56:59]
    v_mfma_f32_16x16x32_bf16 v[60:63], v[212:215], a[32:35], v[60:63]
    v_mfma_f32_16x16x32_bf16 v[64:67], v[212:215], a[36:39], v[64:67]
    s_waitcnt vmcnt(5)
    v_mfma_f32_16x16x32_bf16 v[48:51], v[216:219], a[40:43], v[48:51]
    v_mfma_f32_16x16x32_bf16 v[52:55], v[216:219], a[44:47], v[52:55]
    v_mfma_f32_16x16x32_bf16 v[56:59], v[216:219], a[48:51], v[56:59]
    v_mfma_f32_16x16x32_bf16 v[60:63], v[216:219], a[52:55], v[60:63]
    v_mfma_f32_16x16x32_bf16 v[64:67], v[216:219], a[56:59], v[64:67]
    s_waitcnt vmcnt(4)
    v_mfma_f32_16x16x32_bf16 v[48:51], v[220:223], a[60:63], v[48:51]
    v_mfma_f32_16x16x32_bf16 v[52:55], v[220:223], a[64:67], v[52:55]
    v_mfma_f32_16x16x32_bf16 v[56:59], v[220:223], a[68:71], v[56:59]
    v_mfma_f32_16x16x32_bf16 v[60:63], v[220:223], a[72:75], v[60:63]
    v_mfma_f32_16x16x32_bf16 v[64:67], v[220:223], a[76:79], v[64:67]
    s_waitcnt vmcnt(3)
    v_mfma_f32_16x16x32_bf16 v[48:51], v[224:227], a[80:83], v[48:51]
    v_mfma_f32_16x16x32_bf16 v[52:55], v[224:227], a[84:87], v[52:55]
    v_mfma_f32_16x16x32_bf16 v[56:59], v[224:227], a[88:91], v[56:59]
    v_mfma_f32_16x16x32_bf16 v[60:63], v[224:227], a[92:95], v[60:63]
    v_mfma_f32_16x16x32_bf16 v[64:67], v[224:227], a[96:99], v[64:67]
    s_waitcnt vmcnt(2)
    v_mfma_f32_16x16x32_bf16 v[48:51], v[228:231], a[100:103], v[48:51]
    v_mfma_f32_16x16x32_bf16 v[52:55], v[228:231], a[104:107], v[52:55]
    v_mfma_f32_16x16x32_bf16 v[56:59], v[228:231], a[108:111], v[56:59]
    v_mfma_f32_16x16x32_bf16 v[60:63], v[228:231], a[112:115], v[60:63]
    v_mfma_f32_16x16x32_bf16 v[64:67], v[228:231], a[116:119], v[64:67]
    s_waitcnt vmcnt(1)
    v_mfma_f32_16x16x32_bf16 v[48:51], v[232:235], a[120:123], v[48:51]
    v_mfma_f32_16x16x32_bf16 v[52:55], v[232:235], a[124:127], v[52:55]
    v_mfma_f32_16x16x32_bf16 v[56:59], v[232:235], a[128:131], v[56:59]
    v_mfma_f32_16x16x32_bf16 v[60:63], v[232:235], a[132:135], v[60:63]
    v_mfma_f32_16x16x32_bf16 v[64:67], v[232:235], a[136:139], v[64:67]
    s_waitcnt vmcnt(0)
    v_mfma_f32_16x16x32_bf16 v[48:51], v[236:239], a[140:143], v[48:51]
    v_mfma_f32_16x16x32_bf16 v[52:55], v[236:239], a[144:147], v[52:55]
    v_mfma_f32_16x16x32_bf16 v[56:59], v[236:239], a[148:151], v[56:59]
    v_mfma_f32_16x16x32_bf16 v[60:63], v[236:239], a[152:155], v[60:63]
    v_mfma_f32_16x16x32_bf16 v[64:67], v[236:239], a[156:159], v[64:67]
    s_nop 3
    v_max3_f32 v245, v245, v48, v49
    v_max3_f32 v245, v245, v50, v51
    v_max3_f32 v246, v246, v52, v53
    v_max3_f32 v246, v246, v54, v55
    v_max3_f32 v247, v247, v56, v57
    v_max3_f32 v247, v247, v58, v59
    v_max3_f32 v248, v248, v60, v61
    v_max3_f32 v248, v248, v62, v63
    v_max3_f32 v249, v249, v64, v65
    v_max3_f32 v249, v249, v66, v67
    s_add_u32 s36, s36, 8192
    s_cmp_lt_u32 s36, 65536
    s_cbranch_scc1 L_slow1_h
    v_mov_b32 v38, v245
    s_nop 1
    v_permlane32_swap_b32 v38, v245
    s_nop 1
    v_max_f32 v245, v245, v38
    v_mov_b32 v38, v245
    s_nop 1
    v_permlane16_swap_b32 v38, v245
    s_nop 1
    v_max_f32 v245, v245, v38
    ds_write_b32 v13, v245 offset:2048
    v_mov_b32 v38, v246
    s_nop 1
    v_permlane32_swap_b32 v38, v246
    s_nop 1
    v_max_f32 v246, v246, v38
    v_mov_b32 v38, v246
    s_nop 1
    v_permlane16_swap_b32 v38, v246
    s_nop 1
    v_max_f32 v246, v246, v38
    ds_write_b32 v13, v246 offset:2304
    v_mov_b32 v38, v247
    s_nop 1
    v_permlane32_swap_b32 v38, v247
    s_nop 1
    v_max_f32 v247, v247, v38
    v_mov_b32 v38, v247
    s_nop 1
    v_permlane16_swap_b32 v38, v247
    s_nop 1
    v_max_f32 v247, v247, v38
    ds_write_b32 v13, v247 offset:2560
    v_mov_b32 v38, v248
    s_nop 1
    v_permlane32_swap_b32 v38, v248
    s_nop 1
    v_max_f32 v248, v248, v38
    v_mov_b32 v38, v248
    s_nop 1
    v_permlane16_swap_b32 v38, v248
    s_nop 1
    v_max_f32 v248, v248, v38
    ds_write_b32 v13, v248 offset:2816
    v_mov_b32 v38, v249
    s_nop 1
    v_permlane32_swap_b32 v38, v249
    s_nop 1
    v_max_f32 v249, v249, v38
    v_mov_b32 v38, v249
    s_nop 1
    v_permlane16_swap_b32 v38, v249
    s_nop 1
    v_max_f32 v249, v249, v38
    ds_write_b32 v13, v249 offset:3072
    s_waitcnt vmcnt(0) lgkmcnt(0)
    s_barrier
    ds_read_b128 v[160:163], v14 offset:2048
    s_waitcnt lgkmcnt(0)
    v_max3_f32 v160, v160, v161, v162
    v_max_f32 v245, v160, v163
    ds_read_b128 v[164:167], v14 offset:2304
    s_waitcnt lgkmcnt(0)
    v_max3_f32 v164, v164, v165, v166
    v_max_f32 v246, v164, v167
    ds_read_b128 v[168:171], v14 offset:2560
    s_waitcnt lgkmcnt(0)
    v_max3_f32 v168, v168, v169, v170
    v_max_f32 v247, v168, v171
    ds_read_b128 v[172:175], v14 offset:2816
    s_waitcnt lgkmcnt(0)
    v_max3_f32 v172, v172, v173, v174
    v_max_f32 v248, v172, v175
    ds_read_b128 v[176:179], v14 offset:3072
    s_waitcnt lgkmcnt(0)
    v_max3_f32 v176, v176, v177, v178
    v_max_f32 v249, v176, v179
    v_mov_b32 v88, 0
    v_mov_b32 v89, 0
    v_mov_b32 v90, 0
    v_mov_b32 v91, 0
    v_mov_b32 v92, 0
    v_mov_b32 v93, 0
    v_mov_b32 v94, 0
    v_mov_b32 v95, 0
    v_mov_b32 v96, 0
    v_mov_b32 v97, 0
    v_mov_b32 v98, 0
    v_mov_b32 v99, 0
    v_mov_b32 v100, 0
    v_mov_b32 v101, 0
    v_mov_b32 v102, 0
    v_mov_b32 v103, 0
    v_mov_b32 v104, 0
    v_mov_b32 v105, 0
    v_mov_b32 v106, 0
    v_mov_b32 v107, 0
    s_mov_b32 s79, 0
L_slow2_h:
    s_cmp_eq_u32 s79, 0
    s_cselect_b32 s36, 0, s36
    s_cselect_b32 s35, 49152, s35
    s_cmp_eq_u32 s79, 1
    s_cselect_b32 s36, 16384, s36
    s_cselect_b32 s35, 69632, s35
    s_cmp_eq_u32 s79, 2
    s_cselect_b32 s36, 32768, s36
    s_cselect_b32 s35, 0, s35
    s_cmp_eq_u32 s79, 3
    s_cselect_b32 s36, 49152, s36
    s_cselect_b32 s35, 20480, s35
    s_xor_b32 s36, s36, s1
    v_add_u32 v40, s35, v15
    buffer_load_dwordx4 v[208:211], v39, s[8:11], s36 offen offset:0
    buffer_load_dwordx4 v[212:215], v39, s[8:11], s36 offen offset:64
    buffer_load_dwordx4 v[216:219], v39, s[8:11], s36 offen offset:128
    buffer_load_dwordx4 v[220:223], v39, s[8:11], s36 offen offset:192
    buffer_load_dwordx4 v[224:227], v39, s[8:11], s36 offen offset:256
    buffer_load_dwordx4 v[228:231], v39, s[8:11], s36 offen offset:320
    buffer_load_dwordx4 v[232:235], v39, s[8:11], s36 offen offset:384
    buffer_load_dwordx4 v[236:239], v39, s[8:11], s36 offen offset:448
    s_waitcnt vmcnt(7)
    v_mfma_f32_16x16x32_bf16 v[48:51], v[208:211], a[0:3], 0
    v_mfma_f32_16x16x32_bf16 v[52:55], v[208:211], a[4:7], 0
    v_mfma_f32_16x16x32_bf16 v[56:59], v[208:211], a[8:11], 0
    v_mfma_f32_16x16x32_bf16 v[60:63], v[208:211], a[12:15], 0
    v_mfma_f32_16x16x32_bf16 v[64:67], v[208:211], a[16:19], 0
    s_waitcnt vmcnt(6)
    v_mfma_f32_16x16x32_bf16 v[48:51], v[212:215], a[20:23], v[48:51]
    v_mfma_f32_16x16x32_bf16 v[52:55], v[212:215], a[24:27], v[52:55]
    v_mfma_f32_16x16x32_bf16 v[56:59], v[212:215], a[28:31], v[56:59]
    v_mfma_f32_16x16x32_bf16 v[60:63], v[212:215], a[32:35], v[60:63]
    v_mfma_f32_16x16x32_bf16 v[64:67], v[212:215], a[36:39], v[64:67]
    s_waitcnt vmcnt(5)
    v_mfma_f32_16x16x32_bf16 v[48:51], v[216:219], a[40:43], v[48:51]
    v_mfma_f32_16x16x32_bf16 v[52:55], v[216:219], a[44:47], v[52:55]
    v_mfma_f32_16x16x32_bf16 v[56:59], v[216:219], a[48:51], v[56:59]
    v_mfma_f32_16x16x32_bf16 v[60:63], v[216:219], a[52:55], v[60:63]
    v_mfma_f32_16x16x32_bf16 v[64:67], v[216:219], a[56:59], v[64:67]
    s_waitcnt vmcnt(4)
    v_mfma_f32_16x16x32_bf16 v[48:51], v[220:223], a[60:63], v[48:51]
    v_mfma_f32_16x16x32_bf16 v[52:55], v[220:223], a[64:67], v[52:55]
    v_mfma_f32_16x16x32_bf16 v[56:59], v[220:223], a[68:71], v[56:59]
    v_mfma_f32_16x16x32_bf16 v[60:63], v[220:223], a[72:75], v[60:63]
    v_mfma_f32_16x16x32_bf16 v[64:67], v[220:223], a[76:79], v[64:67]
    s_waitcnt vmcnt(3)
    v_mfma_f32_16x16x32_bf16 v[48:51], v[224:227], a[80:83], v[48:51]
    v_mfma_f32_16x16x32_bf16 v[52:55], v[224:227], a[84:87], v[52:55]
    v_mfma_f32_16x16x32_bf16 v[56:59], v[224:227], a[88:91], v[56:59]
    v_mfma_f32_16x16x32_bf16 v[60:63], v[224:227], a[92:95], v[60:63]
    v_mfma_f32_16x16x32_bf16 v[64:67], v[224:227], a[96:99], v[64:67]
    s_waitcnt vmcnt(2)
    v_mfma_f32_16x16x32_bf16 v[48:51], v[228:231], a[100:103], v[48:51]
    v_mfma_f32_16x16x32_bf16 v[52:55], v[228:231], a[104:107], v[52:55]
    v_mfma_f32_16x16x32_bf16 v[56:59], v[228:231], a[108:111], v[56:59]
    v_mfma_f32_16x16x32_bf16 v[60:63], v[228:231], a[112:115], v[60:63]
    v_mfma_f32_16x16x32_bf16 v[64:67], v[228:231], a[116:119], v[64:67]
    s_waitcnt vmcnt(1)
    v_mfma_f32_16x16x32_bf16 v[48:51], v[232:235], a[120:123], v[48:51]
    v_mfma_f32_16x16x32_bf16 v[52:55], v[232:235], a[124:127], v[52:55]
    v_mfma_f32_16x16x32_bf16 v[56:59], v[232:235], a[128:131], v[56:59]
    v_mfma_f32_16x16x32_bf16 v[60:63], v[232:235], a[132:135], v[60:63]
    v_mfma_f32_16x16x32_bf16 v[64:67], v[232:235], a[136:139], v[64:67]
    s_waitcnt vmcnt(0)
    v_mfma_f32_16x16x32_bf16 v[48:51], v[236:239], a[140:143], v[48:51]
    v_mfma_f32_16x16x32_bf16 v[52:55], v[236:239], a[144:147], v[52:55]
    v_mfma_f32_16x16x32_bf16 v[56:59], v[236:239], a[148:151], v[56:59]
    v_mfma_f32_16x16x32_bf16 v[60:63], v[236:239], a[152:155], v[60:63]
    v_mfma_f32_16x16x32_bf16 v[64:67], v[236:239], a[156:159], v[64:67]
    s_xor_b32 s36, s36, 8192
    s_nop 2
    v_sub_f32 v48, v48, v245
    v_sub_f32 v49, v49, v245
    v_sub_f32 v50, v50, v245
    v_sub_f32 v51, v51, v245
    v_exp_f32 v48, v48
    v_exp_f32 v49, v49
    v_exp_f32 v50, v50
    v_exp_f32 v51, v51
    v_cvt_pk_bf16_f32 v108, v48, v49
    v_cvt_pk_bf16_f32 v109, v50, v51
    v_sub_f32 v52, v52, v246
    v_sub_f32 v53, v53, v246
    v_sub_f32 v54, v54, v246
    v_sub_f32 v55, v55, v246
    v_exp_f32 v52, v52
    v_exp_f32 v53, v53
    v_exp_f32 v54, v54
    v_exp_f32 v55, v55
    v_cvt_pk_bf16_f32 v112, v52, v53
    v_cvt_pk_bf16_f32 v113, v54, v55
    v_sub_f32 v56, v56, v247
    v_sub_f32 v57, v57, v247
    v_sub_f32 v58, v58, v247
    v_sub_f32 v59, v59, v247
    v_exp_f32 v56, v56
    v_exp_f32 v57, v57
    v_exp_f32 v58, v58
    v_exp_f32 v59, v59
    v_cvt_pk_bf16_f32 v116, v56, v57
    v_cvt_pk_bf16_f32 v117, v58, v59
    v_sub_f32 v60, v60, v248
    v_sub_f32 v61, v61, v248
    v_sub_f32 v62, v62, v248
    v_sub_f32 v63, v63, v248
    v_exp_f32 v60, v60
    v_exp_f32 v61, v61
    v_exp_f32 v62, v62
    v_exp_f32 v63, v63
    v_cvt_pk_bf16_f32 v120, v60, v61
    v_cvt_pk_bf16_f32 v121, v62, v63
    v_sub_f32 v64, v64, v249
    v_sub_f32 v65, v65, v249
    v_sub_f32 v66, v66, v249
    v_sub_f32 v67, v67, v249
    v_exp_f32 v64, v64
    v_exp_f32 v65, v65
    v_exp_f32 v66, v66
    v_exp_f32 v67, v67
    v_cvt_pk_bf16_f32 v124, v64, v65
    v_cvt_pk_bf16_f32 v125, v66, v67
    buffer_load_dwordx4 v[208:211], v39, s[8:11], s36 offen offset:0
    buffer_load_dwordx4 v[212:215], v39, s[8:11], s36 offen offset:64
    buffer_load_dwordx4 v[216:219], v39, s[8:11], s36 offen offset:128
    buffer_load_dwordx4 v[220:223], v39, s[8:11], s36 offen offset:192
    buffer_load_dwordx4 v[224:227], v39, s[8:11], s36 offen offset:256
    buffer_load_dwordx4 v[228:231], v39, s[8:11], s36 offen offset:320
    buffer_load_dwordx4 v[232:235], v39, s[8:11], s36 offen offset:384
    buffer_load_dwordx4 v[236:239], v39, s[8:11], s36 offen offset:448
    s_waitcnt vmcnt(7)
    v_mfma_f32_16x16x32_bf16 v[68:71], v[208:211], a[0:3], 0
    v_mfma_f32_16x16x32_bf16 v[72:75], v[208:211], a[4:7], 0
    v_mfma_f32_16x16x32_bf16 v[76:79], v[208:211], a[8:11], 0
    v_mfma_f32_16x16x32_bf16 v[80:83], v[208:211], a[12:15], 0
    v_mfma_f32_16x16x32_bf16 v[84:87], v[208:211], a[16:19], 0
    s_waitcnt vmcnt(6)
    v_mfma_f32_16x16x32_bf16 v[68:71], v[212:215], a[20:23], v[68:71]
    v_mfma_f32_16x16x32_bf16 v[72:75], v[212:215], a[24:27], v[72:75]
    v_mfma_f32_16x16x32_bf16 v[76:79], v[212:215], a[28:31], v[76:79]
    v_mfma_f32_16x16x32_bf16 v[80:83], v[212:215], a[32:35], v[80:83]
    v_mfma_f32_16x16x32_bf16 v[84:87], v[212:215], a[36:39], v[84:87]
    s_waitcnt vmcnt(5)
    v_mfma_f32_16x16x32_bf16 v[68:71], v[216:219], a[40:43], v[68:71]
    v_mfma_f32_16x16x32_bf16 v[72:75], v[216:219], a[44:47], v[72:75]
    v_mfma_f32_16x16x32_bf16 v[76:79], v[216:219], a[48:51], v[76:79]
    v_mfma_f32_16x16x32_bf16 v[80:83], v[216:219], a[52:55], v[80:83]
    v_mfma_f32_16x16x32_bf16 v[84:87], v[216:219], a[56:59], v[84:87]
    s_waitcnt vmcnt(4)
    v_mfma_f32_16x16x32_bf16 v[68:71], v[220:223], a[60:63], v[68:71]
    v_mfma_f32_16x16x32_bf16 v[72:75], v[220:223], a[64:67], v[72:75]
    v_mfma_f32_16x16x32_bf16 v[76:79], v[220:223], a[68:71], v[76:79]
    v_mfma_f32_16x16x32_bf16 v[80:83], v[220:223], a[72:75], v[80:83]
    v_mfma_f32_16x16x32_bf16 v[84:87], v[220:223], a[76:79], v[84:87]
    s_waitcnt vmcnt(3)
    v_mfma_f32_16x16x32_bf16 v[68:71], v[224:227], a[80:83], v[68:71]
    v_mfma_f32_16x16x32_bf16 v[72:75], v[224:227], a[84:87], v[72:75]
    v_mfma_f32_16x16x32_bf16 v[76:79], v[224:227], a[88:91], v[76:79]
    v_mfma_f32_16x16x32_bf16 v[80:83], v[224:227], a[92:95], v[80:83]
    v_mfma_f32_16x16x32_bf16 v[84:87], v[224:227], a[96:99], v[84:87]
    s_waitcnt vmcnt(2)
    v_mfma_f32_16x16x32_bf16 v[68:71], v[228:231], a[100:103], v[68:71]
    v_mfma_f32_16x16x32_bf16 v[72:75], v[228:231], a[104:107], v[72:75]
    v_mfma_f32_16x16x32_bf16 v[76:79], v[228:231], a[108:111], v[76:79]
    v_mfma_f32_16x16x32_bf16 v[80:83], v[228:231], a[112:115], v[80:83]
    v_mfma_f32_16x16x32_bf16 v[84:87], v[228:231], a[116:119], v[84:87]
    s_waitcnt vmcnt(1)
    v_mfma_f32_16x16x32_bf16 v[68:71], v[232:235], a[120:123], v[68:71]
    v_mfma_f32_16x16x32_bf16 v[72:75], v[232:235], a[124:127], v[72:75]
    v_mfma_f32_16x16x32_bf16 v[76:79], v[232:235], a[128:131], v[76:79]
    v_mfma_f32_16x16x32_bf16 v[80:83], v[232:235], a[132:135], v[80:83]
    v_mfma_f32_16x16x32_bf16 v[84:87], v[232:235], a[136:139], v[84:87]
    s_waitcnt vmcnt(0)
    v_mfma_f32_16x16x32_bf16 v[68:71], v[236:239], a[140:143], v[68:71]
    v_mfma_f32_16x16x32_bf16 v[72:75], v[236:239], a[144:147], v[72:75]
    v_mfma_f32_16x16x32_bf16 v[76:79], v[236:239], a[148:151], v[76:79]
    v_mfma_f32_16x16x32_bf16 v[80:83], v[236:239], a[152:155], v[80:83]
    v_mfma_f32_16x16x32_bf16 v[84:87], v[236:239], a[156:159], v[84:87]
    s_nop 3
    v_sub_f32 v68, v68, v245
    v_sub_f32 v69, v69, v245
    v_sub_f32 v70, v70, v245
    v_sub_f32 v71, v71, v245
    v_exp_f32 v68, v68
    v_exp_f32 v69, v69
    v_exp_f32 v70, v70
    v_exp_f32 v71, v71
    v_cvt_pk_bf16_f32 v110, v68, v69
    v_cvt_pk_bf16_f32 v111, v70, v71
    v_sub_f32 v72, v72, v246
    v_sub_f32 v73, v73, v246
    v_sub_f32 v74, v74, v246
    v_sub_f32 v75, v75, v246
    v_exp_f32 v72, v72
    v_exp_f32 v73, v73
    v_exp_f32 v74, v74
    v_exp_f32 v75, v75
    v_cvt_pk_bf16_f32 v114, v72, v73
    v_cvt_pk_bf16_f32 v115, v74, v75
    v_sub_f32 v76, v76, v247
    v_sub_f32 v77, v77, v247
    v_sub_f32 v78, v78, v247
    v_sub_f32 v79, v79, v247
    v_exp_f32 v76, v76
    v_exp_f32 v77, v77
    v_exp_f32 v78, v78
    v_exp_f32 v79, v79
    v_cvt_pk_bf16_f32 v118, v76, v77
    v_cvt_pk_bf16_f32 v119, v78, v79
    v_sub_f32 v80, v80, v248
    v_sub_f32 v81, v81, v248
    v_sub_f32 v82, v82, v248
    v_sub_f32 v83, v83, v248
    v_exp_f32 v80, v80
    v_exp_f32 v81, v81
    v_exp_f32 v82, v82
    v_exp_f32 v83, v83
    v_cvt_pk_bf16_f32 v122, v80, v81
    v_cvt_pk_bf16_f32 v123, v82, v83
    v_sub_f32 v84, v84, v249
    v_sub_f32 v85, v85, v249
    v_sub_f32 v86, v86, v249
    v_sub_f32 v87, v87, v249
    v_exp_f32 v84, v84
    v_exp_f32 v85, v85
    v_exp_f32 v86, v86
    v_exp_f32 v87, v87
    v_cvt_pk_bf16_f32 v126, v84, v85
    v_cvt_pk_bf16_f32 v127, v86, v87
    ds_write_b128 v40, v[108:111] offset:0
    v_mfma_f32_16x16x32_bf16 v[88:91], v[44:47], v[108:111], v[88:91]
    ds_write_b128 v40, v[112:115] offset:1024
    v_mfma_f32_16x16x32_bf16 v[92:95], v[44:47], v[112:115], v[92:95]
    ds_write_b128 v40, v[116:119] offset:2048
    v_mfma_f32_16x16x32_bf16 v[96:99], v[44:47], v[116:119], v[96:99]
    ds_write_b128 v40, v[120:123] offset:3072
    v_mfma_f32_16x16x32_bf16 v[100:103], v[44:47], v[120:123], v[100:103]
    ds_write_b128 v40, v[124:127] offset:4096
    v_mfma_f32_16x16x32_bf16 v[104:107], v[44:47], v[124:127], v[104:107]
    s_add_u32 s79, s79, 1
    s_cmp_lt_u32 s79, 4
    s_nop 7
    s_cbranch_scc1 L_slow2_h
    ds_write_b32 v13, v88 offset:0
    ds_write_b32 v13, v92 offset:256
    ds_write_b32 v13, v96 offset:512
    ds_write_b32 v13, v100 offset:768
    ds_write_b32 v13, v104 offset:1024
    s_waitcnt vmcnt(0) lgkmcnt(0)
    s_nop 7
    s_barrier
    s_branch L_pv_h
L_ep_l:
    s_mov_b32 s79, 0x100000
    v_mov_b32 v38, 0
L_ep2_l:
    global_load_dword v250, v38, s[48:49] sc1
    s_waitcnt vmcnt(0)
    s_sub_u32 s79, s79, 1
    s_cbranch_scc1 L_epok_l
    v_cmp_eq_u32 vcc, 0, v250
    s_nop 1
    s_cbranch_vccnz L_ep2_l
    s_branch L_epok_l
L_slow_l:
    s_waitcnt vmcnt(0) lgkmcnt(0)
    s_nop 7
    s_barrier
    s_mov_b32 s39, 1
    v_and_b32 v39, 15, v0
    v_lshlrev_b32 v39, 9, v39
    v_lshrrev_b32 v38, 4, v0
    v_lshl_add_u32 v39, v38, 4, v39
    s_and_b32 s35, s33, 1
    s_lshl_b32 s35, s35, 12
    v_xor_b32 v39, s35, v39
    v_add_u32 v39, 3072, v39
    v_mov_b32 v245, 0xff800000
    v_mov_b32 v246, 0xff800000
    v_mov_b32 v247, 0xff800000
    v_mov_b32 v248, 0xff800000
    s_mov_b32 s36, 0
L_slow1_l:
    buffer_load_dwordx4 v[208:211], v39, s[8:11], s36 offen offset:0
    buffer_load_dwordx4 v[212:215], v39, s[8:11], s36 offen offset:64
    buffer_load_dwordx4 v[216:219], v39, s[8:11], s36 offen offset:128
    buffer_load_dwordx4 v[220:223], v39, s[8:11], s36 offen offset:192
    buffer_load_dwordx4 v[224:227], v39, s[8:11], s36 offen offset:256
    buffer_load_dwordx4 v[228:231], v39, s[8:11], s36 offen offset:320
    buffer_load_dwordx4 v[232:235], v39, s[8:11], s36 offen offset:384
    buffer_load_dwordx4 v[236:239], v39, s[8:11], s36 offen offset:448
    s_waitcnt vmcnt(7)
    v_mfma_f32_16x16x32_bf16 v[48:51], v[208:211], a[0:3], 0
    v_mfma_f32_16x16x32_bf16 v[52:55], v[208:211], a[4:7], 0
    v_mfma_f32_16x16x32_bf16 v[56:59], v[208:211], a[8:11], 0
    v_mfma_f32_16x16x32_bf16 v[60:63], v[208:211], a[12:15], 0
    s_waitcnt vmcnt(6)
    v_mfma_f32_16x16x32_bf16 v[48:51], v[212:215], a[16:19], v[48:51]
    v_mfma_f32_16x16x32_bf16 v[52:55], v[212:215], a[20:23], v[52:55]
    v_mfma_f32_16x16x32_bf16 v[56:59], v[212:215], a[24:27], v[56:59]
    v_mfma_f32_16x16x32_bf16 v[60:63], v[212:215], a[28:31], v[60:63]
    s_waitcnt vmcnt(5)
    v_mfma_f32_16x16x32_bf16 v[48:51], v[216:219], a[32:35], v[48:51]
    v_mfma_f32_16x16x32_bf16 v[52:55], v[216:219], a[36:39], v[52:55]
    v_mfma_f32_16x16x32_bf16 v[56:59], v[216:219], a[40:43], v[56:59]
    v_mfma_f32_16x16x32_bf16 v[60:63], v[216:219], a[44:47], v[60:63]
    s_waitcnt vmcnt(4)
    v_mfma_f32_16x16x32_bf16 v[48:51], v[220:223], a[48:51], v[48:51]
    v_mfma_f32_16x16x32_bf16 v[52:55], v[220:223], a[52:55], v[52:55]
    v_mfma_f32_16x16x32_bf16 v[56:59], v[220:223], a[56:59], v[56:59]
    v_mfma_f32_16x16x32_bf16 v[60:63], v[220:223], a[60:63], v[60:63]
    s_waitcnt vmcnt(3)
    v_mfma_f32_16x16x32_bf16 v[48:51], v[224:227], a[64:67], v[48:51]
    v_mfma_f32_16x16x32_bf16 v[52:55], v[224:227], a[68:71], v[52:55]
    v_mfma_f32_16x16x32_bf16 v[56:59], v[224:227], a[72:75], v[56:59]
    v_mfma_f32_16x16x32_bf16 v[60:63], v[224:227], a[76:79], v[60:63]
    s_waitcnt vmcnt(2)
    v_mfma_f32_16x16x32_bf16 v[48:51], v[228:231], a[80:83], v[48:51]
    v_mfma_f32_16x16x32_bf16 v[52:55], v[228:231], a[84:87], v[52:55]
    v_mfma_f32_16x16x32_bf16 v[56:59], v[228:231], a[88:91], v[56:59]
    v_mfma_f32_16x16x32_bf16 v[60:63], v[228:231], a[92:95], v[60:63]
    s_waitcnt vmcnt(1)
    v_mfma_f32_16x16x32_bf16 v[48:51], v[232:235], a[96:99], v[48:51]
    v_mfma_f32_16x16x32_bf16 v[52:55], v[232:235], a[100:103], v[52:55]
    v_mfma_f32_16x16x32_bf16 v[56:59], v[232:235], a[104:107], v[56:59]
    v_mfma_f32_16x16x32_bf16 v[60:63], v[232:235], a[108:111], v[60:63]
    s_waitcnt vmcnt(0)
    v_mfma_f32_16x16x32_bf16 v[48:51], v[236:239], a[112:115], v[48:51]
    v_mfma_f32_16x16x32_bf16 v[52:55], v[236:239], a[116:119], v[52:55]
    v_mfma_f32_16x16x32_bf16 v[56:59], v[236:239], a[120:123], v[56:59]
    v_mfma_f32_16x16x32_bf16 v[60:63], v[236:239], a[124:127], v[60:63]
    s_nop 4
    v_max3_f32 v245, v245, v48, v49
    v_max3_f32 v245, v245, v50, v51
    v_max3_f32 v246, v246, v52, v53
    v_max3_f32 v246, v246, v54, v55
    v_max3_f32 v247, v247, v56, v57
    v_max3_f32 v247, v247, v58, v59
    v_max3_f32 v248, v248, v60, v61
    v_max3_f32 v248, v248, v62, v63
    s_add_u32 s36, s36, 8192
    s_cmp_lt_u32 s36, 65536
    s_cbranch_scc1 L_slow1_l
    v_mov_b32 v38, v245
    s_nop 1
    v_permlane32_swap_b32 v38, v245
    s_nop 1
    v_max_f32 v245, v245, v38
    v_mov_b32 v38, v245
    s_nop 1
    v_permlane16_swap_b32 v38, v245
    s_nop 1
    v_max_f32 v245, v245, v38
    ds_write_b32 v13, v245 offset:2048
    v_mov_b32 v38, v246
    s_nop 1
    v_permlane32_swap_b32 v38, v246
    s_nop 1
    v_max_f32 v246, v246, v38
    v_mov_b32 v38, v246
    s_nop 1
    v_permlane16_swap_b32 v38, v246
    s_nop 1
    v_max_f32 v246, v246, v38
    ds_write_b32 v13, v246 offset:2304
    v_mov_b32 v38, v247
    s_nop 1
    v_permlane32_swap_b32 v38, v247
    s_nop 1
    v_max_f32 v247, v247, v38
    v_mov_b32 v38, v247
    s_nop 1
    v_permlane16_swap_b32 v38, v247
    s_nop 1
    v_max_f32 v247, v247, v38
    ds_write_b32 v13, v247 offset:2560
    v_mov_b32 v38, v248
    s_nop 1
    v_permlane32_swap_b32 v38, v248
    s_nop 1
    v_max_f32 v248, v248, v38
    v_mov_b32 v38, v248
    s_nop 1
    v_permlane16_swap_b32 v38, v248
    s_nop 1
    v_max_f32 v248, v248, v38
    ds_write_b32 v13, v248 offset:2816
    s_waitcnt vmcnt(0) lgkmcnt(0)
    s_barrier
    ds_read_b128 v[160:163], v14 offset:2048
    s_waitcnt lgkmcnt(0)
    v_max3_f32 v160, v160, v161, v162
    v_max_f32 v245, v160, v163
    ds_read_b128 v[164:167], v14 offset:2304
    s_waitcnt lgkmcnt(0)
    v_max3_f32 v164, v164, v165, v166
    v_max_f32 v246, v164, v167
    ds_read_b128 v[168:171], v14 offset:2560
    s_waitcnt lgkmcnt(0)
    v_max3_f32 v168, v168, v169, v170
    v_max_f32 v247, v168, v171
    ds_read_b128 v[172:175], v14 offset:2816
    s_waitcnt lgkmcnt(0)
    v_max3_f32 v172, v172, v173, v174
    v_max_f32 v248, v172, v175
    v_mov_b32 v88, 0
    v_mov_b32 v89, 0
    v_mov_b32 v90, 0
    v_mov_b32 v91, 0
    v_mov_b32 v92, 0
    v_mov_b32 v93, 0
    v_mov_b32 v94, 0
    v_mov_b32 v95, 0
    v_mov_b32 v96, 0
    v_mov_b32 v97, 0
    v_mov_b32 v98, 0
    v_mov_b32 v99, 0
    v_mov_b32 v100, 0
    v_mov_b32 v101, 0
    v_mov_b32 v102, 0
    v_mov_b32 v103, 0
    s_mov_b32 s79, 0
L_slow2_l:
    s_cmp_eq_u32 s79, 0
    s_cselect_b32 s36, 0, s36
    s_cselect_b32 s35, 49152, s35
    s_cmp_eq_u32 s79, 1
    s_cselect_b32 s36, 16384, s36
    s_cselect_b32 s35, 65536, s35
    s_cmp_eq_u32 s79, 2
    s_cselect_b32 s36, 32768, s36
    s_cselect_b32 s35, 0, s35
    s_cmp_eq_u32 s79, 3
    s_cselect_b32 s36, 49152, s36
    s_cselect_b32 s35, 16384, s35
    s_xor_b32 s36, s36, s1
    v_add_u32 v40, s35, v15
    buffer_load_dwordx4 v[208:211], v39, s[8:11], s36 offen offset:0
    buffer_load_dwordx4 v[212:215], v39, s[8:11], s36 offen offset:64
    buffer_load_dwordx4 v[216:219], v39, s[8:11], s36 offen offset:128
    buffer_load_dwordx4 v[220:223], v39, s[8:11], s36 offen offset:192
    buffer_load_dwordx4 v[224:227], v39, s[8:11], s36 offen offset:256
    buffer_load_dwordx4 v[228:231], v39, s[8:11], s36 offen offset:320
    buffer_load_dwordx4 v[232:235], v39, s[8:11], s36 offen offset:384
    buffer_load_dwordx4 v[236:239], v39, s[8:11], s36 offen offset:448
    s_waitcnt vmcnt(7)
    v_mfma_f32_16x16x32_bf16 v[48:51], v[208:211], a[0:3], 0
    v_mfma_f32_16x16x32_bf16 v[52:55], v[208:211], a[4:7], 0
    v_mfma_f32_16x16x32_bf16 v[56:59], v[208:211], a[8:11], 0
    v_mfma_f32_16x16x32_bf16 v[60:63], v[208:211], a[12:15], 0
    s_waitcnt vmcnt(6)
    v_mfma_f32_16x16x32_bf16 v[48:51], v[212:215], a[16:19], v[48:51]
    v_mfma_f32_16x16x32_bf16 v[52:55], v[212:215], a[20:23], v[52:55]
    v_mfma_f32_16x16x32_bf16 v[56:59], v[212:215], a[24:27], v[56:59]
    v_mfma_f32_16x16x32_bf16 v[60:63], v[212:215], a[28:31], v[60:63]
    s_waitcnt vmcnt(5)
    v_mfma_f32_16x16x32_bf16 v[48:51], v[216:219], a[32:35], v[48:51]
    v_mfma_f32_16x16x32_bf16 v[52:55], v[216:219], a[36:39], v[52:55]
    v_mfma_f32_16x16x32_bf16 v[56:59], v[216:219], a[40:43], v[56:59]
    v_mfma_f32_16x16x32_bf16 v[60:63], v[216:219], a[44:47], v[60:63]
    s_waitcnt vmcnt(4)
    v_mfma_f32_16x16x32_bf16 v[48:51], v[220:223], a[48:51], v[48:51]
    v_mfma_f32_16x16x32_bf16 v[52:55], v[220:223], a[52:55], v[52:55]
    v_mfma_f32_16x16x32_bf16 v[56:59], v[220:223], a[56:59], v[56:59]
    v_mfma_f32_16x16x32_bf16 v[60:63], v[220:223], a[60:63], v[60:63]
    s_waitcnt vmcnt(3)
    v_mfma_f32_16x16x32_bf16 v[48:51], v[224:227], a[64:67], v[48:51]
    v_mfma_f32_16x16x32_bf16 v[52:55], v[224:227], a[68:71], v[52:55]
    v_mfma_f32_16x16x32_bf16 v[56:59], v[224:227], a[72:75], v[56:59]
    v_mfma_f32_16x16x32_bf16 v[60:63], v[224:227], a[76:79], v[60:63]
    s_waitcnt vmcnt(2)
    v_mfma_f32_16x16x32_bf16 v[48:51], v[228:231], a[80:83], v[48:51]
    v_mfma_f32_16x16x32_bf16 v[52:55], v[228:231], a[84:87], v[52:55]
    v_mfma_f32_16x16x32_bf16 v[56:59], v[228:231], a[88:91], v[56:59]
    v_mfma_f32_16x16x32_bf16 v[60:63], v[228:231], a[92:95], v[60:63]
    s_waitcnt vmcnt(1)
    v_mfma_f32_16x16x32_bf16 v[48:51], v[232:235], a[96:99], v[48:51]
    v_mfma_f32_16x16x32_bf16 v[52:55], v[232:235], a[100:103], v[52:55]
    v_mfma_f32_16x16x32_bf16 v[56:59], v[232:235], a[104:107], v[56:59]
    v_mfma_f32_16x16x32_bf16 v[60:63], v[232:235], a[108:111], v[60:63]
    s_waitcnt vmcnt(0)
    v_mfma_f32_16x16x32_bf16 v[48:51], v[236:239], a[112:115], v[48:51]
    v_mfma_f32_16x16x32_bf16 v[52:55], v[236:239], a[116:119], v[52:55]
    v_mfma_f32_16x16x32_bf16 v[56:59], v[236:239], a[120:123], v[56:59]
    v_mfma_f32_16x16x32_bf16 v[60:63], v[236:239], a[124:127], v[60:63]
    s_xor_b32 s36, s36, 8192
    s_nop 3
    v_sub_f32 v48, v48, v245
    v_sub_f32 v49, v49, v245
    v_sub_f32 v50, v50, v245
    v_sub_f32 v51, v51, v245
    v_exp_f32 v48, v48
    v_exp_f32 v49, v49
    v_exp_f32 v50, v50
    v_exp_f32 v51, v51
    v_cvt_pk_bf16_f32 v108, v48, v49
    v_cvt_pk_bf16_f32 v109, v50, v51
    v_sub_f32 v52, v52, v246
    v_sub_f32 v53, v53, v246
    v_sub_f32 v54, v54, v246
    v_sub_f32 v55, v55, v246
    v_exp_f32 v52, v52
    v_exp_f32 v53, v53
    v_exp_f32 v54, v54
    v_exp_f32 v55, v55
    v_cvt_pk_bf16_f32 v112, v52, v53
    v_cvt_pk_bf16_f32 v113, v54, v55
    v_sub_f32 v56, v56, v247
    v_sub_f32 v57, v57, v247
    v_sub_f32 v58, v58, v247
    v_sub_f32 v59, v59, v247
    v_exp_f32 v56, v56
    v_exp_f32 v57, v57
    v_exp_f32 v58, v58
    v_exp_f32 v59, v59
    v_cvt_pk_bf16_f32 v116, v56, v57
    v_cvt_pk_bf16_f32 v117, v58, v59
    v_sub_f32 v60, v60, v248
    v_sub_f32 v61, v61, v248
    v_sub_f32 v62, v62, v248
    v_sub_f32 v63, v63, v248
    v_exp_f32 v60, v60
    v_exp_f32 v61, v61
    v_exp_f32 v62, v62
    v_exp_f32 v63, v63
    v_cvt_pk_bf16_f32 v120, v60, v61
    v_cvt_pk_bf16_f32 v121, v62, v63
    buffer_load_dwordx4 v[208:211], v39, s[8:11], s36 offen offset:0
    buffer_load_dwordx4 v[212:215], v39, s[8:11], s36 offen offset:64
    buffer_load_dwordx4 v[216:219], v39, s[8:11], s36 offen offset:128
    buffer_load_dwordx4 v[220:223], v39, s[8:11], s36 offen offset:192
    buffer_load_dwordx4 v[224:227], v39, s[8:11], s36 offen offset:256
    buffer_load_dwordx4 v[228:231], v39, s[8:11], s36 offen offset:320
    buffer_load_dwordx4 v[232:235], v39, s[8:11], s36 offen offset:384
    buffer_load_dwordx4 v[236:239], v39, s[8:11], s36 offen offset:448
    s_waitcnt vmcnt(7)
    v_mfma_f32_16x16x32_bf16 v[68:71], v[208:211], a[0:3], 0
    v_mfma_f32_16x16x32_bf16 v[72:75], v[208:211], a[4:7], 0
    v_mfma_f32_16x16x32_bf16 v[76:79], v[208:211], a[8:11], 0
    v_mfma_f32_16x16x32_bf16 v[80:83], v[208:211], a[12:15], 0
    s_waitcnt vmcnt(6)
    v_mfma_f32_16x16x32_bf16 v[68:71], v[212:215], a[16:19], v[68:71]
    v_mfma_f32_16x16x32_bf16 v[72:75], v[212:215], a[20:23], v[72:75]
    v_mfma_f32_16x16x32_bf16 v[76:79], v[212:215], a[24:27], v[76:79]
    v_mfma_f32_16x16x32_bf16 v[80:83], v[212:215], a[28:31], v[80:83]
    s_waitcnt vmcnt(5)
    v_mfma_f32_16x16x32_bf16 v[68:71], v[216:219], a[32:35], v[68:71]
    v_mfma_f32_16x16x32_bf16 v[72:75], v[216:219], a[36:39], v[72:75]
    v_mfma_f32_16x16x32_bf16 v[76:79], v[216:219], a[40:43], v[76:79]
    v_mfma_f32_16x16x32_bf16 v[80:83], v[216:219], a[44:47], v[80:83]
    s_waitcnt vmcnt(4)
    v_mfma_f32_16x16x32_bf16 v[68:71], v[220:223], a[48:51], v[68:71]
    v_mfma_f32_16x16x32_bf16 v[72:75], v[220:223], a[52:55], v[72:75]
    v_mfma_f32_16x16x32_bf16 v[76:79], v[220:223], a[56:59], v[76:79]
    v_mfma_f32_16x16x32_bf16 v[80:83], v[220:223], a[60:63], v[80:83]
    s_waitcnt vmcnt(3)
    v_mfma_f32_16x16x32_bf16 v[68:71], v[224:227], a[64:67], v[68:71]
    v_mfma_f32_16x16x32_bf16 v[72:75], v[224:227], a[68:71], v[72:75]
    v_mfma_f32_16x16x32_bf16 v[76:79], v[224:227], a[72:75], v[76:79]
    v_mfma_f32_16x16x32_bf16 v[80:83], v[224:227], a[76:79], v[80:83]
    s_waitcnt vmcnt(2)
    v_mfma_f32_16x16x32_bf16 v[68:71], v[228:231], a[80:83], v[68:71]
    v_mfma_f32_16x16x32_bf16 v[72:75], v[228:231], a[84:87], v[72:75]
    v_mfma_f32_16x16x32_bf16 v[76:79], v[228:231], a[88:91], v[76:79]
    v_mfma_f32_16x16x32_bf16 v[80:83], v[228:231], a[92:95], v[80:83]
    s_waitcnt vmcnt(1)
    v_mfma_f32_16x16x32_bf16 v[68:71], v[232:235], a[96:99], v[68:71]
    v_mfma_f32_16x16x32_bf16 v[72:75], v[232:235], a[100:103], v[72:75]
    v_mfma_f32_16x16x32_bf16 v[76:79], v[232:235], a[104:107], v[76:79]
    v_mfma_f32_16x16x32_bf16 v[80:83], v[232:235], a[108:111], v[80:83]
    s_waitcnt vmcnt(0)
    v_mfma_f32_16x16x32_bf16 v[68:71], v[236:239], a[112:115], v[68:71]
    v_mfma_f32_16x16x32_bf16 v[72:75], v[236:239], a[116:119], v[72:75]
    v_mfma_f32_16x16x32_bf16 v[76:79], v[236:239], a[120:123], v[76:79]
    v_mfma_f32_16x16x32_bf16 v[80:83], v[236:239], a[124:127], v[80:83]
    s_nop 4
    v_sub_f32 v68, v68, v245
    v_sub_f32 v69, v69, v245
    v_sub_f32 v70, v70, v245
    v_sub_f32 v71, v71, v245
    v_exp_f32 v68, v68
    v_exp_f32 v69, v69
    v_exp_f32 v70, v70
    v_exp_f32 v71, v71
    v_cvt_pk_bf16_f32 v110, v68, v69
    v_cvt_pk_bf16_f32 v111, v70, v71
    v_sub_f32 v72, v72, v246
    v_sub_f32 v73, v73, v246
    v_sub_f32 v74, v74, v246
    v_sub_f32 v75, v75, v246
    v_exp_f32 v72, v72
    v_exp_f32 v73, v73
    v_exp_f32 v74, v74
    v_exp_f32 v75, v75
    v_cvt_pk_bf16_f32 v114, v72, v73
    v_cvt_pk_bf16_f32 v115, v74, v75
    v_sub_f32 v76, v76, v247
    v_sub_f32 v77, v77, v247
    v_sub_f32 v78, v78, v247
    v_sub_f32 v79, v79, v247
    v_exp_f32 v76, v76
    v_exp_f32 v77, v77
    v_exp_f32 v78, v78
    v_exp_f32 v79, v79
    v_cvt_pk_bf16_f32 v118, v76, v77
    v_cvt_pk_bf16_f32 v119, v78, v79
    v_sub_f32 v80, v80, v248
    v_sub_f32 v81, v81, v248
    v_sub_f32 v82, v82, v248
    v_sub_f32 v83, v83, v248
    v_exp_f32 v80, v80
    v_exp_f32 v81, v81
    v_exp_f32 v82, v82
    v_exp_f32 v83, v83
    v_cvt_pk_bf16_f32 v122, v80, v81
    v_cvt_pk_bf16_f32 v123, v82, v83
    ds_write_b128 v40, v[108:111] offset:0
    v_mfma_f32_16x16x32_bf16 v[88:91], v[44:47], v[108:111], v[88:91]
    ds_write_b128 v40, v[112:115] offset:1024
    v_mfma_f32_16x16x32_bf16 v[92:95], v[44:47], v[112:115], v[92:95]
    ds_write_b128 v40, v[116:119] offset:2048
    v_mfma_f32_16x16x32_bf16 v[96:99], v[44:47], v[116:119], v[96:99]
    ds_write_b128 v40, v[120:123] offset:3072
    v_mfma_f32_16x16x32_bf16 v[100:103], v[44:47], v[120:123], v[100:103]
    s_add_u32 s79, s79, 1
    s_cmp_lt_u32 s79, 4
    s_nop 7
    s_cbranch_scc1 L_slow2_l
    ds_write_b32 v13, v88 offset:0
    ds_write_b32 v13, v92 offset:256
    ds_write_b32 v13, v96 offset:512
    ds_write_b32 v13, v100 offset:768
    s_waitcnt vmcnt(0) lgkmcnt(0)
    s_nop 7
    s_barrier
    s_branch L_pv_l
L_k1_end:
    s_endpgm

.section .rodata,"a"
.p2align 6
.amdhsa_kernel standalone__mha_block_cached__near_ridge_kernel
  .amdhsa_next_free_vgpr 512
  .amdhsa_next_free_sgpr 102
  .amdhsa_accum_offset 256
  .amdhsa_group_segment_fixed_size 0
  .amdhsa_kernarg_size 64
  .amdhsa_user_sgpr_count 2
  .amdhsa_user_sgpr_kernarg_segment_ptr 1
  .amdhsa_system_sgpr_workgroup_id_x 1
  .amdhsa_float_denorm_mode_32 3
.end_amdhsa_kernel
.text
```
